```python
import torch

def _softmax(x, axis=-1):
    return torch.softmax(x, dim=axis)
def _gelu(x):
    return torch.nn.functional.gelu(x, approximate="tanh")
def _silu(x):
    return torch.nn.functional.silu(x)
def _sigmoid(x):
    return torch.sigmoid(x)
def _layernorm(x, axis=-1, eps=1e-5):
    m = x.mean(dim=axis, keepdim=True)
    v = x.var(dim=axis, keepdim=True, unbiased=False)
    return (x - m) / torch.sqrt(v + eps)
def _scatter_add(tgt, idx, src, axis=0):
    return tgt.clone().index_add_(axis, idx, src)
def _segment_sum(src, seg, n):
    out = torch.zeros((n,) + src.shape[1:], dtype=src.dtype)
    return out.index_add_(0, seg, src)
def _pad(x, pw):
    flat = tuple(v for pair in reversed(pw) for v in pair)
    return torch.nn.functional.pad(x, flat)

kernel_name = 'gated_mix__linear_kernel_hedgehog__mixer_channel_mlp__prompt'

def setup_inputs():

    _w = (lambda a: (lambda t: t.to(torch.bfloat16) if t.is_floating_point() else t)(torch.as_tensor(a)))
    def _A_setup():
        B, S, D, H = 1, 2048, 1024, 32
        Dh = D // H
        return {
            "x": _w((lambda *s: torch.randn(*s, dtype=torch.bfloat16) * 0.05)(B, S, D)),
            "wqkv": _w((lambda *s: torch.randn(*s, dtype=torch.bfloat16) * 0.8)(D, 3 * D)),
            "w_phi": _w((lambda *s: torch.randn(*s, dtype=torch.bfloat16) * 0.8)(H, Dh, Dh) * (Dh ** -0.5)),
            "wo": _w((lambda *s: torch.randn(*s, dtype=torch.bfloat16) * 0.1)(D, D)),
        }
    _A_in = _A_setup()

    def _B_setup():
        B, S, D, F = 1, 2048, 1024, 3584
        return {
            "x": _w((lambda *s: torch.randn(*s, dtype=torch.bfloat16) * 0.05)(B, S, D)),
            "w1": _w((lambda *s: torch.randn(*s, dtype=torch.bfloat16) * 1.6)(D, F) * (D ** -0.5)),
            "b1": _w((lambda *s: torch.randn(*s, dtype=torch.bfloat16) * 0.4)(F)),
            "w2": _w((lambda *s: torch.randn(*s, dtype=torch.bfloat16) * 0.05)(F, D) * (F ** -0.5)),
            "b2": _w((lambda *s: torch.randn(*s, dtype=torch.bfloat16) * 0.05)(D)),
        }
    _B_in = _B_setup()

    return {
        "A_x": _A_in["x"],
        "A_wqkv": _A_in["wqkv"],
        "A_w_phi": _A_in["w_phi"],
        "A_wo": _A_in["wo"],
        "B_x": _B_in["x"],
        "B_w1": _B_in["w1"],
        "B_b1": _B_in["b1"],
        "B_w2": _B_in["w2"],
        "B_b2": _B_in["b2"],
        "gate_w": _w((lambda *s: torch.randn(*s, dtype=torch.bfloat16) * 0.05)(1024) * 16.0),
    }

def reference(A_x, A_wqkv, A_w_phi, A_wo, B_x, B_w1, B_b1, B_w2, B_b2, gate_w):
    def _A_ref(x, wqkv, w_phi, wo):
        B, S, D = x.shape
        H = 32; Dh = D // H
        qkv = (lambda x, *d: x.permute(*d))((x @ wqkv).reshape(B, S, 3, H, Dh), 2, 0, 3, 1, 4)
        q, k, v = qkv[0], qkv[1], qkv[2]
        pq = torch.einsum("bhsd,hdf->bhsf", q, w_phi)
        pk = torch.einsum("bhsd,hdf->bhsf", k, w_phi)
        phi_q = torch.concatenate([_softmax(pq, axis=-1), _softmax(-pq, axis=-1)], axis=-1)
        phi_k = torch.concatenate([_softmax(pk, axis=-1), _softmax(-pk, axis=-1)], axis=-1)
        kv = torch.einsum("bhsf,bhsd->bhfd", phi_k, v)
        z  = torch.einsum("bhsf->bhf", phi_k)
        num = torch.einsum("bhqf,bhfd->bhqd", phi_q, kv)
        den = torch.einsum("bhqf,bhf->bhq", phi_q, z)[..., None] + 1e-6
        o = num / den
        return (lambda x, *d: x.permute(*d))(o, 0, 2, 1, 3).reshape(B, S, D) @ wo

    def _B_ref(x, w1, b1, w2, b2):
        y = _layernorm(x, axis=-1)
        h = _gelu(torch.einsum("bsd,df->bsf", y, w1) + b1)
        return torch.einsum("bsf,fd->bsd", h, w2) + b2

    x = A_x
    g = _sigmoid((x * gate_w).sum(-1, keepdims=True))
    a = _A_ref(x, A_wqkv, A_w_phi, A_wo)
    b = _B_ref(x, B_w1, B_b1, B_w2, B_b2)
    return g * a + (1 - g) * b
```

```asm
; @launch grid=(256,1,1) block=(256,1,1) lds=131072
.amdgcn_target "amdgcn-amd-amdhsa--gfx950"
.text
.globl gated_mix__linear_kernel_hedgehog__mixer_channel_mlp__prompt_kernel
.p2align 8
.type gated_mix__linear_kernel_hedgehog__mixer_channel_mlp__prompt_kernel,@function
gated_mix__linear_kernel_hedgehog__mixer_channel_mlp__prompt_kernel:
    s_cmp_ge_u32 s2, 256
    s_cbranch_scc1 gated_mix__linear_kernel_hedgehog__mixer_channel_mlp__prompt_kernel_end
    s_getpc_b64 s[50:51]
pc_1:
    s_sub_u32 s50, s50, pc_1-gated_mix__linear_kernel_hedgehog__mixer_channel_mlp__prompt_kernel
    s_subb_u32 s51, s51, 0
    s_lshr_b32 s48, s2, 3
    s_lshl_b32 s48, s48, 2
    v_lshrrev_b32 v64, 6, v0
    v_add_u32 v64, s48, v64
    v_mul_u32_u24 v64, 4, v64
    v_and_b32 v65, 63, v0
    v_min_u32 v65, 3, v65
    v_add_u32 v64, v64, v65
    v_lshlrev_b32 v64, 7, v64
    v_min_u32 v64, gated_mix__linear_kernel_hedgehog__mixer_channel_mlp__prompt_kernel_end-gated_mix__linear_kernel_hedgehog__mixer_channel_mlp__prompt_kernel, v64
    global_load_dword a253, v64, s[50:51]
    s_load_dwordx2 s[4:5], s[0:1], 0
    s_load_dwordx2 s[6:7], s[0:1], 72
    s_load_dwordx2 s[70:71], s[0:1], 8
    s_load_dwordx2 s[72:73], s[0:1], 40
    s_load_dwordx2 s[74:75], s[0:1], 16
    s_load_dwordx2 s[76:77], s[0:1], 48
    s_load_dwordx2 s[52:53], s[0:1], 96
    s_load_dwordx2 s[68:69], s[0:1], 88
    s_load_dwordx2 s[96:97], s[0:1], 56
    s_load_dwordx2 s[98:99], s[0:1], 24
    v_and_b32 v1, 63, v0
    v_lshrrev_b32 v24, 6, v0
    s_and_b32 s44, s2, 7
    s_lshr_b32 s39, s2, 3
    v_readfirstlane_b32 s32, v24
    s_and_b32 s38, s39, 1
    s_and_b32 s35, s44, 1
    s_lshl_b32 s35, s35, 2
    s_bfe_u32 s45, s39, 0x20001
    s_add_u32 s35, s35, s45
    s_lshr_b32 s36, s44, 1
    s_lshl_b32 s36, s36, 2
    s_lshr_b32 s45, s39, 3
    s_add_u32 s36, s36, s45
    s_lshr_b32 s33, s32, 1
    s_and_b32 s34, s32, 1
    s_waitcnt lgkmcnt(0)
    s_cmp_lg_u32 s32, 0
    s_cbranch_scc1 mbz_2
    s_lshl_b32 s58, s2, 8
    s_add_u32 s58, s58, 23592960
    s_add_u32 s56, s52, s58
    s_addc_u32 s57, s53, 0
    s_mov_b32 s58, 256
    s_mov_b32 s59, 0x20000
    v_lshlrev_b32 v24, 2, v1
    v_mov_b32 v25, 0
    buffer_store_dword v25, v24, s[56:59], 0 offen sc1
mbz_2:
    s_lshl_b32 s100, s2, 8
    s_add_u32 s100, s100, 23592960
    s_add_u32 s100, s52, s100
    s_addc_u32 s101, s53, 0
    s_cmp_eq_u32 s38, 0
    s_cbranch_scc1 gated_mix__linear_kernel_hedgehog__mixer_channel_mlp__prompt_kernel_qkv
    s_lshl_b32 s44, s35, 19
    s_add_u32 s8, s4, s44
    s_addc_u32 s9, s5, 0
    s_mov_b32 s10, 524288
    s_mov_b32 s11, 0x20000
    s_mul_i32 s44, s36, 448
    s_add_u32 s12, s72, s44
    s_addc_u32 s13, s73, 0
    s_sub_u32 s14, 7340032, s44
    s_mov_b32 s15, 0x20000
    s_movk_i32 s46, 7168
    s_cmp_lt_u32 s32, 2
    s_cselect_b32 s20, s12, s8
    s_cselect_b32 s21, s13, s9
    s_cselect_b32 s22, s14, s10
    s_mov_b32 s23, 0x20000
    s_movk_i32 s45, 128
    s_cselect_b32 s43, 458752, s45
    s_and_b32 s44, s35, 3
    s_lshl_b32 s44, s44, 4
    s_lshl_b32 s45, s32, 3
    s_add_u32 s44, s44, s45
    v_lshrrev_b32 v24, 2, v1
    v_add_u32 v24, s44, v24
    v_mul_u32_u24 v24, s46, v24
    v_and_b32 v25, 3, v1
    v_lshlrev_b32 v25, 7, v25
    v_add_u32 v24, v24, v25
    s_and_b32 s44, s36, 3
    s_lshl_b32 s44, s44, 1
    s_add_u32 s44, s44, s38
    s_lshl_b32 s44, s44, 5
    s_and_b32 s45, s32, 1
    s_lshl_b32 s45, s45, 4
    s_add_u32 s44, s44, s45
    v_add_u32 v25, s44, v1
    v_lshlrev_b32 v25, 11, v25
    s_cmp_lt_u32 s32, 2
    s_cselect_b32 s44, 32, 16
    s_cselect_b64 vcc, -1, 0
    v_cndmask_b32 v24, v25, v24, vcc
    v_cmp_gt_u32 vcc, s44, v1
    v_mov_b32 v25, 0x7ffffff0
    s_nop 0
    v_cndmask_b32 v22, v25, v24, vcc
    s_mov_b32 s42, 0
    buffer_load_dword a251, v22, s[20:23], s42 offen
    s_add_u32 s42, s42, s43
    buffer_load_dword a251, v22, s[20:23], s42 offen
    s_add_u32 s42, s42, s43
    buffer_load_dword a251, v22, s[20:23], s42 offen
    s_add_u32 s42, s42, s43
    v_lshrrev_b32 v24, 3, v1
    s_lshl_b32 s44, s32, 6
    v_add_u32 v24, s44, v24
    v_lshlrev_b32 v24, 11, v24
    v_and_b32 v25, 7, v1
    v_lshrrev_b32 v26, 4, v1
    v_xor_b32 v25, v25, v26
    v_lshlrev_b32 v25, 4, v25
    v_add_u32 v2, v24, v25
    v_xor_b32 v24, 64, v2
    v_add_u32 v3, 15360, v24
    v_add_u32 v4, 30720, v2
    v_xor_b32 v24, 64, v2
    v_add_u32 v5, 46080, v24
    v_add_u32 v6, 65536, v2
    v_xor_b32 v24, 64, v2
    v_add_u32 v7, 80896, v24
    v_add_u32 v8, 96256, v2
    v_xor_b32 v24, 64, v2
    v_add_u32 v9, 111616, v24
    s_mul_i32 s44, s32, 448
    s_movk_i32 s45, 2341
    s_movk_i32 s46, 7168
    v_add_u32 v24, s44, v1
    v_mul_u32_u24 v25, s45, v24
    v_lshrrev_b32 v25, 16, v25
    v_mul_u32_u24 v26, 28, v25
    v_sub_u32 v26, v24, v26
    v_bfe_u32 v27, v25, 3, 1
    v_lshlrev_b32 v27, 1, v27
    v_xor_b32 v26, v26, v27
    v_lshlrev_b32 v26, 4, v26
    v_mul_u32_u24 v25, s46, v25
    v_add_u32 v10, v25, v26
    v_add_u32 v24, s44, v1
    v_add_u32 v24, 64, v24
    v_mul_u32_u24 v25, s45, v24
    v_lshrrev_b32 v25, 16, v25
    v_mul_u32_u24 v26, 28, v25
    v_sub_u32 v26, v24, v26
    v_bfe_u32 v27, v25, 3, 1
    v_lshlrev_b32 v27, 1, v27
    v_xor_b32 v26, v26, v27
    v_lshlrev_b32 v26, 4, v26
    v_mul_u32_u24 v25, s46, v25
    v_add_u32 v11, v25, v26
    v_subrev_u32 v11, 1024, v11
    v_add_u32 v24, s44, v1
    v_add_u32 v24, 128, v24
    v_mul_u32_u24 v25, s45, v24
    v_lshrrev_b32 v25, 16, v25
    v_mul_u32_u24 v26, 28, v25
    v_sub_u32 v26, v24, v26
    v_bfe_u32 v27, v25, 3, 1
    v_lshlrev_b32 v27, 1, v27
    v_xor_b32 v26, v26, v27
    v_lshlrev_b32 v26, 4, v26
    v_mul_u32_u24 v25, s46, v25
    v_add_u32 v12, v25, v26
    v_subrev_u32 v12, 2048, v12
    v_add_u32 v24, s44, v1
    v_add_u32 v24, 192, v24
    v_mul_u32_u24 v25, s45, v24
    v_lshrrev_b32 v25, 16, v25
    v_mul_u32_u24 v26, 28, v25
    v_sub_u32 v26, v24, v26
    v_bfe_u32 v27, v25, 3, 1
    v_lshlrev_b32 v27, 1, v27
    v_xor_b32 v26, v26, v27
    v_lshlrev_b32 v26, 4, v26
    v_mul_u32_u24 v25, s46, v25
    v_add_u32 v13, v25, v26
    v_subrev_u32 v13, 3072, v13
    v_add_u32 v24, s44, v1
    v_add_u32 v24, 256, v24
    v_mul_u32_u24 v25, s45, v24
    v_lshrrev_b32 v25, 16, v25
    v_mul_u32_u24 v26, 28, v25
    v_sub_u32 v26, v24, v26
    v_bfe_u32 v27, v25, 3, 1
    v_lshlrev_b32 v27, 1, v27
    v_xor_b32 v26, v26, v27
    v_lshlrev_b32 v26, 4, v26
    v_mul_u32_u24 v25, s46, v25
    v_add_u32 v14, v25, v26
    v_add_u32 v24, s44, v1
    v_add_u32 v24, 320, v24
    v_mul_u32_u24 v25, s45, v24
    v_lshrrev_b32 v25, 16, v25
    v_mul_u32_u24 v26, 28, v25
    v_sub_u32 v26, v24, v26
    v_bfe_u32 v27, v25, 3, 1
    v_lshlrev_b32 v27, 1, v27
    v_xor_b32 v26, v26, v27
    v_lshlrev_b32 v26, 4, v26
    v_mul_u32_u24 v25, s46, v25
    v_add_u32 v15, v25, v26
    v_subrev_u32 v15, 1024, v15
    v_add_u32 v24, s44, v1
    v_add_u32 v24, 384, v24
    v_mul_u32_u24 v25, s45, v24
    v_lshrrev_b32 v25, 16, v25
    v_mul_u32_u24 v26, 28, v25
    v_sub_u32 v26, v24, v26
    v_bfe_u32 v27, v25, 3, 1
    v_lshlrev_b32 v27, 1, v27
    v_xor_b32 v26, v26, v27
    v_lshlrev_b32 v26, 4, v26
    v_mul_u32_u24 v25, s46, v25
    v_add_u32 v16, v25, v26
    v_subrev_u32 v16, 2048, v16
    s_lshl_b32 s44, s32, 13
    s_add_u32 s24, s44, 0
    s_add_u32 s25, s24, 4096
    s_mul_i32 s44, s32, 7168
    s_add_u32 s26, s44, 65536
    s_add_u32 s27, s26, 4096
    s_lshl_b32 s44, s32, 13
    s_add_u32 s28, s44, 32768
    s_add_u32 s29, s28, 4096
    s_mul_i32 s44, s32, 7168
    s_add_u32 s30, s44, 94208
    s_add_u32 s31, s30, 4096
    s_mov_b32 s40, 0
    s_mov_b32 s41, 0
    v_and_b32 v24, 15, v1
    v_lshrrev_b32 v25, 4, v1
    s_lshl_b32 s44, s33, 7
    v_add_u32 v26, s44, v24
    v_lshlrev_b32 v26, 7, v26
    v_lshrrev_b32 v27, 1, v24
    v_xor_b32 v27, v27, v25
    v_lshlrev_b32 v27, 4, v27
    v_add_u32 v17, v26, v27
    v_xor_b32 v18, 64, v17
    v_lshrrev_b32 v26, 2, v24
    v_lshlrev_b32 v27, 3, v25
    v_add_u32 v26, v26, v27
    s_movk_i32 s45, 448
    v_mul_u32_u24 v26, s45, v26
    v_and_b32 v27, 3, v1
    v_lshlrev_b32 v27, 3, v27
    v_add_u32 v26, v26, v27
    v_add_u32 v26, 65536, v26
    v_and_b32 v27, 1, v25
    v_lshlrev_b32 v28, 5, v27
    s_lshl_b32 s44, s34, 8
    v_add_u32 v29, s44, v26
    v_add_u32 v19, v29, v28
    v_sub_u32 v20, v29, v28
    s_add_u32 s44, s34, 6
    v_xor_b32 v27, s44, v27
    v_lshlrev_b32 v27, 5, v27
    v_add_u32 v21, v26, v27
    s_mov_b32 m0, s24
    s_nop 0
    buffer_load_dwordx4 v2, s[8:11], s40 offen lds
    buffer_load_dwordx4 v3, s[8:11], s40 offen offset:1024 lds
    buffer_load_dwordx4 v4, s[8:11], s40 offen offset:2048 lds
    buffer_load_dwordx4 v5, s[8:11], s40 offen offset:3072 lds
    s_mov_b32 m0, s25
    s_nop 0
    buffer_load_dwordx4 v6, s[8:11], s40 offen lds
    buffer_load_dwordx4 v7, s[8:11], s40 offen offset:1024 lds
    buffer_load_dwordx4 v8, s[8:11], s40 offen offset:2048 lds
    buffer_load_dwordx4 v9, s[8:11], s40 offen offset:3072 lds
    s_mov_b32 m0, s26
    s_nop 0
    buffer_load_dwordx4 v10, s[12:15], s41 offen lds
    buffer_load_dwordx4 v11, s[12:15], s41 offen offset:1024 lds
    buffer_load_dwordx4 v12, s[12:15], s41 offen offset:2048 lds
    buffer_load_dwordx4 v13, s[12:15], s41 offen offset:3072 lds
    s_mov_b32 m0, s27
    s_nop 0
    buffer_load_dwordx4 v14, s[12:15], s41 offen lds
    buffer_load_dwordx4 v15, s[12:15], s41 offen offset:1024 lds
    buffer_load_dwordx4 v16, s[12:15], s41 offen offset:2048 lds
    s_add_u32 s40, s40, 128
    s_add_u32 s41, s41, 458752
    s_mov_b32 m0, s28
    s_nop 0
    buffer_load_dwordx4 v2, s[8:11], s40 offen lds
    buffer_load_dwordx4 v3, s[8:11], s40 offen offset:1024 lds
    buffer_load_dwordx4 v4, s[8:11], s40 offen offset:2048 lds
    buffer_load_dwordx4 v5, s[8:11], s40 offen offset:3072 lds
    s_mov_b32 m0, s29
    s_nop 0
    buffer_load_dwordx4 v6, s[8:11], s40 offen lds
    buffer_load_dwordx4 v7, s[8:11], s40 offen offset:1024 lds
    buffer_load_dwordx4 v8, s[8:11], s40 offen offset:2048 lds
    buffer_load_dwordx4 v9, s[8:11], s40 offen offset:3072 lds
    s_mov_b32 m0, s30
    s_nop 0
    buffer_load_dwordx4 v10, s[12:15], s41 offen lds
    buffer_load_dwordx4 v11, s[12:15], s41 offen offset:1024 lds
    buffer_load_dwordx4 v12, s[12:15], s41 offen offset:2048 lds
    buffer_load_dwordx4 v13, s[12:15], s41 offen offset:3072 lds
    s_mov_b32 m0, s31
    s_nop 0
    buffer_load_dwordx4 v14, s[12:15], s41 offen lds
    buffer_load_dwordx4 v15, s[12:15], s41 offen offset:1024 lds
    buffer_load_dwordx4 v16, s[12:15], s41 offen offset:2048 lds
    s_add_u32 s40, s40, 128
    s_add_u32 s41, s41, 458752
    buffer_load_dword a251, v22, s[20:23], s42 offen
    s_add_u32 s42, s42, s43
    v_and_b32 v63, 31, v1
    v_cmp_gt_u32 vcc, 28, v63
    v_lshlrev_b32 v63, 4, v63
    v_lshrrev_b32 v62, 5, v1
    s_movk_i32 s44, 7168
    v_mul_u32_u24 v62, s44, v62
    v_add_u32 v62, v62, v63
    v_mov_b32 v63, 0x7ffffff0
    v_cndmask_b32 v62, v63, v62, vcc
    s_lshl_b32 s44, s35, 2
    s_add_u32 s44, s44, s32
    s_mul_i32 s44, s44, 229376
    s_mul_i32 s45, s36, 448
    s_add_u32 s44, s44, s45
    s_add_u32 s56, s72, s44
    s_addc_u32 s57, s73, 0
    s_mov_b32 s58, 222656
    s_mov_b32 s59, 0x20000
    s_mov_b32 s67, 0
    s_mov_b32 s64, 0x00003f80
    s_mov_b32 s65, 0x3f800000
    v_mov_b32 v48, 0
    v_mov_b32 v49, 0
    v_mov_b32 v50, 0
    v_mov_b32 v51, 0
    v_mov_b32 v52, 0
    v_mov_b32 v53, 0
    v_mov_b32 v54, 0
    v_mov_b32 v55, 0
    s_waitcnt vmcnt(16)
    s_barrier
    ds_read_b64_tr_b16 a[32:33], v19 offset:0
    ds_read_b64_tr_b16 a[34:35], v19 offset:1792
    ds_read_b128 a[0:3], v17 offset:0
    ds_read_b128 a[4:7], v17 offset:2048
    ds_read_b128 a[8:11], v17 offset:4096
    ds_read_b128 a[12:15], v17 offset:6144
    ds_read_b128 a[16:19], v17 offset:8192
    ds_read_b128 a[20:23], v17 offset:10240
    ds_read_b128 a[24:27], v17 offset:12288
    ds_read_b128 a[28:31], v17 offset:14336
    ds_read_b64_tr_b16 a[36:37], v20 offset:32
    ds_read_b64_tr_b16 a[38:39], v20 offset:1824
    ds_read_b64_tr_b16 a[40:41], v19 offset:64
    ds_read_b64_tr_b16 a[42:43], v19 offset:1856
    ds_read_b64_tr_b16 a[44:45], v20 offset:96
    ds_read_b64_tr_b16 a[46:47], v20 offset:1888
    ds_read_b64_tr_b16 a[48:49], v19 offset:128
    ds_read_b64_tr_b16 a[50:51], v19 offset:1920
    ds_read_b64_tr_b16 a[52:53], v20 offset:160
    ds_read_b64_tr_b16 a[54:55], v20 offset:1952
    ds_read_b64_tr_b16 a[56:57], v21 offset:0
    ds_read_b64_tr_b16 a[58:59], v21 offset:1792
    s_mov_b32 s72, s52
    s_mov_b32 s73, s53
    s_mov_b32 s74, 0
    s_mov_b32 s75, 0x20000
    s_cmp_lg_u32 s32, 0
    s_cbranch_scc1 ini_3
    v_mov_b32 v56, 0
    v_mov_b32 v57, 1
    v_cmp_eq_u32 vcc, 0, v1
    s_nop 1
    s_and_saveexec_b64 s[50:51], vcc
    global_atomic_add v56, v57, s[68:69] sc1
    s_mov_b64 exec, s[50:51]
ini_3:
    v_mov_b32 v58, 0
    v_mov_b32 v60, 0
    s_waitcnt lgkmcnt(0)
    v_mfma_f32_16x16x32_bf16 v[64:67], a[32:35], a[0:3], 0
    ds_read_b64_tr_b16 a[92:93], v19 offset:14336
    v_mfma_f32_16x16x32_bf16 v[88:91], a[32:35], a[4:7], 0
    ds_read_b64_tr_b16 a[94:95], v19 offset:16128
    v_mfma_f32_16x16x32_bf16 v[112:115], a[32:35], a[8:11], 0
    v_mfma_f32_16x16x32_bf16 v[136:139], a[32:35], a[12:15], 0
    ds_read_b128 a[60:63], v18 offset:0
    v_mfma_f32_16x16x32_bf16 v[160:163], a[32:35], a[16:19], 0
    v_mfma_f32_16x16x32_bf16 v[184:187], a[32:35], a[20:23], 0
    ds_read_b128 a[64:67], v18 offset:2048
    v_mfma_f32_16x16x32_bf16 v[208:211], a[32:35], a[24:27], 0
    ds_read_b128 a[68:71], v18 offset:4096
    v_mfma_f32_16x16x32_bf16 v[232:235], a[32:35], a[28:31], 0
    v_mfma_f32_16x16x32_bf16 v[68:71], a[36:39], a[0:3], 0
    ds_read_b128 a[72:75], v18 offset:6144
    v_mfma_f32_16x16x32_bf16 v[92:95], a[36:39], a[4:7], 0
    v_mfma_f32_16x16x32_bf16 v[116:119], a[36:39], a[8:11], 0
    ds_read_b128 a[76:79], v18 offset:8192
    v_mfma_f32_16x16x32_bf16 v[140:143], a[36:39], a[12:15], 0
    v_mfma_f32_16x16x32_bf16 v[164:167], a[36:39], a[16:19], 0
    ds_read_b128 a[80:83], v18 offset:10240
    v_mfma_f32_16x16x32_bf16 v[188:191], a[36:39], a[20:23], 0
    ds_read_b128 a[84:87], v18 offset:12288
    v_mfma_f32_16x16x32_bf16 v[212:215], a[36:39], a[24:27], 0
    v_mfma_f32_16x16x32_bf16 v[236:239], a[36:39], a[28:31], 0
    ds_read_b128 a[88:91], v18 offset:14336
    v_mfma_f32_16x16x32_bf16 v[72:75], a[40:43], a[0:3], 0
    v_mfma_f32_16x16x32_bf16 v[96:99], a[40:43], a[4:7], 0
    ds_read_b64_tr_b16 a[96:97], v20 offset:14368
    v_mfma_f32_16x16x32_bf16 v[120:123], a[40:43], a[8:11], 0
    ds_read_b64_tr_b16 a[98:99], v20 offset:16160
    v_mfma_f32_16x16x32_bf16 v[144:147], a[40:43], a[12:15], 0
    v_mfma_f32_16x16x32_bf16 v[168:171], a[40:43], a[16:19], 0
    ds_read_b64_tr_b16 a[100:101], v19 offset:14400
    v_mfma_f32_16x16x32_bf16 v[192:195], a[40:43], a[20:23], 0
    v_mfma_f32_16x16x32_bf16 v[216:219], a[40:43], a[24:27], 0
    ds_read_b64_tr_b16 a[102:103], v19 offset:16192
    v_mfma_f32_16x16x32_bf16 v[240:243], a[40:43], a[28:31], 0
    v_mfma_f32_16x16x32_bf16 v[76:79], a[44:47], a[0:3], 0
    ds_read_b64_tr_b16 a[104:105], v20 offset:14432
    v_mfma_f32_16x16x32_bf16 v[100:103], a[44:47], a[4:7], 0
    ds_read_b64_tr_b16 a[106:107], v20 offset:16224
    v_mfma_f32_16x16x32_bf16 v[124:127], a[44:47], a[8:11], 0
    v_mfma_f32_16x16x32_bf16 v[148:151], a[44:47], a[12:15], 0
    ds_read_b64_tr_b16 a[108:109], v19 offset:14464
    v_mfma_f32_16x16x32_bf16 v[172:175], a[44:47], a[16:19], 0
    v_mfma_f32_16x16x32_bf16 v[196:199], a[44:47], a[20:23], 0
    ds_read_b64_tr_b16 a[110:111], v19 offset:16256
    v_mfma_f32_16x16x32_bf16 v[220:223], a[44:47], a[24:27], 0
    ds_read_b64_tr_b16 a[112:113], v20 offset:14496
    v_mfma_f32_16x16x32_bf16 v[244:247], a[44:47], a[28:31], 0
    v_mfma_f32_16x16x32_bf16 v[80:83], a[48:51], a[0:3], 0
    ds_read_b64_tr_b16 a[114:115], v20 offset:16288
    v_mfma_f32_16x16x32_bf16 v[104:107], a[48:51], a[4:7], 0
    v_mfma_f32_16x16x32_bf16 v[128:131], a[48:51], a[8:11], 0
    ds_read_b64_tr_b16 a[116:117], v21 offset:14336
    v_mfma_f32_16x16x32_bf16 v[152:155], a[48:51], a[12:15], 0
    v_mfma_f32_16x16x32_bf16 v[176:179], a[48:51], a[16:19], 0
    ds_read_b64_tr_b16 a[118:119], v21 offset:16128
    v_mfma_f32_16x16x32_bf16 v[200:203], a[48:51], a[20:23], 0
    v_mfma_f32_16x16x32_bf16 v[224:227], a[48:51], a[24:27], 0
    v_mfma_f32_16x16x32_bf16 v[248:251], a[48:51], a[28:31], 0
    v_mfma_f32_16x16x32_bf16 v[84:87], a[52:55], a[0:3], 0
    s_waitcnt vmcnt(1) lgkmcnt(0)
    s_barrier
    v_mfma_f32_16x16x32_bf16 v[108:111], a[52:55], a[4:7], 0
    s_mov_b32 m0, s24
    v_mfma_f32_16x16x32_bf16 v[132:135], a[52:55], a[8:11], 0
    v_mfma_f32_16x16x32_bf16 v[156:159], a[52:55], a[12:15], 0
    v_mfma_f32_16x16x32_bf16 v[180:183], a[52:55], a[16:19], 0
    buffer_load_dwordx4 v2, s[8:11], s40 offen lds
    v_mfma_f32_16x16x32_bf16 v[204:207], a[52:55], a[20:23], 0
    v_mfma_f32_16x16x32_bf16 v[228:231], a[52:55], a[24:27], 0
    v_mfma_f32_16x16x32_bf16 v[252:255], a[52:55], a[28:31], 0
    v_mfma_f32_16x16x32_bf16 a[128:131], a[56:59], a[0:3], 0
    buffer_load_dwordx4 v3, s[8:11], s40 offen offset:1024 lds
    v_mfma_f32_16x16x32_bf16 a[132:135], a[56:59], a[4:7], 0
    v_mfma_f32_16x16x32_bf16 a[136:139], a[56:59], a[8:11], 0
    v_mfma_f32_16x16x32_bf16 a[140:143], a[56:59], a[12:15], 0
    buffer_load_dwordx4 v4, s[8:11], s40 offen offset:2048 lds
    v_mfma_f32_16x16x32_bf16 a[144:147], a[56:59], a[16:19], 0
    v_mfma_f32_16x16x32_bf16 a[148:151], a[56:59], a[20:23], 0
    v_mfma_f32_16x16x32_bf16 a[152:155], a[56:59], a[24:27], 0
    v_mfma_f32_16x16x32_bf16 a[156:159], a[56:59], a[28:31], 0
    buffer_load_dwordx4 v5, s[8:11], s40 offen offset:3072 lds
    v_mfma_f32_16x16x32_bf16 v[64:67], a[92:95], a[60:63], v[64:67]
    ds_read_b64_tr_b16 a[32:33], v19 offset:28672
    v_mfma_f32_16x16x32_bf16 v[88:91], a[92:95], a[64:67], v[88:91]
    ds_read_b64_tr_b16 a[34:35], v19 offset:30464
    v_mfma_f32_16x16x32_bf16 v[112:115], a[92:95], a[68:71], v[112:115]
    s_mov_b32 m0, s25
    v_mfma_f32_16x16x32_bf16 v[136:139], a[92:95], a[72:75], v[136:139]
    ds_read_b128 a[0:3], v17 offset:32768
    v_mfma_f32_16x16x32_bf16 v[160:163], a[92:95], a[76:79], v[160:163]
    v_mfma_f32_16x16x32_bf16 v[184:187], a[92:95], a[80:83], v[184:187]
    ds_read_b128 a[4:7], v17 offset:34816
    v_mfma_f32_16x16x32_bf16 v[208:211], a[92:95], a[84:87], v[208:211]
    buffer_load_dwordx4 v6, s[8:11], s40 offen lds
    v_mfma_f32_16x16x32_bf16 v[232:235], a[92:95], a[88:91], v[232:235]
    ds_read_b128 a[8:11], v17 offset:36864
    v_mfma_f32_16x16x32_bf16 v[68:71], a[96:99], a[60:63], v[68:71]
    v_mfma_f32_16x16x32_bf16 v[92:95], a[96:99], a[64:67], v[92:95]
    buffer_load_dwordx4 v7, s[8:11], s40 offen offset:1024 lds
    ds_read_b128 a[12:15], v17 offset:38912
    v_mfma_f32_16x16x32_bf16 v[116:119], a[96:99], a[68:71], v[116:119]
    v_mfma_f32_16x16x32_bf16 v[140:143], a[96:99], a[72:75], v[140:143]
    ds_read_b128 a[16:19], v17 offset:40960
    v_mfma_f32_16x16x32_bf16 v[164:167], a[96:99], a[76:79], v[164:167]
    v_mfma_f32_16x16x32_bf16 v[188:191], a[96:99], a[80:83], v[188:191]
    buffer_load_dwordx4 v8, s[8:11], s40 offen offset:2048 lds
    ds_read_b128 a[20:23], v17 offset:43008
    v_mfma_f32_16x16x32_bf16 v[212:215], a[96:99], a[84:87], v[212:215]
    v_mfma_f32_16x16x32_bf16 v[236:239], a[96:99], a[88:91], v[236:239]
    ds_read_b128 a[24:27], v17 offset:45056
    v_mfma_f32_16x16x32_bf16 v[72:75], a[100:103], a[60:63], v[72:75]
    buffer_load_dwordx4 v9, s[8:11], s40 offen offset:3072 lds
    v_mfma_f32_16x16x32_bf16 v[96:99], a[100:103], a[64:67], v[96:99]
    ds_read_b128 a[28:31], v17 offset:47104
    v_mfma_f32_16x16x32_bf16 v[120:123], a[100:103], a[68:71], v[120:123]
    v_mfma_f32_16x16x32_bf16 v[144:147], a[100:103], a[72:75], v[144:147]
    ds_read_b64_tr_b16 a[36:37], v20 offset:28704
    v_mfma_f32_16x16x32_bf16 v[168:171], a[100:103], a[76:79], v[168:171]
    s_mov_b32 m0, s26
    ds_read_b64_tr_b16 a[38:39], v20 offset:30496
    v_mfma_f32_16x16x32_bf16 v[192:195], a[100:103], a[80:83], v[192:195]
    v_mfma_f32_16x16x32_bf16 v[216:219], a[100:103], a[84:87], v[216:219]
    ds_read_b64_tr_b16 a[40:41], v19 offset:28736
    v_mfma_f32_16x16x32_bf16 v[240:243], a[100:103], a[88:91], v[240:243]
    buffer_load_dwordx4 v10, s[12:15], s41 offen lds
    v_mfma_f32_16x16x32_bf16 v[76:79], a[104:107], a[60:63], v[76:79]
    ds_read_b64_tr_b16 a[42:43], v19 offset:30528
    v_mfma_f32_16x16x32_bf16 v[100:103], a[104:107], a[64:67], v[100:103]
    v_mfma_f32_16x16x32_bf16 v[124:127], a[104:107], a[68:71], v[124:127]
    ds_read_b64_tr_b16 a[44:45], v20 offset:28768
    v_mfma_f32_16x16x32_bf16 v[148:151], a[104:107], a[72:75], v[148:151]
    buffer_load_dwordx4 v11, s[12:15], s41 offen offset:1024 lds
    v_mfma_f32_16x16x32_bf16 v[172:175], a[104:107], a[76:79], v[172:175]
    ds_read_b64_tr_b16 a[46:47], v20 offset:30560
    v_mfma_f32_16x16x32_bf16 v[196:199], a[104:107], a[80:83], v[196:199]
    v_mfma_f32_16x16x32_bf16 v[220:223], a[104:107], a[84:87], v[220:223]
    buffer_load_dwordx4 v12, s[12:15], s41 offen offset:2048 lds
    ds_read_b64_tr_b16 a[48:49], v19 offset:28800
    v_mfma_f32_16x16x32_bf16 v[244:247], a[104:107], a[88:91], v[244:247]
    v_mfma_f32_16x16x32_bf16 v[80:83], a[108:111], a[60:63], v[80:83]
    ds_read_b64_tr_b16 a[50:51], v19 offset:30592
    v_mfma_f32_16x16x32_bf16 v[104:107], a[108:111], a[64:67], v[104:107]
    v_mfma_f32_16x16x32_bf16 v[128:131], a[108:111], a[68:71], v[128:131]
    buffer_load_dwordx4 v13, s[12:15], s41 offen offset:3072 lds
    ds_read_b64_tr_b16 a[52:53], v20 offset:28832
    v_mfma_f32_16x16x32_bf16 v[152:155], a[108:111], a[72:75], v[152:155]
    v_mfma_f32_16x16x32_bf16 v[176:179], a[108:111], a[76:79], v[176:179]
    ds_read_b64_tr_b16 a[54:55], v20 offset:30624
    v_mfma_f32_16x16x32_bf16 v[200:203], a[108:111], a[80:83], v[200:203]
    s_mov_b32 m0, s27
    v_mfma_f32_16x16x32_bf16 v[224:227], a[108:111], a[84:87], v[224:227]
    ds_read_b64_tr_b16 a[56:57], v21 offset:28672
    v_mfma_f32_16x16x32_bf16 v[248:251], a[108:111], a[88:91], v[248:251]
    v_mfma_f32_16x16x32_bf16 v[84:87], a[112:115], a[60:63], v[84:87]
    ds_read_b64_tr_b16 a[58:59], v21 offset:30464
    v_mfma_f32_16x16x32_bf16 v[108:111], a[112:115], a[64:67], v[108:111]
    buffer_load_dwordx4 v14, s[12:15], s41 offen lds
    v_mfma_f32_16x16x32_bf16 v[132:135], a[112:115], a[68:71], v[132:135]
    v_mfma_f32_16x16x32_bf16 v[156:159], a[112:115], a[72:75], v[156:159]
    v_mfma_f32_16x16x32_bf16 v[180:183], a[112:115], a[76:79], v[180:183]
    buffer_load_dwordx4 v15, s[12:15], s41 offen offset:1024 lds
    v_mfma_f32_16x16x32_bf16 v[204:207], a[112:115], a[80:83], v[204:207]
    v_mfma_f32_16x16x32_bf16 v[228:231], a[112:115], a[84:87], v[228:231]
    v_mfma_f32_16x16x32_bf16 v[252:255], a[112:115], a[88:91], v[252:255]
    v_mfma_f32_16x16x32_bf16 a[128:131], a[116:119], a[60:63], a[128:131]
    buffer_load_dwordx4 v16, s[12:15], s41 offen offset:2048 lds
    v_mfma_f32_16x16x32_bf16 a[132:135], a[116:119], a[64:67], a[132:135]
    s_add_u32 s40, s40, 128
    s_add_u32 s41, s41, 458752
    v_mfma_f32_16x16x32_bf16 a[136:139], a[116:119], a[68:71], a[136:139]
    buffer_load_dword a251, v22, s[20:23], s42 offen
    s_add_u32 s42, s42, s43
    v_mfma_f32_16x16x32_bf16 a[140:143], a[116:119], a[72:75], a[140:143]
    v_mfma_f32_16x16x32_bf16 a[144:147], a[116:119], a[76:79], a[144:147]
    v_mfma_f32_16x16x32_bf16 a[148:151], a[116:119], a[80:83], a[148:151]
    v_mfma_f32_16x16x32_bf16 a[152:155], a[116:119], a[84:87], a[152:155]
    v_mfma_f32_16x16x32_bf16 a[156:159], a[116:119], a[88:91], a[156:159]
    s_waitcnt lgkmcnt(0)
    v_mfma_f32_16x16x32_bf16 v[64:67], a[32:35], a[0:3], v[64:67]
    ds_read_b64_tr_b16 a[92:93], v19 offset:43008
    v_mfma_f32_16x16x32_bf16 v[88:91], a[32:35], a[4:7], v[88:91]
    ds_read_b64_tr_b16 a[94:95], v19 offset:44800
    v_mfma_f32_16x16x32_bf16 v[112:115], a[32:35], a[8:11], v[112:115]
    v_mfma_f32_16x16x32_bf16 v[136:139], a[32:35], a[12:15], v[136:139]
    ds_read_b128 a[60:63], v18 offset:32768
    v_mfma_f32_16x16x32_bf16 v[160:163], a[32:35], a[16:19], v[160:163]
    v_mfma_f32_16x16x32_bf16 v[184:187], a[32:35], a[20:23], v[184:187]
    ds_read_b128 a[64:67], v18 offset:34816
    v_mfma_f32_16x16x32_bf16 v[208:211], a[32:35], a[24:27], v[208:211]
    ds_read_b128 a[68:71], v18 offset:36864
    v_mfma_f32_16x16x32_bf16 v[232:235], a[32:35], a[28:31], v[232:235]
    v_mfma_f32_16x16x32_bf16 v[68:71], a[36:39], a[0:3], v[68:71]
    ds_read_b128 a[72:75], v18 offset:38912
    v_mfma_f32_16x16x32_bf16 v[92:95], a[36:39], a[4:7], v[92:95]
    v_mfma_f32_16x16x32_bf16 v[116:119], a[36:39], a[8:11], v[116:119]
    ds_read_b128 a[76:79], v18 offset:40960
    v_mfma_f32_16x16x32_bf16 v[140:143], a[36:39], a[12:15], v[140:143]
    v_mfma_f32_16x16x32_bf16 v[164:167], a[36:39], a[16:19], v[164:167]
    ds_read_b128 a[80:83], v18 offset:43008
    v_mfma_f32_16x16x32_bf16 v[188:191], a[36:39], a[20:23], v[188:191]
    ds_read_b128 a[84:87], v18 offset:45056
    v_mfma_f32_16x16x32_bf16 v[212:215], a[36:39], a[24:27], v[212:215]
    v_mfma_f32_16x16x32_bf16 v[236:239], a[36:39], a[28:31], v[236:239]
    ds_read_b128 a[88:91], v18 offset:47104
    v_mfma_f32_16x16x32_bf16 v[72:75], a[40:43], a[0:3], v[72:75]
    v_mfma_f32_16x16x32_bf16 v[96:99], a[40:43], a[4:7], v[96:99]
    ds_read_b64_tr_b16 a[96:97], v20 offset:43040
    v_mfma_f32_16x16x32_bf16 v[120:123], a[40:43], a[8:11], v[120:123]
    ds_read_b64_tr_b16 a[98:99], v20 offset:44832
    v_mfma_f32_16x16x32_bf16 v[144:147], a[40:43], a[12:15], v[144:147]
    v_mfma_f32_16x16x32_bf16 v[168:171], a[40:43], a[16:19], v[168:171]
    ds_read_b64_tr_b16 a[100:101], v19 offset:43072
    v_mfma_f32_16x16x32_bf16 v[192:195], a[40:43], a[20:23], v[192:195]
    v_mfma_f32_16x16x32_bf16 v[216:219], a[40:43], a[24:27], v[216:219]
    ds_read_b64_tr_b16 a[102:103], v19 offset:44864
    v_mfma_f32_16x16x32_bf16 v[240:243], a[40:43], a[28:31], v[240:243]
    v_mfma_f32_16x16x32_bf16 v[76:79], a[44:47], a[0:3], v[76:79]
    ds_read_b64_tr_b16 a[104:105], v20 offset:43104
    v_mfma_f32_16x16x32_bf16 v[100:103], a[44:47], a[4:7], v[100:103]
    ds_read_b64_tr_b16 a[106:107], v20 offset:44896
    v_mfma_f32_16x16x32_bf16 v[124:127], a[44:47], a[8:11], v[124:127]
    v_mfma_f32_16x16x32_bf16 v[148:151], a[44:47], a[12:15], v[148:151]
    ds_read_b64_tr_b16 a[108:109], v19 offset:43136
    v_mfma_f32_16x16x32_bf16 v[172:175], a[44:47], a[16:19], v[172:175]
    v_mfma_f32_16x16x32_bf16 v[196:199], a[44:47], a[20:23], v[196:199]
    ds_read_b64_tr_b16 a[110:111], v19 offset:44928
    v_mfma_f32_16x16x32_bf16 v[220:223], a[44:47], a[24:27], v[220:223]
    ds_read_b64_tr_b16 a[112:113], v20 offset:43168
    v_mfma_f32_16x16x32_bf16 v[244:247], a[44:47], a[28:31], v[244:247]
    v_mfma_f32_16x16x32_bf16 v[80:83], a[48:51], a[0:3], v[80:83]
    ds_read_b64_tr_b16 a[114:115], v20 offset:44960
    v_mfma_f32_16x16x32_bf16 v[104:107], a[48:51], a[4:7], v[104:107]
    v_mfma_f32_16x16x32_bf16 v[128:131], a[48:51], a[8:11], v[128:131]
    ds_read_b64_tr_b16 a[116:117], v21 offset:43008
    v_mfma_f32_16x16x32_bf16 v[152:155], a[48:51], a[12:15], v[152:155]
    v_mfma_f32_16x16x32_bf16 v[176:179], a[48:51], a[16:19], v[176:179]
    ds_read_b64_tr_b16 a[118:119], v21 offset:44800
    v_mfma_f32_16x16x32_bf16 v[200:203], a[48:51], a[20:23], v[200:203]
    v_mfma_f32_16x16x32_bf16 v[224:227], a[48:51], a[24:27], v[224:227]
    v_mfma_f32_16x16x32_bf16 v[248:251], a[48:51], a[28:31], v[248:251]
    v_mfma_f32_16x16x32_bf16 v[84:87], a[52:55], a[0:3], v[84:87]
    s_waitcnt vmcnt(1) lgkmcnt(0)
    s_barrier
    v_mfma_f32_16x16x32_bf16 v[108:111], a[52:55], a[4:7], v[108:111]
    s_mov_b32 m0, s28
    v_mfma_f32_16x16x32_bf16 v[132:135], a[52:55], a[8:11], v[132:135]
    v_mfma_f32_16x16x32_bf16 v[156:159], a[52:55], a[12:15], v[156:159]
    v_mfma_f32_16x16x32_bf16 v[180:183], a[52:55], a[16:19], v[180:183]
    buffer_load_dwordx4 v2, s[8:11], s40 offen lds
    v_mfma_f32_16x16x32_bf16 v[204:207], a[52:55], a[20:23], v[204:207]
    v_mfma_f32_16x16x32_bf16 v[228:231], a[52:55], a[24:27], v[228:231]
    v_mfma_f32_16x16x32_bf16 v[252:255], a[52:55], a[28:31], v[252:255]
    v_mfma_f32_16x16x32_bf16 a[128:131], a[56:59], a[0:3], a[128:131]
    buffer_load_dwordx4 v3, s[8:11], s40 offen offset:1024 lds
    v_mfma_f32_16x16x32_bf16 a[132:135], a[56:59], a[4:7], a[132:135]
    v_mfma_f32_16x16x32_bf16 a[136:139], a[56:59], a[8:11], a[136:139]
    v_mfma_f32_16x16x32_bf16 a[140:143], a[56:59], a[12:15], a[140:143]
    buffer_load_dwordx4 v4, s[8:11], s40 offen offset:2048 lds
    v_mfma_f32_16x16x32_bf16 a[144:147], a[56:59], a[16:19], a[144:147]
    v_mfma_f32_16x16x32_bf16 a[148:151], a[56:59], a[20:23], a[148:151]
    v_mfma_f32_16x16x32_bf16 a[152:155], a[56:59], a[24:27], a[152:155]
    v_mfma_f32_16x16x32_bf16 a[156:159], a[56:59], a[28:31], a[156:159]
    buffer_load_dwordx4 v5, s[8:11], s40 offen offset:3072 lds
    v_mfma_f32_16x16x32_bf16 v[64:67], a[92:95], a[60:63], v[64:67]
    ds_read_b64_tr_b16 a[32:33], v19 offset:0
    v_mfma_f32_16x16x32_bf16 v[88:91], a[92:95], a[64:67], v[88:91]
    ds_read_b64_tr_b16 a[34:35], v19 offset:1792
    v_mfma_f32_16x16x32_bf16 v[112:115], a[92:95], a[68:71], v[112:115]
    s_mov_b32 m0, s29
    v_mfma_f32_16x16x32_bf16 v[136:139], a[92:95], a[72:75], v[136:139]
    ds_read_b128 a[0:3], v17 offset:0
    v_mfma_f32_16x16x32_bf16 v[160:163], a[92:95], a[76:79], v[160:163]
    v_mfma_f32_16x16x32_bf16 v[184:187], a[92:95], a[80:83], v[184:187]
    ds_read_b128 a[4:7], v17 offset:2048
    v_mfma_f32_16x16x32_bf16 v[208:211], a[92:95], a[84:87], v[208:211]
    buffer_load_dwordx4 v6, s[8:11], s40 offen lds
    v_mfma_f32_16x16x32_bf16 v[232:235], a[92:95], a[88:91], v[232:235]
    ds_read_b128 a[8:11], v17 offset:4096
    v_mfma_f32_16x16x32_bf16 v[68:71], a[96:99], a[60:63], v[68:71]
    v_mfma_f32_16x16x32_bf16 v[92:95], a[96:99], a[64:67], v[92:95]
    buffer_load_dwordx4 v7, s[8:11], s40 offen offset:1024 lds
    ds_read_b128 a[12:15], v17 offset:6144
    v_mfma_f32_16x16x32_bf16 v[116:119], a[96:99], a[68:71], v[116:119]
    v_mfma_f32_16x16x32_bf16 v[140:143], a[96:99], a[72:75], v[140:143]
    ds_read_b128 a[16:19], v17 offset:8192
    v_mfma_f32_16x16x32_bf16 v[164:167], a[96:99], a[76:79], v[164:167]
    v_mfma_f32_16x16x32_bf16 v[188:191], a[96:99], a[80:83], v[188:191]
    buffer_load_dwordx4 v8, s[8:11], s40 offen offset:2048 lds
    ds_read_b128 a[20:23], v17 offset:10240
    v_mfma_f32_16x16x32_bf16 v[212:215], a[96:99], a[84:87], v[212:215]
    v_mfma_f32_16x16x32_bf16 v[236:239], a[96:99], a[88:91], v[236:239]
    ds_read_b128 a[24:27], v17 offset:12288
    v_mfma_f32_16x16x32_bf16 v[72:75], a[100:103], a[60:63], v[72:75]
    buffer_load_dwordx4 v9, s[8:11], s40 offen offset:3072 lds
    v_mfma_f32_16x16x32_bf16 v[96:99], a[100:103], a[64:67], v[96:99]
    ds_read_b128 a[28:31], v17 offset:14336
    v_mfma_f32_16x16x32_bf16 v[120:123], a[100:103], a[68:71], v[120:123]
    v_mfma_f32_16x16x32_bf16 v[144:147], a[100:103], a[72:75], v[144:147]
    ds_read_b64_tr_b16 a[36:37], v20 offset:32
    v_mfma_f32_16x16x32_bf16 v[168:171], a[100:103], a[76:79], v[168:171]
    s_mov_b32 m0, s30
    ds_read_b64_tr_b16 a[38:39], v20 offset:1824
    v_mfma_f32_16x16x32_bf16 v[192:195], a[100:103], a[80:83], v[192:195]
    v_mfma_f32_16x16x32_bf16 v[216:219], a[100:103], a[84:87], v[216:219]
    ds_read_b64_tr_b16 a[40:41], v19 offset:64
    v_mfma_f32_16x16x32_bf16 v[240:243], a[100:103], a[88:91], v[240:243]
    buffer_load_dwordx4 v10, s[12:15], s41 offen lds
    v_mfma_f32_16x16x32_bf16 v[76:79], a[104:107], a[60:63], v[76:79]
    ds_read_b64_tr_b16 a[42:43], v19 offset:1856
    v_mfma_f32_16x16x32_bf16 v[100:103], a[104:107], a[64:67], v[100:103]
    v_mfma_f32_16x16x32_bf16 v[124:127], a[104:107], a[68:71], v[124:127]
    ds_read_b64_tr_b16 a[44:45], v20 offset:96
    v_mfma_f32_16x16x32_bf16 v[148:151], a[104:107], a[72:75], v[148:151]
    buffer_load_dwordx4 v11, s[12:15], s41 offen offset:1024 lds
    v_mfma_f32_16x16x32_bf16 v[172:175], a[104:107], a[76:79], v[172:175]
    ds_read_b64_tr_b16 a[46:47], v20 offset:1888
    v_mfma_f32_16x16x32_bf16 v[196:199], a[104:107], a[80:83], v[196:199]
    v_mfma_f32_16x16x32_bf16 v[220:223], a[104:107], a[84:87], v[220:223]
    buffer_load_dwordx4 v12, s[12:15], s41 offen offset:2048 lds
    ds_read_b64_tr_b16 a[48:49], v19 offset:128
    v_mfma_f32_16x16x32_bf16 v[244:247], a[104:107], a[88:91], v[244:247]
    v_mfma_f32_16x16x32_bf16 v[80:83], a[108:111], a[60:63], v[80:83]
    ds_read_b64_tr_b16 a[50:51], v19 offset:1920
    v_mfma_f32_16x16x32_bf16 v[104:107], a[108:111], a[64:67], v[104:107]
    v_mfma_f32_16x16x32_bf16 v[128:131], a[108:111], a[68:71], v[128:131]
    buffer_load_dwordx4 v13, s[12:15], s41 offen offset:3072 lds
    ds_read_b64_tr_b16 a[52:53], v20 offset:160
    v_mfma_f32_16x16x32_bf16 v[152:155], a[108:111], a[72:75], v[152:155]
    v_mfma_f32_16x16x32_bf16 v[176:179], a[108:111], a[76:79], v[176:179]
    ds_read_b64_tr_b16 a[54:55], v20 offset:1952
    v_mfma_f32_16x16x32_bf16 v[200:203], a[108:111], a[80:83], v[200:203]
    s_mov_b32 m0, s31
    v_mfma_f32_16x16x32_bf16 v[224:227], a[108:111], a[84:87], v[224:227]
    ds_read_b64_tr_b16 a[56:57], v21 offset:0
    v_mfma_f32_16x16x32_bf16 v[248:251], a[108:111], a[88:91], v[248:251]
    v_mfma_f32_16x16x32_bf16 v[84:87], a[112:115], a[60:63], v[84:87]
    ds_read_b64_tr_b16 a[58:59], v21 offset:1792
    v_mfma_f32_16x16x32_bf16 v[108:111], a[112:115], a[64:67], v[108:111]
    buffer_load_dwordx4 v14, s[12:15], s41 offen lds
    v_mfma_f32_16x16x32_bf16 v[132:135], a[112:115], a[68:71], v[132:135]
    v_mfma_f32_16x16x32_bf16 v[156:159], a[112:115], a[72:75], v[156:159]
    v_mfma_f32_16x16x32_bf16 v[180:183], a[112:115], a[76:79], v[180:183]
    buffer_load_dwordx4 v15, s[12:15], s41 offen offset:1024 lds
    v_mfma_f32_16x16x32_bf16 v[204:207], a[112:115], a[80:83], v[204:207]
    v_mfma_f32_16x16x32_bf16 v[228:231], a[112:115], a[84:87], v[228:231]
    v_mfma_f32_16x16x32_bf16 v[252:255], a[112:115], a[88:91], v[252:255]
    v_mfma_f32_16x16x32_bf16 a[128:131], a[116:119], a[60:63], a[128:131]
    buffer_load_dwordx4 v16, s[12:15], s41 offen offset:2048 lds
    v_mfma_f32_16x16x32_bf16 a[132:135], a[116:119], a[64:67], a[132:135]
    s_add_u32 s40, s40, 128
    s_add_u32 s41, s41, 458752
    v_mfma_f32_16x16x32_bf16 a[136:139], a[116:119], a[68:71], a[136:139]
    buffer_load_dword a251, v22, s[20:23], s42 offen
    s_add_u32 s42, s42, s43
    v_mfma_f32_16x16x32_bf16 a[140:143], a[116:119], a[72:75], a[140:143]
    v_mfma_f32_16x16x32_bf16 a[144:147], a[116:119], a[76:79], a[144:147]
    v_mfma_f32_16x16x32_bf16 a[148:151], a[116:119], a[80:83], a[148:151]
    v_mfma_f32_16x16x32_bf16 a[152:155], a[116:119], a[84:87], a[152:155]
    v_mfma_f32_16x16x32_bf16 a[156:159], a[116:119], a[88:91], a[156:159]
    s_mov_b32 s37, 6
.p2align 6
gated_mix__linear_kernel_hedgehog__mixer_channel_mlp__prompt_kernel_m_loop:
    s_waitcnt lgkmcnt(0)
    v_mfma_f32_16x16x32_bf16 v[64:67], a[32:35], a[0:3], v[64:67]
    ds_read_b64_tr_b16 a[92:93], v19 offset:14336
    v_mfma_f32_16x16x32_bf16 v[88:91], a[32:35], a[4:7], v[88:91]
    ds_read_b64_tr_b16 a[94:95], v19 offset:16128
    buffer_load_dwordx4 v[24:27], v62, s[56:59], s67 offen
    v_mfma_f32_16x16x32_bf16 v[112:115], a[32:35], a[8:11], v[112:115]
    s_add_u32 s67, s67, 14336
    v_mfma_f32_16x16x32_bf16 v[136:139], a[32:35], a[12:15], v[136:139]
    ds_read_b128 a[60:63], v18 offset:0
    buffer_load_dwordx4 v[28:31], v62, s[56:59], s67 offen
    v_mfma_f32_16x16x32_bf16 v[160:163], a[32:35], a[16:19], v[160:163]
    s_add_u32 s67, s67, 14336
    v_mfma_f32_16x16x32_bf16 v[184:187], a[32:35], a[20:23], v[184:187]
    ds_read_b128 a[64:67], v18 offset:2048
    buffer_load_dwordx4 v[32:35], v62, s[56:59], s67 offen
    v_mfma_f32_16x16x32_bf16 v[208:211], a[32:35], a[24:27], v[208:211]
    ds_read_b128 a[68:71], v18 offset:4096
    s_add_u32 s67, s67, 14336
    v_mfma_f32_16x16x32_bf16 v[232:235], a[32:35], a[28:31], v[232:235]
    v_mfma_f32_16x16x32_bf16 v[68:71], a[36:39], a[0:3], v[68:71]
    ds_read_b128 a[72:75], v18 offset:6144
    buffer_load_dwordx4 v[36:39], v62, s[56:59], s67 offen
    v_mfma_f32_16x16x32_bf16 v[92:95], a[36:39], a[4:7], v[92:95]
    s_add_u32 s67, s67, 14336
    v_mfma_f32_16x16x32_bf16 v[116:119], a[36:39], a[8:11], v[116:119]
    ds_read_b128 a[76:79], v18 offset:8192
    buffer_load_dwordx4 v[40:43], v62, s[56:59], s67 offen
    v_mfma_f32_16x16x32_bf16 v[140:143], a[36:39], a[12:15], v[140:143]
    s_add_u32 s67, s67, 14336
    v_mfma_f32_16x16x32_bf16 v[164:167], a[36:39], a[16:19], v[164:167]
    ds_read_b128 a[80:83], v18 offset:10240
    buffer_load_dwordx4 v[44:47], v62, s[56:59], s67 offen
    v_mfma_f32_16x16x32_bf16 v[188:191], a[36:39], a[20:23], v[188:191]
    ds_read_b128 a[84:87], v18 offset:12288
    v_mfma_f32_16x16x32_bf16 v[212:215], a[36:39], a[24:27], v[212:215]
    s_add_u32 s67, s67, 14336
    v_mfma_f32_16x16x32_bf16 v[236:239], a[36:39], a[28:31], v[236:239]
    ds_read_b128 a[88:91], v18 offset:14336
    v_mfma_f32_16x16x32_bf16 v[72:75], a[40:43], a[0:3], v[72:75]
    v_mfma_f32_16x16x32_bf16 v[96:99], a[40:43], a[4:7], v[96:99]
    ds_read_b64_tr_b16 a[96:97], v20 offset:14368
    v_mfma_f32_16x16x32_bf16 v[120:123], a[40:43], a[8:11], v[120:123]
    ds_read_b64_tr_b16 a[98:99], v20 offset:16160
    v_mfma_f32_16x16x32_bf16 v[144:147], a[40:43], a[12:15], v[144:147]
    v_mfma_f32_16x16x32_bf16 v[168:171], a[40:43], a[16:19], v[168:171]
    ds_read_b64_tr_b16 a[100:101], v19 offset:14400
    v_mfma_f32_16x16x32_bf16 v[192:195], a[40:43], a[20:23], v[192:195]
    v_mfma_f32_16x16x32_bf16 v[216:219], a[40:43], a[24:27], v[216:219]
    ds_read_b64_tr_b16 a[102:103], v19 offset:16192
    v_mfma_f32_16x16x32_bf16 v[240:243], a[40:43], a[28:31], v[240:243]
    v_mfma_f32_16x16x32_bf16 v[76:79], a[44:47], a[0:3], v[76:79]
    ds_read_b64_tr_b16 a[104:105], v20 offset:14432
    v_mfma_f32_16x16x32_bf16 v[100:103], a[44:47], a[4:7], v[100:103]
    ds_read_b64_tr_b16 a[106:107], v20 offset:16224
    v_mfma_f32_16x16x32_bf16 v[124:127], a[44:47], a[8:11], v[124:127]
    v_mfma_f32_16x16x32_bf16 v[148:151], a[44:47], a[12:15], v[148:151]
    ds_read_b64_tr_b16 a[108:109], v19 offset:14464
    v_mfma_f32_16x16x32_bf16 v[172:175], a[44:47], a[16:19], v[172:175]
    v_mfma_f32_16x16x32_bf16 v[196:199], a[44:47], a[20:23], v[196:199]
    ds_read_b64_tr_b16 a[110:111], v19 offset:16256
    v_mfma_f32_16x16x32_bf16 v[220:223], a[44:47], a[24:27], v[220:223]
    ds_read_b64_tr_b16 a[112:113], v20 offset:14496
    v_mfma_f32_16x16x32_bf16 v[244:247], a[44:47], a[28:31], v[244:247]
    v_mfma_f32_16x16x32_bf16 v[80:83], a[48:51], a[0:3], v[80:83]
    ds_read_b64_tr_b16 a[114:115], v20 offset:16288
    v_mfma_f32_16x16x32_bf16 v[104:107], a[48:51], a[4:7], v[104:107]
    v_mfma_f32_16x16x32_bf16 v[128:131], a[48:51], a[8:11], v[128:131]
    ds_read_b64_tr_b16 a[116:117], v21 offset:14336
    v_mfma_f32_16x16x32_bf16 v[152:155], a[48:51], a[12:15], v[152:155]
    v_mfma_f32_16x16x32_bf16 v[176:179], a[48:51], a[16:19], v[176:179]
    ds_read_b64_tr_b16 a[118:119], v21 offset:16128
    v_mfma_f32_16x16x32_bf16 v[200:203], a[48:51], a[20:23], v[200:203]
    v_mfma_f32_16x16x32_bf16 v[224:227], a[48:51], a[24:27], v[224:227]
    v_mfma_f32_16x16x32_bf16 v[248:251], a[48:51], a[28:31], v[248:251]
    v_mfma_f32_16x16x32_bf16 v[84:87], a[52:55], a[0:3], v[84:87]
    s_waitcnt vmcnt(7) lgkmcnt(0)
    s_barrier
    v_mfma_f32_16x16x32_bf16 v[108:111], a[52:55], a[4:7], v[108:111]
    s_mov_b32 m0, s24
    v_mfma_f32_16x16x32_bf16 v[132:135], a[52:55], a[8:11], v[132:135]
    v_mfma_f32_16x16x32_bf16 v[156:159], a[52:55], a[12:15], v[156:159]
    v_mfma_f32_16x16x32_bf16 v[180:183], a[52:55], a[16:19], v[180:183]
    buffer_load_dwordx4 v2, s[8:11], s40 offen lds
    v_mfma_f32_16x16x32_bf16 v[204:207], a[52:55], a[20:23], v[204:207]
    v_mfma_f32_16x16x32_bf16 v[228:231], a[52:55], a[24:27], v[228:231]
    v_mfma_f32_16x16x32_bf16 v[252:255], a[52:55], a[28:31], v[252:255]
    v_mfma_f32_16x16x32_bf16 a[128:131], a[56:59], a[0:3], a[128:131]
    buffer_load_dwordx4 v3, s[8:11], s40 offen offset:1024 lds
    v_mfma_f32_16x16x32_bf16 a[132:135], a[56:59], a[4:7], a[132:135]
    v_mfma_f32_16x16x32_bf16 a[136:139], a[56:59], a[8:11], a[136:139]
    v_mfma_f32_16x16x32_bf16 a[140:143], a[56:59], a[12:15], a[140:143]
    buffer_load_dwordx4 v4, s[8:11], s40 offen offset:2048 lds
    v_mfma_f32_16x16x32_bf16 a[144:147], a[56:59], a[16:19], a[144:147]
    v_mfma_f32_16x16x32_bf16 a[148:151], a[56:59], a[20:23], a[148:151]
    v_mfma_f32_16x16x32_bf16 a[152:155], a[56:59], a[24:27], a[152:155]
    v_mfma_f32_16x16x32_bf16 a[156:159], a[56:59], a[28:31], a[156:159]
    buffer_load_dwordx4 v5, s[8:11], s40 offen offset:3072 lds
    v_mfma_f32_16x16x32_bf16 v[64:67], a[92:95], a[60:63], v[64:67]
    ds_read_b64_tr_b16 a[32:33], v19 offset:28672
    v_mfma_f32_16x16x32_bf16 v[88:91], a[92:95], a[64:67], v[88:91]
    ds_read_b64_tr_b16 a[34:35], v19 offset:30464
    v_mfma_f32_16x16x32_bf16 v[112:115], a[92:95], a[68:71], v[112:115]
    s_mov_b32 m0, s25
    v_mfma_f32_16x16x32_bf16 v[136:139], a[92:95], a[72:75], v[136:139]
    ds_read_b128 a[0:3], v17 offset:32768
    v_mfma_f32_16x16x32_bf16 v[160:163], a[92:95], a[76:79], v[160:163]
    v_mfma_f32_16x16x32_bf16 v[184:187], a[92:95], a[80:83], v[184:187]
    ds_read_b128 a[4:7], v17 offset:34816
    v_mfma_f32_16x16x32_bf16 v[208:211], a[92:95], a[84:87], v[208:211]
    buffer_load_dwordx4 v6, s[8:11], s40 offen lds
    v_mfma_f32_16x16x32_bf16 v[232:235], a[92:95], a[88:91], v[232:235]
    ds_read_b128 a[8:11], v17 offset:36864
    v_mfma_f32_16x16x32_bf16 v[68:71], a[96:99], a[60:63], v[68:71]
    v_mfma_f32_16x16x32_bf16 v[92:95], a[96:99], a[64:67], v[92:95]
    buffer_load_dwordx4 v7, s[8:11], s40 offen offset:1024 lds
    ds_read_b128 a[12:15], v17 offset:38912
    v_mfma_f32_16x16x32_bf16 v[116:119], a[96:99], a[68:71], v[116:119]
    v_mfma_f32_16x16x32_bf16 v[140:143], a[96:99], a[72:75], v[140:143]
    ds_read_b128 a[16:19], v17 offset:40960
    v_mfma_f32_16x16x32_bf16 v[164:167], a[96:99], a[76:79], v[164:167]
    v_mfma_f32_16x16x32_bf16 v[188:191], a[96:99], a[80:83], v[188:191]
    buffer_load_dwordx4 v8, s[8:11], s40 offen offset:2048 lds
    ds_read_b128 a[20:23], v17 offset:43008
    v_mfma_f32_16x16x32_bf16 v[212:215], a[96:99], a[84:87], v[212:215]
    v_mfma_f32_16x16x32_bf16 v[236:239], a[96:99], a[88:91], v[236:239]
    ds_read_b128 a[24:27], v17 offset:45056
    v_mfma_f32_16x16x32_bf16 v[72:75], a[100:103], a[60:63], v[72:75]
    buffer_load_dwordx4 v9, s[8:11], s40 offen offset:3072 lds
    v_mfma_f32_16x16x32_bf16 v[96:99], a[100:103], a[64:67], v[96:99]
    ds_read_b128 a[28:31], v17 offset:47104
    v_mfma_f32_16x16x32_bf16 v[120:123], a[100:103], a[68:71], v[120:123]
    v_mfma_f32_16x16x32_bf16 v[144:147], a[100:103], a[72:75], v[144:147]
    ds_read_b64_tr_b16 a[36:37], v20 offset:28704
    v_mfma_f32_16x16x32_bf16 v[168:171], a[100:103], a[76:79], v[168:171]
    s_mov_b32 m0, s26
    ds_read_b64_tr_b16 a[38:39], v20 offset:30496
    v_mfma_f32_16x16x32_bf16 v[192:195], a[100:103], a[80:83], v[192:195]
    v_mfma_f32_16x16x32_bf16 v[216:219], a[100:103], a[84:87], v[216:219]
    ds_read_b64_tr_b16 a[40:41], v19 offset:28736
    v_mfma_f32_16x16x32_bf16 v[240:243], a[100:103], a[88:91], v[240:243]
    buffer_load_dwordx4 v10, s[12:15], s41 offen lds
    v_mfma_f32_16x16x32_bf16 v[76:79], a[104:107], a[60:63], v[76:79]
    ds_read_b64_tr_b16 a[42:43], v19 offset:30528
    v_mfma_f32_16x16x32_bf16 v[100:103], a[104:107], a[64:67], v[100:103]
    v_mfma_f32_16x16x32_bf16 v[124:127], a[104:107], a[68:71], v[124:127]
    ds_read_b64_tr_b16 a[44:45], v20 offset:28768
    v_mfma_f32_16x16x32_bf16 v[148:151], a[104:107], a[72:75], v[148:151]
    buffer_load_dwordx4 v11, s[12:15], s41 offen offset:1024 lds
    v_mfma_f32_16x16x32_bf16 v[172:175], a[104:107], a[76:79], v[172:175]
    ds_read_b64_tr_b16 a[46:47], v20 offset:30560
    v_mfma_f32_16x16x32_bf16 v[196:199], a[104:107], a[80:83], v[196:199]
    v_mfma_f32_16x16x32_bf16 v[220:223], a[104:107], a[84:87], v[220:223]
    buffer_load_dwordx4 v12, s[12:15], s41 offen offset:2048 lds
    ds_read_b64_tr_b16 a[48:49], v19 offset:28800
    v_mfma_f32_16x16x32_bf16 v[244:247], a[104:107], a[88:91], v[244:247]
    v_mfma_f32_16x16x32_bf16 v[80:83], a[108:111], a[60:63], v[80:83]
    ds_read_b64_tr_b16 a[50:51], v19 offset:30592
    v_mfma_f32_16x16x32_bf16 v[104:107], a[108:111], a[64:67], v[104:107]
    v_mfma_f32_16x16x32_bf16 v[128:131], a[108:111], a[68:71], v[128:131]
    buffer_load_dwordx4 v13, s[12:15], s41 offen offset:3072 lds
    ds_read_b64_tr_b16 a[52:53], v20 offset:28832
    v_mfma_f32_16x16x32_bf16 v[152:155], a[108:111], a[72:75], v[152:155]
    v_mfma_f32_16x16x32_bf16 v[176:179], a[108:111], a[76:79], v[176:179]
    ds_read_b64_tr_b16 a[54:55], v20 offset:30624
    v_mfma_f32_16x16x32_bf16 v[200:203], a[108:111], a[80:83], v[200:203]
    s_mov_b32 m0, s27
    v_mfma_f32_16x16x32_bf16 v[224:227], a[108:111], a[84:87], v[224:227]
    ds_read_b64_tr_b16 a[56:57], v21 offset:28672
    v_mfma_f32_16x16x32_bf16 v[248:251], a[108:111], a[88:91], v[248:251]
    v_mfma_f32_16x16x32_bf16 v[84:87], a[112:115], a[60:63], v[84:87]
    ds_read_b64_tr_b16 a[58:59], v21 offset:30464
    v_mfma_f32_16x16x32_bf16 v[108:111], a[112:115], a[64:67], v[108:111]
    buffer_load_dwordx4 v14, s[12:15], s41 offen lds
    v_mfma_f32_16x16x32_bf16 v[132:135], a[112:115], a[68:71], v[132:135]
    v_mfma_f32_16x16x32_bf16 v[156:159], a[112:115], a[72:75], v[156:159]
    v_mfma_f32_16x16x32_bf16 v[180:183], a[112:115], a[76:79], v[180:183]
    buffer_load_dwordx4 v15, s[12:15], s41 offen offset:1024 lds
    v_mfma_f32_16x16x32_bf16 v[204:207], a[112:115], a[80:83], v[204:207]
    v_mfma_f32_16x16x32_bf16 v[228:231], a[112:115], a[84:87], v[228:231]
    v_mfma_f32_16x16x32_bf16 v[252:255], a[112:115], a[88:91], v[252:255]
    v_mfma_f32_16x16x32_bf16 a[128:131], a[116:119], a[60:63], a[128:131]
    buffer_load_dwordx4 v16, s[12:15], s41 offen offset:2048 lds
    v_mfma_f32_16x16x32_bf16 a[132:135], a[116:119], a[64:67], a[132:135]
    s_add_u32 s40, s40, 128
    s_add_u32 s41, s41, 458752
    v_mfma_f32_16x16x32_bf16 a[136:139], a[116:119], a[68:71], a[136:139]
    buffer_load_dword a251, v22, s[20:23], s42 offen
    s_add_u32 s42, s42, s43
    v_mfma_f32_16x16x32_bf16 a[140:143], a[116:119], a[72:75], a[140:143]
    v_mfma_f32_16x16x32_bf16 a[144:147], a[116:119], a[76:79], a[144:147]
    v_mfma_f32_16x16x32_bf16 a[148:151], a[116:119], a[80:83], a[148:151]
    v_mfma_f32_16x16x32_bf16 a[152:155], a[116:119], a[84:87], a[152:155]
    v_mfma_f32_16x16x32_bf16 a[156:159], a[116:119], a[88:91], a[156:159]
    s_waitcnt lgkmcnt(0)
    v_mfma_f32_16x16x32_bf16 v[64:67], a[32:35], a[0:3], v[64:67]
    ds_read_b64_tr_b16 a[92:93], v19 offset:43008
    v_mfma_f32_16x16x32_bf16 v[88:91], a[32:35], a[4:7], v[88:91]
    ds_read_b64_tr_b16 a[94:95], v19 offset:44800
    v_mfma_f32_16x16x32_bf16 v[112:115], a[32:35], a[8:11], v[112:115]
    v_mfma_f32_16x16x32_bf16 v[136:139], a[32:35], a[12:15], v[136:139]
    ds_read_b128 a[60:63], v18 offset:32768
    v_mfma_f32_16x16x32_bf16 v[160:163], a[32:35], a[16:19], v[160:163]
    v_mfma_f32_16x16x32_bf16 v[184:187], a[32:35], a[20:23], v[184:187]
    ds_read_b128 a[64:67], v18 offset:34816
    v_mfma_f32_16x16x32_bf16 v[208:211], a[32:35], a[24:27], v[208:211]
    ds_read_b128 a[68:71], v18 offset:36864
    v_mfma_f32_16x16x32_bf16 v[232:235], a[32:35], a[28:31], v[232:235]
    v_mfma_f32_16x16x32_bf16 v[68:71], a[36:39], a[0:3], v[68:71]
    ds_read_b128 a[72:75], v18 offset:38912
    v_mfma_f32_16x16x32_bf16 v[92:95], a[36:39], a[4:7], v[92:95]
    v_mfma_f32_16x16x32_bf16 v[116:119], a[36:39], a[8:11], v[116:119]
    ds_read_b128 a[76:79], v18 offset:40960
    v_mfma_f32_16x16x32_bf16 v[140:143], a[36:39], a[12:15], v[140:143]
    v_mfma_f32_16x16x32_bf16 v[164:167], a[36:39], a[16:19], v[164:167]
    ds_read_b128 a[80:83], v18 offset:43008
    v_mfma_f32_16x16x32_bf16 v[188:191], a[36:39], a[20:23], v[188:191]
    ds_read_b128 a[84:87], v18 offset:45056
    v_mfma_f32_16x16x32_bf16 v[212:215], a[36:39], a[24:27], v[212:215]
    v_mfma_f32_16x16x32_bf16 v[236:239], a[36:39], a[28:31], v[236:239]
    ds_read_b128 a[88:91], v18 offset:47104
    v_mfma_f32_16x16x32_bf16 v[72:75], a[40:43], a[0:3], v[72:75]
    v_mfma_f32_16x16x32_bf16 v[96:99], a[40:43], a[4:7], v[96:99]
    ds_read_b64_tr_b16 a[96:97], v20 offset:43040
    v_mfma_f32_16x16x32_bf16 v[120:123], a[40:43], a[8:11], v[120:123]
    ds_read_b64_tr_b16 a[98:99], v20 offset:44832
    v_mfma_f32_16x16x32_bf16 v[144:147], a[40:43], a[12:15], v[144:147]
    v_mfma_f32_16x16x32_bf16 v[168:171], a[40:43], a[16:19], v[168:171]
    ds_read_b64_tr_b16 a[100:101], v19 offset:43072
    v_mfma_f32_16x16x32_bf16 v[192:195], a[40:43], a[20:23], v[192:195]
    v_mfma_f32_16x16x32_bf16 v[216:219], a[40:43], a[24:27], v[216:219]
    ds_read_b64_tr_b16 a[102:103], v19 offset:44864
    v_mfma_f32_16x16x32_bf16 v[240:243], a[40:43], a[28:31], v[240:243]
    v_mfma_f32_16x16x32_bf16 v[76:79], a[44:47], a[0:3], v[76:79]
    ds_read_b64_tr_b16 a[104:105], v20 offset:43104
    v_mfma_f32_16x16x32_bf16 v[100:103], a[44:47], a[4:7], v[100:103]
    ds_read_b64_tr_b16 a[106:107], v20 offset:44896
    v_mfma_f32_16x16x32_bf16 v[124:127], a[44:47], a[8:11], v[124:127]
    v_mfma_f32_16x16x32_bf16 v[148:151], a[44:47], a[12:15], v[148:151]
    ds_read_b64_tr_b16 a[108:109], v19 offset:43136
    v_mfma_f32_16x16x32_bf16 v[172:175], a[44:47], a[16:19], v[172:175]
    v_mfma_f32_16x16x32_bf16 v[196:199], a[44:47], a[20:23], v[196:199]
    ds_read_b64_tr_b16 a[110:111], v19 offset:44928
    v_mfma_f32_16x16x32_bf16 v[220:223], a[44:47], a[24:27], v[220:223]
    ds_read_b64_tr_b16 a[112:113], v20 offset:43168
    v_mfma_f32_16x16x32_bf16 v[244:247], a[44:47], a[28:31], v[244:247]
    v_mfma_f32_16x16x32_bf16 v[80:83], a[48:51], a[0:3], v[80:83]
    ds_read_b64_tr_b16 a[114:115], v20 offset:44960
    v_mfma_f32_16x16x32_bf16 v[104:107], a[48:51], a[4:7], v[104:107]
    v_mfma_f32_16x16x32_bf16 v[128:131], a[48:51], a[8:11], v[128:131]
    ds_read_b64_tr_b16 a[116:117], v21 offset:43008
    v_mfma_f32_16x16x32_bf16 v[152:155], a[48:51], a[12:15], v[152:155]
    v_mfma_f32_16x16x32_bf16 v[176:179], a[48:51], a[16:19], v[176:179]
    ds_read_b64_tr_b16 a[118:119], v21 offset:44800
    v_mfma_f32_16x16x32_bf16 v[200:203], a[48:51], a[20:23], v[200:203]
    v_mfma_f32_16x16x32_bf16 v[224:227], a[48:51], a[24:27], v[224:227]
    v_mfma_f32_16x16x32_bf16 v[248:251], a[48:51], a[28:31], v[248:251]
    v_mfma_f32_16x16x32_bf16 v[84:87], a[52:55], a[0:3], v[84:87]
    s_waitcnt vmcnt(1) lgkmcnt(0)
    s_barrier
    v_mfma_f32_16x16x32_bf16 v[108:111], a[52:55], a[4:7], v[108:111]
    s_mov_b32 m0, s28
    v_mfma_f32_16x16x32_bf16 v[132:135], a[52:55], a[8:11], v[132:135]
    v_mfma_f32_16x16x32_bf16 v[156:159], a[52:55], a[12:15], v[156:159]
    v_mfma_f32_16x16x32_bf16 v[180:183], a[52:55], a[16:19], v[180:183]
    buffer_load_dwordx4 v2, s[8:11], s40 offen lds
    v_mfma_f32_16x16x32_bf16 v[204:207], a[52:55], a[20:23], v[204:207]
    v_mfma_f32_16x16x32_bf16 v[228:231], a[52:55], a[24:27], v[228:231]
    v_mfma_f32_16x16x32_bf16 v[252:255], a[52:55], a[28:31], v[252:255]
    v_mfma_f32_16x16x32_bf16 a[128:131], a[56:59], a[0:3], a[128:131]
    buffer_load_dwordx4 v3, s[8:11], s40 offen offset:1024 lds
    v_mfma_f32_16x16x32_bf16 a[132:135], a[56:59], a[4:7], a[132:135]
    v_mfma_f32_16x16x32_bf16 a[136:139], a[56:59], a[8:11], a[136:139]
    v_mfma_f32_16x16x32_bf16 a[140:143], a[56:59], a[12:15], a[140:143]
    buffer_load_dwordx4 v4, s[8:11], s40 offen offset:2048 lds
    v_mfma_f32_16x16x32_bf16 a[144:147], a[56:59], a[16:19], a[144:147]
    v_mfma_f32_16x16x32_bf16 a[148:151], a[56:59], a[20:23], a[148:151]
    v_mfma_f32_16x16x32_bf16 a[152:155], a[56:59], a[24:27], a[152:155]
    v_mfma_f32_16x16x32_bf16 a[156:159], a[56:59], a[28:31], a[156:159]
    buffer_load_dwordx4 v5, s[8:11], s40 offen offset:3072 lds
    v_mfma_f32_16x16x32_bf16 v[64:67], a[92:95], a[60:63], v[64:67]
    ds_read_b64_tr_b16 a[32:33], v19 offset:0
    v_mfma_f32_16x16x32_bf16 v[88:91], a[92:95], a[64:67], v[88:91]
    ds_read_b64_tr_b16 a[34:35], v19 offset:1792
    v_mfma_f32_16x16x32_bf16 v[112:115], a[92:95], a[68:71], v[112:115]
    s_mov_b32 m0, s29
    v_mfma_f32_16x16x32_bf16 v[136:139], a[92:95], a[72:75], v[136:139]
    ds_read_b128 a[0:3], v17 offset:0
    v_mfma_f32_16x16x32_bf16 v[160:163], a[92:95], a[76:79], v[160:163]
    v_mfma_f32_16x16x32_bf16 v[184:187], a[92:95], a[80:83], v[184:187]
    ds_read_b128 a[4:7], v17 offset:2048
    v_mfma_f32_16x16x32_bf16 v[208:211], a[92:95], a[84:87], v[208:211]
    buffer_load_dwordx4 v6, s[8:11], s40 offen lds
    v_mfma_f32_16x16x32_bf16 v[232:235], a[92:95], a[88:91], v[232:235]
    ds_read_b128 a[8:11], v17 offset:4096
    v_mfma_f32_16x16x32_bf16 v[68:71], a[96:99], a[60:63], v[68:71]
    v_mfma_f32_16x16x32_bf16 v[92:95], a[96:99], a[64:67], v[92:95]
    buffer_load_dwordx4 v7, s[8:11], s40 offen offset:1024 lds
    ds_read_b128 a[12:15], v17 offset:6144
    v_mfma_f32_16x16x32_bf16 v[116:119], a[96:99], a[68:71], v[116:119]
    v_mfma_f32_16x16x32_bf16 v[140:143], a[96:99], a[72:75], v[140:143]
    ds_read_b128 a[16:19], v17 offset:8192
    v_mfma_f32_16x16x32_bf16 v[164:167], a[96:99], a[76:79], v[164:167]
    v_mfma_f32_16x16x32_bf16 v[188:191], a[96:99], a[80:83], v[188:191]
    buffer_load_dwordx4 v8, s[8:11], s40 offen offset:2048 lds
    ds_read_b128 a[20:23], v17 offset:10240
    v_mfma_f32_16x16x32_bf16 v[212:215], a[96:99], a[84:87], v[212:215]
    v_mfma_f32_16x16x32_bf16 v[236:239], a[96:99], a[88:91], v[236:239]
    ds_read_b128 a[24:27], v17 offset:12288
    v_mfma_f32_16x16x32_bf16 v[72:75], a[100:103], a[60:63], v[72:75]
    buffer_load_dwordx4 v9, s[8:11], s40 offen offset:3072 lds
    v_mfma_f32_16x16x32_bf16 v[96:99], a[100:103], a[64:67], v[96:99]
    ds_read_b128 a[28:31], v17 offset:14336
    v_mfma_f32_16x16x32_bf16 v[120:123], a[100:103], a[68:71], v[120:123]
    v_mfma_f32_16x16x32_bf16 v[144:147], a[100:103], a[72:75], v[144:147]
    ds_read_b64_tr_b16 a[36:37], v20 offset:32
    v_mfma_f32_16x16x32_bf16 v[168:171], a[100:103], a[76:79], v[168:171]
    s_mov_b32 m0, s30
    ds_read_b64_tr_b16 a[38:39], v20 offset:1824
    v_mfma_f32_16x16x32_bf16 v[192:195], a[100:103], a[80:83], v[192:195]
    v_mfma_f32_16x16x32_bf16 v[216:219], a[100:103], a[84:87], v[216:219]
    ds_read_b64_tr_b16 a[40:41], v19 offset:64
    v_mfma_f32_16x16x32_bf16 v[240:243], a[100:103], a[88:91], v[240:243]
    buffer_load_dwordx4 v10, s[12:15], s41 offen lds
    v_mfma_f32_16x16x32_bf16 v[76:79], a[104:107], a[60:63], v[76:79]
    ds_read_b64_tr_b16 a[42:43], v19 offset:1856
    v_mfma_f32_16x16x32_bf16 v[100:103], a[104:107], a[64:67], v[100:103]
    v_mfma_f32_16x16x32_bf16 v[124:127], a[104:107], a[68:71], v[124:127]
    ds_read_b64_tr_b16 a[44:45], v20 offset:96
    v_mfma_f32_16x16x32_bf16 v[148:151], a[104:107], a[72:75], v[148:151]
    buffer_load_dwordx4 v11, s[12:15], s41 offen offset:1024 lds
    v_mfma_f32_16x16x32_bf16 v[172:175], a[104:107], a[76:79], v[172:175]
    ds_read_b64_tr_b16 a[46:47], v20 offset:1888
    v_mfma_f32_16x16x32_bf16 v[196:199], a[104:107], a[80:83], v[196:199]
    v_mfma_f32_16x16x32_bf16 v[220:223], a[104:107], a[84:87], v[220:223]
    buffer_load_dwordx4 v12, s[12:15], s41 offen offset:2048 lds
    ds_read_b64_tr_b16 a[48:49], v19 offset:128
    v_mfma_f32_16x16x32_bf16 v[244:247], a[104:107], a[88:91], v[244:247]
    v_mfma_f32_16x16x32_bf16 v[80:83], a[108:111], a[60:63], v[80:83]
    ds_read_b64_tr_b16 a[50:51], v19 offset:1920
    v_mfma_f32_16x16x32_bf16 v[104:107], a[108:111], a[64:67], v[104:107]
    v_mfma_f32_16x16x32_bf16 v[128:131], a[108:111], a[68:71], v[128:131]
    buffer_load_dwordx4 v13, s[12:15], s41 offen offset:3072 lds
    ds_read_b64_tr_b16 a[52:53], v20 offset:160
    v_mfma_f32_16x16x32_bf16 v[152:155], a[108:111], a[72:75], v[152:155]
    v_mfma_f32_16x16x32_bf16 v[176:179], a[108:111], a[76:79], v[176:179]
    ds_read_b64_tr_b16 a[54:55], v20 offset:1952
    v_mfma_f32_16x16x32_bf16 v[200:203], a[108:111], a[80:83], v[200:203]
    s_mov_b32 m0, s31
    v_mfma_f32_16x16x32_bf16 v[224:227], a[108:111], a[84:87], v[224:227]
    ds_read_b64_tr_b16 a[56:57], v21 offset:0
    v_mfma_f32_16x16x32_bf16 v[248:251], a[108:111], a[88:91], v[248:251]
    v_mfma_f32_16x16x32_bf16 v[84:87], a[112:115], a[60:63], v[84:87]
    ds_read_b64_tr_b16 a[58:59], v21 offset:1792
    v_mfma_f32_16x16x32_bf16 v[108:111], a[112:115], a[64:67], v[108:111]
    buffer_load_dwordx4 v14, s[12:15], s41 offen lds
    v_mfma_f32_16x16x32_bf16 v[132:135], a[112:115], a[68:71], v[132:135]
    v_mfma_f32_16x16x32_bf16 v[156:159], a[112:115], a[72:75], v[156:159]
    v_mfma_f32_16x16x32_bf16 v[180:183], a[112:115], a[76:79], v[180:183]
    buffer_load_dwordx4 v15, s[12:15], s41 offen offset:1024 lds
    v_mfma_f32_16x16x32_bf16 v[204:207], a[112:115], a[80:83], v[204:207]
    v_mfma_f32_16x16x32_bf16 v[228:231], a[112:115], a[84:87], v[228:231]
    v_mfma_f32_16x16x32_bf16 v[252:255], a[112:115], a[88:91], v[252:255]
    v_mfma_f32_16x16x32_bf16 a[128:131], a[116:119], a[60:63], a[128:131]
    buffer_load_dwordx4 v16, s[12:15], s41 offen offset:2048 lds
    v_mfma_f32_16x16x32_bf16 a[132:135], a[116:119], a[64:67], a[132:135]
    s_add_u32 s40, s40, 128
    s_add_u32 s41, s41, 458752
    v_mfma_f32_16x16x32_bf16 a[136:139], a[116:119], a[68:71], a[136:139]
    buffer_load_dword a251, v22, s[20:23], s42 offen
    s_add_u32 s42, s42, s43
    v_mfma_f32_16x16x32_bf16 a[140:143], a[116:119], a[72:75], a[140:143]
    v_mfma_f32_16x16x32_bf16 a[144:147], a[116:119], a[76:79], a[144:147]
    v_mfma_f32_16x16x32_bf16 a[148:151], a[116:119], a[80:83], a[148:151]
    v_mfma_f32_16x16x32_bf16 a[152:155], a[116:119], a[84:87], a[152:155]
    v_mfma_f32_16x16x32_bf16 a[156:159], a[116:119], a[88:91], a[156:159]
    s_sub_u32 s37, s37, 1
    s_cmp_lg_u32 s37, 5
    s_cbranch_scc1 hook_6
    v_dot2c_f32_bf16 v48, s64, v24
    v_dot2c_f32_bf16 v49, s65, v24
    v_dot2c_f32_bf16 v50, s64, v25
    v_dot2c_f32_bf16 v51, s65, v25
    v_dot2c_f32_bf16 v52, s64, v26
    v_dot2c_f32_bf16 v53, s65, v26
    v_dot2c_f32_bf16 v54, s64, v27
    v_dot2c_f32_bf16 v55, s65, v27
    v_dot2c_f32_bf16 v48, s64, v28
    v_dot2c_f32_bf16 v49, s65, v28
    v_dot2c_f32_bf16 v50, s64, v29
    v_dot2c_f32_bf16 v51, s65, v29
    v_dot2c_f32_bf16 v52, s64, v30
    v_dot2c_f32_bf16 v53, s65, v30
    v_dot2c_f32_bf16 v54, s64, v31
    v_dot2c_f32_bf16 v55, s65, v31
    v_dot2c_f32_bf16 v48, s64, v32
    v_dot2c_f32_bf16 v49, s65, v32
    v_dot2c_f32_bf16 v50, s64, v33
    v_dot2c_f32_bf16 v51, s65, v33
    v_dot2c_f32_bf16 v52, s64, v34
    v_dot2c_f32_bf16 v53, s65, v34
    v_dot2c_f32_bf16 v54, s64, v35
    v_dot2c_f32_bf16 v55, s65, v35
    v_dot2c_f32_bf16 v48, s64, v36
    v_dot2c_f32_bf16 v49, s65, v36
    v_dot2c_f32_bf16 v50, s64, v37
    v_dot2c_f32_bf16 v51, s65, v37
    v_dot2c_f32_bf16 v52, s64, v38
    v_dot2c_f32_bf16 v53, s65, v38
    v_dot2c_f32_bf16 v54, s64, v39
    v_dot2c_f32_bf16 v55, s65, v39
    v_dot2c_f32_bf16 v48, s64, v40
    v_dot2c_f32_bf16 v49, s65, v40
    v_dot2c_f32_bf16 v50, s64, v41
    v_dot2c_f32_bf16 v51, s65, v41
    v_dot2c_f32_bf16 v52, s64, v42
    v_dot2c_f32_bf16 v53, s65, v42
    v_dot2c_f32_bf16 v54, s64, v43
    v_dot2c_f32_bf16 v55, s65, v43
    v_dot2c_f32_bf16 v48, s64, v44
    v_dot2c_f32_bf16 v49, s65, v44
    v_dot2c_f32_bf16 v50, s64, v45
    v_dot2c_f32_bf16 v51, s65, v45
    v_dot2c_f32_bf16 v52, s64, v46
    v_dot2c_f32_bf16 v53, s65, v46
    v_dot2c_f32_bf16 v54, s64, v47
    v_dot2c_f32_bf16 v55, s65, v47
    s_branch hkend_5
hook_6:
    s_cmp_lg_u32 s37, 4
    s_cbranch_scc1 hook_7
    v_dot2c_f32_bf16 v48, s64, v24
    v_dot2c_f32_bf16 v49, s65, v24
    v_dot2c_f32_bf16 v50, s64, v25
    v_dot2c_f32_bf16 v51, s65, v25
    v_dot2c_f32_bf16 v52, s64, v26
    v_dot2c_f32_bf16 v53, s65, v26
    v_dot2c_f32_bf16 v54, s64, v27
    v_dot2c_f32_bf16 v55, s65, v27
    v_dot2c_f32_bf16 v48, s64, v28
    v_dot2c_f32_bf16 v49, s65, v28
    v_dot2c_f32_bf16 v50, s64, v29
    v_dot2c_f32_bf16 v51, s65, v29
    v_dot2c_f32_bf16 v52, s64, v30
    v_dot2c_f32_bf16 v53, s65, v30
    v_dot2c_f32_bf16 v54, s64, v31
    v_dot2c_f32_bf16 v55, s65, v31
    v_dot2c_f32_bf16 v48, s64, v32
    v_dot2c_f32_bf16 v49, s65, v32
    v_dot2c_f32_bf16 v50, s64, v33
    v_dot2c_f32_bf16 v51, s65, v33
    v_dot2c_f32_bf16 v52, s64, v34
    v_dot2c_f32_bf16 v53, s65, v34
    v_dot2c_f32_bf16 v54, s64, v35
    v_dot2c_f32_bf16 v55, s65, v35
    v_dot2c_f32_bf16 v48, s64, v36
    v_dot2c_f32_bf16 v49, s65, v36
    v_dot2c_f32_bf16 v50, s64, v37
    v_dot2c_f32_bf16 v51, s65, v37
    v_dot2c_f32_bf16 v52, s64, v38
    v_dot2c_f32_bf16 v53, s65, v38
    v_dot2c_f32_bf16 v54, s64, v39
    v_dot2c_f32_bf16 v55, s65, v39
    v_dot2c_f32_bf16 v48, s64, v40
    v_dot2c_f32_bf16 v49, s65, v40
    v_dot2c_f32_bf16 v50, s64, v41
    v_dot2c_f32_bf16 v51, s65, v41
    v_dot2c_f32_bf16 v52, s64, v42
    v_dot2c_f32_bf16 v53, s65, v42
    v_dot2c_f32_bf16 v54, s64, v43
    v_dot2c_f32_bf16 v55, s65, v43
    v_dot2c_f32_bf16 v48, s64, v44
    v_dot2c_f32_bf16 v49, s65, v44
    v_dot2c_f32_bf16 v50, s64, v45
    v_dot2c_f32_bf16 v51, s65, v45
    v_dot2c_f32_bf16 v52, s64, v46
    v_dot2c_f32_bf16 v53, s65, v46
    v_dot2c_f32_bf16 v54, s64, v47
    v_dot2c_f32_bf16 v55, s65, v47
    v_mov_b32 v58, 0
    s_cmp_lg_u32 s32, 0
    s_cbranch_scc1 inl_8
    global_load_dword v59, v58, s[68:69] sc1
    s_branch inl_8_e
inl_8:
    buffer_load_dword a250, v1, s[72:75], 0 offen
inl_8_e:
    s_branch hkend_5
hook_7:
    s_cmp_lg_u32 s37, 3
    s_cbranch_scc1 hook_9
    s_cmp_lg_u32 s32, 0
    s_cbranch_scc1 inc_10_ok
    s_mov_b32 s45, 32768
inc_10:
    v_readfirstlane_b32 s44, v59
    s_nop 1
    s_cmp_ge_u32 s44, 256
    s_cbranch_scc1 inc_10_ok
    s_sub_u32 s45, s45, 1
    s_cbranch_scc1 inc_10_ok
    s_sleep 8
    global_load_dword v59, v58, s[68:69] sc1
    s_waitcnt vmcnt(0)
    s_branch inc_10
inc_10_ok:
    v_dot2c_f32_bf16 v48, s64, v24
    v_dot2c_f32_bf16 v49, s65, v24
    v_dot2c_f32_bf16 v50, s64, v25
    v_dot2c_f32_bf16 v51, s65, v25
    v_dot2c_f32_bf16 v52, s64, v26
    v_dot2c_f32_bf16 v53, s65, v26
    v_dot2c_f32_bf16 v54, s64, v27
    v_dot2c_f32_bf16 v55, s65, v27
    v_dot2c_f32_bf16 v48, s64, v28
    v_dot2c_f32_bf16 v49, s65, v28
    v_dot2c_f32_bf16 v50, s64, v29
    v_dot2c_f32_bf16 v51, s65, v29
    v_dot2c_f32_bf16 v52, s64, v30
    v_dot2c_f32_bf16 v53, s65, v30
    v_dot2c_f32_bf16 v54, s64, v31
    v_dot2c_f32_bf16 v55, s65, v31
    v_dot2c_f32_bf16 v48, s64, v32
    v_dot2c_f32_bf16 v49, s65, v32
    v_dot2c_f32_bf16 v50, s64, v33
    v_dot2c_f32_bf16 v51, s65, v33
    v_dot2c_f32_bf16 v52, s64, v34
    v_dot2c_f32_bf16 v53, s65, v34
    v_dot2c_f32_bf16 v54, s64, v35
    v_dot2c_f32_bf16 v55, s65, v35
    v_dot2c_f32_bf16 v48, s64, v36
    v_dot2c_f32_bf16 v49, s65, v36
    v_dot2c_f32_bf16 v50, s64, v37
    v_dot2c_f32_bf16 v51, s65, v37
    v_dot2c_f32_bf16 v52, s64, v38
    v_dot2c_f32_bf16 v53, s65, v38
    v_dot2c_f32_bf16 v54, s64, v39
    v_dot2c_f32_bf16 v55, s65, v39
    v_dot2c_f32_bf16 v48, s64, v40
    v_dot2c_f32_bf16 v49, s65, v40
    v_dot2c_f32_bf16 v50, s64, v41
    v_dot2c_f32_bf16 v51, s65, v41
    v_dot2c_f32_bf16 v52, s64, v42
    v_dot2c_f32_bf16 v53, s65, v42
    v_dot2c_f32_bf16 v54, s64, v43
    v_dot2c_f32_bf16 v55, s65, v43
    v_dot2c_f32_bf16 v48, s64, v44
    v_dot2c_f32_bf16 v49, s65, v44
    v_dot2c_f32_bf16 v50, s64, v45
    v_dot2c_f32_bf16 v51, s65, v45
    v_dot2c_f32_bf16 v52, s64, v46
    v_dot2c_f32_bf16 v53, s65, v46
    v_dot2c_f32_bf16 v54, s64, v47
    v_dot2c_f32_bf16 v55, s65, v47
    v_permlane32_swap_b32 v48, v49
    v_permlane32_swap_b32 v50, v51
    v_permlane32_swap_b32 v52, v53
    v_permlane32_swap_b32 v54, v55
    v_add_f32 v48, v48, v49
    v_add_f32 v49, v50, v51
    v_add_f32 v50, v52, v53
    v_add_f32 v51, v54, v55
    s_lshl_b32 s44, s32, 10
    s_add_u32 s44, s44, 126976
    v_lshlrev_b32 v56, 4, v1
    v_add_u32 v57, s44, v56
    ds_write_b128 v57, v[48:51]
    s_waitcnt lgkmcnt(0)
    s_barrier
    s_cmp_lg_u32 s32, 0
    s_cbranch_scc1 cs_11
    v_add_u32 v57, 126976, v56
    ds_read_b128 v[24:27], v57 offset:1024
    ds_read_b128 v[28:31], v57 offset:2048
    ds_read_b128 v[32:35], v57 offset:3072
    s_waitcnt lgkmcnt(0)
    v_pk_add_f32 v[24:25], v[24:25], v[28:29]
    v_pk_add_f32 v[48:49], v[48:49], v[32:33]
    v_pk_add_f32 v[26:27], v[26:27], v[30:31]
    v_pk_add_f32 v[50:51], v[50:51], v[34:35]
    v_pk_add_f32 v[48:49], v[48:49], v[24:25]
    v_pk_add_f32 v[50:51], v[50:51], v[26:27]
    s_lshl_b32 s44, s35, 4
    s_add_u32 s44, s44, s36
    s_lshl_b32 s44, s44, 10
    s_add_u32 s44, s44, 23101440
    s_add_u32 s16, s52, s44
    s_addc_u32 s17, s53, 0
    s_mov_b32 s18, 1024
    s_mov_b32 s19, 0x20000
    buffer_store_dwordx4 v[48:51], v56, s[16:19], 0 offen sc1
    s_branch cs_11_e
cs_11:
    buffer_load_dword a250, v1, s[72:75], 0 offen
cs_11_e:
    s_branch hkend_5
hook_9:
    s_cmp_lg_u32 s37, 2
    s_cbranch_scc1 hook_12
    s_add_u32 s78, s35, 48
    s_cmp_lg_u32 s32, 0
    s_cbranch_scc1 post_13
    s_add_u32 s16, s52, 23592960
    s_addc_u32 s17, s53, 0
    s_mov_b32 s18, 65536
    s_mov_b32 s19, 0x20000
    v_mov_b32 v56, 1
    v_mov_b32 v57, v1
    v_and_b32 v58, 3, v57
    v_lshl_add_u32 v56, v58, 1, v56
    v_lshrrev_b32 v57, 2, v57
    v_mov_b32 v58, s36
    v_and_b32 v59, 3, v58
    v_lshl_add_u32 v56, v59, 3, v56
    v_lshrrev_b32 v58, 2, v58
    v_lshl_add_u32 v57, v58, 1, v57
    v_lshl_add_u32 v56, v56, 3, v57
    v_lshlrev_b32 v56, 6, v56
    v_add_u32 v56, s78, v56
    v_lshlrev_b32 v56, 2, v56
    v_mov_b32 v57, 0x7ffffff0
    v_cmp_gt_u32 vcc, 8, v1
    s_nop 1
    v_cndmask_b32 v56, v57, v56, vcc
    v_mov_b32 v57, 1
    buffer_store_dword v57, v56, s[16:19], 0 offen sc1
    s_branch post_13_e
post_13:
    buffer_load_dword a250, v1, s[72:75], 0 offen
post_13_e:
    s_branch hkend_5
hook_12:
    s_cmp_lg_u32 s37, 1
    s_cbranch_scc1 hook_14
    v_min_u32 v58, 15, v1
    v_add_u32 v58, 32, v58
    v_lshlrev_b32 v58, 2, v58
    v_min_u32 v60, 7, v1
    v_add_u32 v60, 48, v60
    v_lshlrev_b32 v60, 2, v60
    global_load_dword v59, v58, s[100:101] sc1
    global_load_dword v61, v60, s[100:101] sc1
    s_branch hkend_5
hook_14:
hkend_5:
    s_cmp_lg_u32 s37, 0
    s_cbranch_scc1 gated_mix__linear_kernel_hedgehog__mixer_channel_mlp__prompt_kernel_m_loop
    s_mov_b32 s44, 32768
wait_15:
    v_cmp_ne_u32 vcc, 1, v59
    s_nop 4
    s_cbranch_vccz wait_15_ok
    s_sub_u32 s44, s44, 1
    s_cbranch_scc1 wait_15_ok
    s_sleep 1
    global_load_dword v59, v58, s[100:101] sc1
    s_waitcnt vmcnt(0)
    s_branch wait_15
wait_15_ok:
    s_mov_b32 s44, 32768
wait_16:
    v_cmp_ne_u32 vcc, 1, v61
    s_nop 4
    s_cbranch_vccz wait_16_ok
    s_sub_u32 s44, s44, 1
    s_cbranch_scc1 wait_16_ok
    s_sleep 1
    global_load_dword v61, v60, s[100:101] sc1
    s_waitcnt vmcnt(0)
    s_branch wait_16
wait_16_ok:
    s_mul_i32 s44, s36, 224
    v_add_u32 v56, s44, v0
    v_lshlrev_b32 v62, 1, v56
    v_and_b32 v57, 1, v0
    v_lshlrev_b32 v57, 5, v57
    v_lshrrev_b32 v63, 3, v0
    v_add_u32 v57, v57, v63
    v_lshlrev_b32 v57, 2, v57
    v_bfe_u32 v63, v0, 1, 2
    v_add_u32 v57, v57, v63
    v_lshlrev_b32 v57, 2, v57
    s_lshl_b32 s44, s36, 10
    v_add_u32 v57, s44, v57
    v_cmp_gt_u32 vcc, 224, v0
    v_mov_b32 v63, 0x7ffffff0
    s_nop 0
    v_cndmask_b32 v57, v63, v57, vcc
    v_cndmask_b32 v62, v63, v62, vcc
    s_lshl_b32 s44, s35, 8
    v_add_u32 v56, s44, v0
    v_lshlrev_b32 v56, 3, v56
    s_add_u32 s56, s52, 23068672
    s_addc_u32 s57, s53, 0
    s_mov_b32 s58, 0x40000
    s_mov_b32 s59, 0x20000
    buffer_load_dwordx2 a[160:161], v56, s[56:59], 0 offen sc1
    s_mov_b32 s44, 32768
    buffer_load_dword a162, v57, s[56:59], s44 offen sc1
    s_mov_b32 s44, 49152
    buffer_load_dword a163, v57, s[56:59], s44 offen sc1
    s_mov_b32 s44, 65536
    buffer_load_dword a164, v57, s[56:59], s44 offen sc1
    s_mov_b32 s44, 81920
    buffer_load_dword a165, v57, s[56:59], s44 offen sc1
    s_mov_b32 s44, 98304
    buffer_load_dword a166, v57, s[56:59], s44 offen sc1
    s_mov_b32 s44, 114688
    buffer_load_dword a167, v57, s[56:59], s44 offen sc1
    s_mov_b32 s44, 131072
    buffer_load_dword a168, v57, s[56:59], s44 offen sc1
    s_mov_b32 s44, 147456
    buffer_load_dword a169, v57, s[56:59], s44 offen sc1
    s_mov_b32 s20, s76
    s_mov_b32 s21, s77
    s_mov_b32 s22, 7168
    s_mov_b32 s23, 0x20000
    buffer_load_ushort a170, v62, s[20:23], 0 offen
    s_getpc_b64 s[50:51]
pc_4:
    s_sub_u32 s50, s50, pc_4-gated_mix__linear_kernel_hedgehog__mixer_channel_mlp__prompt_kernel
    s_subb_u32 s51, s51, 0
    s_lshr_b32 s48, s2, 3
    s_lshl_b32 s48, s48, 2
    v_lshrrev_b32 v48, 6, v0
    v_add_u32 v48, s48, v48
    v_mul_u32_u24 v48, 4, v48
    v_and_b32 v49, 63, v0
    v_min_u32 v49, 3, v49
    v_add_u32 v48, v48, v49
    v_lshlrev_b32 v48, 7, v48
    v_min_u32 v48, gated_mix__linear_kernel_hedgehog__mixer_channel_mlp__prompt_kernel_end-gated_mix__linear_kernel_hedgehog__mixer_channel_mlp__prompt_kernel, v48
    global_load_dword a253, v48, s[50:51]
    s_waitcnt lgkmcnt(0)
    v_mfma_f32_16x16x32_bf16 v[64:67], a[32:35], a[0:3], v[64:67]
    ds_read_b64_tr_b16 a[92:93], v19 offset:14336
    v_mfma_f32_16x16x32_bf16 v[88:91], a[32:35], a[4:7], v[88:91]
    ds_read_b64_tr_b16 a[94:95], v19 offset:16128
    v_mfma_f32_16x16x32_bf16 v[112:115], a[32:35], a[8:11], v[112:115]
    v_mfma_f32_16x16x32_bf16 v[136:139], a[32:35], a[12:15], v[136:139]
    ds_read_b128 a[60:63], v18 offset:0
    v_mfma_f32_16x16x32_bf16 v[160:163], a[32:35], a[16:19], v[160:163]
    v_mfma_f32_16x16x32_bf16 v[184:187], a[32:35], a[20:23], v[184:187]
    ds_read_b128 a[64:67], v18 offset:2048
    v_mfma_f32_16x16x32_bf16 v[208:211], a[32:35], a[24:27], v[208:211]
    ds_read_b128 a[68:71], v18 offset:4096
    v_mfma_f32_16x16x32_bf16 v[232:235], a[32:35], a[28:31], v[232:235]
    v_mfma_f32_16x16x32_bf16 v[68:71], a[36:39], a[0:3], v[68:71]
    ds_read_b128 a[72:75], v18 offset:6144
    v_mfma_f32_16x16x32_bf16 v[92:95], a[36:39], a[4:7], v[92:95]
    v_mfma_f32_16x16x32_bf16 v[116:119], a[36:39], a[8:11], v[116:119]
    ds_read_b128 a[76:79], v18 offset:8192
    v_mfma_f32_16x16x32_bf16 v[140:143], a[36:39], a[12:15], v[140:143]
    v_mfma_f32_16x16x32_bf16 v[164:167], a[36:39], a[16:19], v[164:167]
    ds_read_b128 a[80:83], v18 offset:10240
    v_mfma_f32_16x16x32_bf16 v[188:191], a[36:39], a[20:23], v[188:191]
    ds_read_b128 a[84:87], v18 offset:12288
    v_mfma_f32_16x16x32_bf16 v[212:215], a[36:39], a[24:27], v[212:215]
    v_mfma_f32_16x16x32_bf16 v[236:239], a[36:39], a[28:31], v[236:239]
    ds_read_b128 a[88:91], v18 offset:14336
    v_mfma_f32_16x16x32_bf16 v[72:75], a[40:43], a[0:3], v[72:75]
    v_mfma_f32_16x16x32_bf16 v[96:99], a[40:43], a[4:7], v[96:99]
    ds_read_b64_tr_b16 a[96:97], v20 offset:14368
    v_mfma_f32_16x16x32_bf16 v[120:123], a[40:43], a[8:11], v[120:123]
    ds_read_b64_tr_b16 a[98:99], v20 offset:16160
    v_mfma_f32_16x16x32_bf16 v[144:147], a[40:43], a[12:15], v[144:147]
    v_mfma_f32_16x16x32_bf16 v[168:171], a[40:43], a[16:19], v[168:171]
    ds_read_b64_tr_b16 a[100:101], v19 offset:14400
    v_mfma_f32_16x16x32_bf16 v[192:195], a[40:43], a[20:23], v[192:195]
    v_mfma_f32_16x16x32_bf16 v[216:219], a[40:43], a[24:27], v[216:219]
    ds_read_b64_tr_b16 a[102:103], v19 offset:16192
    v_mfma_f32_16x16x32_bf16 v[240:243], a[40:43], a[28:31], v[240:243]
    v_mfma_f32_16x16x32_bf16 v[76:79], a[44:47], a[0:3], v[76:79]
    ds_read_b64_tr_b16 a[104:105], v20 offset:14432
    v_mfma_f32_16x16x32_bf16 v[100:103], a[44:47], a[4:7], v[100:103]
    ds_read_b64_tr_b16 a[106:107], v20 offset:16224
    v_mfma_f32_16x16x32_bf16 v[124:127], a[44:47], a[8:11], v[124:127]
    v_mfma_f32_16x16x32_bf16 v[148:151], a[44:47], a[12:15], v[148:151]
    ds_read_b64_tr_b16 a[108:109], v19 offset:14464
    v_mfma_f32_16x16x32_bf16 v[172:175], a[44:47], a[16:19], v[172:175]
    v_mfma_f32_16x16x32_bf16 v[196:199], a[44:47], a[20:23], v[196:199]
    ds_read_b64_tr_b16 a[110:111], v19 offset:16256
    v_mfma_f32_16x16x32_bf16 v[220:223], a[44:47], a[24:27], v[220:223]
    ds_read_b64_tr_b16 a[112:113], v20 offset:14496
    v_mfma_f32_16x16x32_bf16 v[244:247], a[44:47], a[28:31], v[244:247]
    v_mfma_f32_16x16x32_bf16 v[80:83], a[48:51], a[0:3], v[80:83]
    ds_read_b64_tr_b16 a[114:115], v20 offset:16288
    v_mfma_f32_16x16x32_bf16 v[104:107], a[48:51], a[4:7], v[104:107]
    v_mfma_f32_16x16x32_bf16 v[128:131], a[48:51], a[8:11], v[128:131]
    ds_read_b64_tr_b16 a[116:117], v21 offset:14336
    v_mfma_f32_16x16x32_bf16 v[152:155], a[48:51], a[12:15], v[152:155]
    v_mfma_f32_16x16x32_bf16 v[176:179], a[48:51], a[16:19], v[176:179]
    ds_read_b64_tr_b16 a[118:119], v21 offset:16128
    v_mfma_f32_16x16x32_bf16 v[200:203], a[48:51], a[20:23], v[200:203]
    v_mfma_f32_16x16x32_bf16 v[224:227], a[48:51], a[24:27], v[224:227]
    v_mfma_f32_16x16x32_bf16 v[248:251], a[48:51], a[28:31], v[248:251]
    v_mfma_f32_16x16x32_bf16 v[84:87], a[52:55], a[0:3], v[84:87]
    s_waitcnt vmcnt(12) lgkmcnt(0)
    s_barrier
    v_mfma_f32_16x16x32_bf16 v[108:111], a[52:55], a[4:7], v[108:111]
    v_mfma_f32_16x16x32_bf16 v[132:135], a[52:55], a[8:11], v[132:135]
    v_mfma_f32_16x16x32_bf16 v[156:159], a[52:55], a[12:15], v[156:159]
    v_mfma_f32_16x16x32_bf16 v[180:183], a[52:55], a[16:19], v[180:183]
    v_mfma_f32_16x16x32_bf16 v[204:207], a[52:55], a[20:23], v[204:207]
    v_mfma_f32_16x16x32_bf16 v[228:231], a[52:55], a[24:27], v[228:231]
    v_mfma_f32_16x16x32_bf16 v[252:255], a[52:55], a[28:31], v[252:255]
    v_mfma_f32_16x16x32_bf16 a[128:131], a[56:59], a[0:3], a[128:131]
    v_mfma_f32_16x16x32_bf16 a[132:135], a[56:59], a[4:7], a[132:135]
    v_mfma_f32_16x16x32_bf16 a[136:139], a[56:59], a[8:11], a[136:139]
    v_mfma_f32_16x16x32_bf16 a[140:143], a[56:59], a[12:15], a[140:143]
    v_mfma_f32_16x16x32_bf16 a[144:147], a[56:59], a[16:19], a[144:147]
    v_mfma_f32_16x16x32_bf16 a[148:151], a[56:59], a[20:23], a[148:151]
    v_mfma_f32_16x16x32_bf16 a[152:155], a[56:59], a[24:27], a[152:155]
    v_mfma_f32_16x16x32_bf16 a[156:159], a[56:59], a[28:31], a[156:159]
    v_mfma_f32_16x16x32_bf16 v[64:67], a[92:95], a[60:63], v[64:67]
    ds_read_b64_tr_b16 a[32:33], v19 offset:28672
    v_mfma_f32_16x16x32_bf16 v[88:91], a[92:95], a[64:67], v[88:91]
    ds_read_b64_tr_b16 a[34:35], v19 offset:30464
    v_mfma_f32_16x16x32_bf16 v[112:115], a[92:95], a[68:71], v[112:115]
    v_mfma_f32_16x16x32_bf16 v[136:139], a[92:95], a[72:75], v[136:139]
    ds_read_b128 a[0:3], v17 offset:32768
    v_mfma_f32_16x16x32_bf16 v[160:163], a[92:95], a[76:79], v[160:163]
    v_mfma_f32_16x16x32_bf16 v[184:187], a[92:95], a[80:83], v[184:187]
    ds_read_b128 a[4:7], v17 offset:34816
    v_mfma_f32_16x16x32_bf16 v[208:211], a[92:95], a[84:87], v[208:211]
    v_mfma_f32_16x16x32_bf16 v[232:235], a[92:95], a[88:91], v[232:235]
    ds_read_b128 a[8:11], v17 offset:36864
    v_mfma_f32_16x16x32_bf16 v[68:71], a[96:99], a[60:63], v[68:71]
    v_mfma_f32_16x16x32_bf16 v[92:95], a[96:99], a[64:67], v[92:95]
    ds_read_b128 a[12:15], v17 offset:38912
    v_mfma_f32_16x16x32_bf16 v[116:119], a[96:99], a[68:71], v[116:119]
    v_mfma_f32_16x16x32_bf16 v[140:143], a[96:99], a[72:75], v[140:143]
    ds_read_b128 a[16:19], v17 offset:40960
    v_mfma_f32_16x16x32_bf16 v[164:167], a[96:99], a[76:79], v[164:167]
    v_mfma_f32_16x16x32_bf16 v[188:191], a[96:99], a[80:83], v[188:191]
    ds_read_b128 a[20:23], v17 offset:43008
    v_mfma_f32_16x16x32_bf16 v[212:215], a[96:99], a[84:87], v[212:215]
    v_mfma_f32_16x16x32_bf16 v[236:239], a[96:99], a[88:91], v[236:239]
    ds_read_b128 a[24:27], v17 offset:45056
    v_mfma_f32_16x16x32_bf16 v[72:75], a[100:103], a[60:63], v[72:75]
    v_mfma_f32_16x16x32_bf16 v[96:99], a[100:103], a[64:67], v[96:99]
    ds_read_b128 a[28:31], v17 offset:47104
    v_mfma_f32_16x16x32_bf16 v[120:123], a[100:103], a[68:71], v[120:123]
    v_mfma_f32_16x16x32_bf16 v[144:147], a[100:103], a[72:75], v[144:147]
    ds_read_b64_tr_b16 a[36:37], v20 offset:28704
    v_mfma_f32_16x16x32_bf16 v[168:171], a[100:103], a[76:79], v[168:171]
    ds_read_b64_tr_b16 a[38:39], v20 offset:30496
    v_mfma_f32_16x16x32_bf16 v[192:195], a[100:103], a[80:83], v[192:195]
    v_mfma_f32_16x16x32_bf16 v[216:219], a[100:103], a[84:87], v[216:219]
    ds_read_b64_tr_b16 a[40:41], v19 offset:28736
    v_mfma_f32_16x16x32_bf16 v[240:243], a[100:103], a[88:91], v[240:243]
    v_mfma_f32_16x16x32_bf16 v[76:79], a[104:107], a[60:63], v[76:79]
    ds_read_b64_tr_b16 a[42:43], v19 offset:30528
    v_mfma_f32_16x16x32_bf16 v[100:103], a[104:107], a[64:67], v[100:103]
    v_mfma_f32_16x16x32_bf16 v[124:127], a[104:107], a[68:71], v[124:127]
    ds_read_b64_tr_b16 a[44:45], v20 offset:28768
    v_mfma_f32_16x16x32_bf16 v[148:151], a[104:107], a[72:75], v[148:151]
    v_mfma_f32_16x16x32_bf16 v[172:175], a[104:107], a[76:79], v[172:175]
    ds_read_b64_tr_b16 a[46:47], v20 offset:30560
    v_mfma_f32_16x16x32_bf16 v[196:199], a[104:107], a[80:83], v[196:199]
    v_mfma_f32_16x16x32_bf16 v[220:223], a[104:107], a[84:87], v[220:223]
    ds_read_b64_tr_b16 a[48:49], v19 offset:28800
    v_mfma_f32_16x16x32_bf16 v[244:247], a[104:107], a[88:91], v[244:247]
    v_mfma_f32_16x16x32_bf16 v[80:83], a[108:111], a[60:63], v[80:83]
    ds_read_b64_tr_b16 a[50:51], v19 offset:30592
    v_mfma_f32_16x16x32_bf16 v[104:107], a[108:111], a[64:67], v[104:107]
    v_mfma_f32_16x16x32_bf16 v[128:131], a[108:111], a[68:71], v[128:131]
    ds_read_b64_tr_b16 a[52:53], v20 offset:28832
    v_mfma_f32_16x16x32_bf16 v[152:155], a[108:111], a[72:75], v[152:155]
    v_mfma_f32_16x16x32_bf16 v[176:179], a[108:111], a[76:79], v[176:179]
    ds_read_b64_tr_b16 a[54:55], v20 offset:30624
    v_mfma_f32_16x16x32_bf16 v[200:203], a[108:111], a[80:83], v[200:203]
    v_mfma_f32_16x16x32_bf16 v[224:227], a[108:111], a[84:87], v[224:227]
    ds_read_b64_tr_b16 a[56:57], v21 offset:28672
    v_mfma_f32_16x16x32_bf16 v[248:251], a[108:111], a[88:91], v[248:251]
    v_mfma_f32_16x16x32_bf16 v[84:87], a[112:115], a[60:63], v[84:87]
    ds_read_b64_tr_b16 a[58:59], v21 offset:30464
    v_mfma_f32_16x16x32_bf16 v[108:111], a[112:115], a[64:67], v[108:111]
    v_mfma_f32_16x16x32_bf16 v[132:135], a[112:115], a[68:71], v[132:135]
    v_mfma_f32_16x16x32_bf16 v[156:159], a[112:115], a[72:75], v[156:159]
    v_mfma_f32_16x16x32_bf16 v[180:183], a[112:115], a[76:79], v[180:183]
    v_mfma_f32_16x16x32_bf16 v[204:207], a[112:115], a[80:83], v[204:207]
    v_mfma_f32_16x16x32_bf16 v[228:231], a[112:115], a[84:87], v[228:231]
    v_mfma_f32_16x16x32_bf16 v[252:255], a[112:115], a[88:91], v[252:255]
    v_mfma_f32_16x16x32_bf16 a[128:131], a[116:119], a[60:63], a[128:131]
    v_mfma_f32_16x16x32_bf16 a[132:135], a[116:119], a[64:67], a[132:135]
    v_mfma_f32_16x16x32_bf16 a[136:139], a[116:119], a[68:71], a[136:139]
    v_mfma_f32_16x16x32_bf16 a[140:143], a[116:119], a[72:75], a[140:143]
    v_mfma_f32_16x16x32_bf16 a[144:147], a[116:119], a[76:79], a[144:147]
    v_mfma_f32_16x16x32_bf16 a[148:151], a[116:119], a[80:83], a[148:151]
    v_mfma_f32_16x16x32_bf16 a[152:155], a[116:119], a[84:87], a[152:155]
    v_mfma_f32_16x16x32_bf16 a[156:159], a[116:119], a[88:91], a[156:159]
    s_waitcnt lgkmcnt(0)
    v_mfma_f32_16x16x32_bf16 v[64:67], a[32:35], a[0:3], v[64:67]
    ds_read_b64_tr_b16 a[92:93], v19 offset:43008
    v_mfma_f32_16x16x32_bf16 v[88:91], a[32:35], a[4:7], v[88:91]
    ds_read_b64_tr_b16 a[94:95], v19 offset:44800
    v_mfma_f32_16x16x32_bf16 v[112:115], a[32:35], a[8:11], v[112:115]
    v_mfma_f32_16x16x32_bf16 v[136:139], a[32:35], a[12:15], v[136:139]
    ds_read_b128 a[60:63], v18 offset:32768
    v_mfma_f32_16x16x32_bf16 v[160:163], a[32:35], a[16:19], v[160:163]
    v_mfma_f32_16x16x32_bf16 v[184:187], a[32:35], a[20:23], v[184:187]
    ds_read_b128 a[64:67], v18 offset:34816
    v_mfma_f32_16x16x32_bf16 v[208:211], a[32:35], a[24:27], v[208:211]
    ds_read_b128 a[68:71], v18 offset:36864
    v_mfma_f32_16x16x32_bf16 v[232:235], a[32:35], a[28:31], v[232:235]
    v_mfma_f32_16x16x32_bf16 v[68:71], a[36:39], a[0:3], v[68:71]
    ds_read_b128 a[72:75], v18 offset:38912
    v_mfma_f32_16x16x32_bf16 v[92:95], a[36:39], a[4:7], v[92:95]
    v_mfma_f32_16x16x32_bf16 v[116:119], a[36:39], a[8:11], v[116:119]
    ds_read_b128 a[76:79], v18 offset:40960
    v_mfma_f32_16x16x32_bf16 v[140:143], a[36:39], a[12:15], v[140:143]
    v_mfma_f32_16x16x32_bf16 v[164:167], a[36:39], a[16:19], v[164:167]
    ds_read_b128 a[80:83], v18 offset:43008
    v_mfma_f32_16x16x32_bf16 v[188:191], a[36:39], a[20:23], v[188:191]
    ds_read_b128 a[84:87], v18 offset:45056
    v_mfma_f32_16x16x32_bf16 v[212:215], a[36:39], a[24:27], v[212:215]
    v_mfma_f32_16x16x32_bf16 v[236:239], a[36:39], a[28:31], v[236:239]
    ds_read_b128 a[88:91], v18 offset:47104
    v_mfma_f32_16x16x32_bf16 v[72:75], a[40:43], a[0:3], v[72:75]
    v_mfma_f32_16x16x32_bf16 v[96:99], a[40:43], a[4:7], v[96:99]
    ds_read_b64_tr_b16 a[96:97], v20 offset:43040
    v_mfma_f32_16x16x32_bf16 v[120:123], a[40:43], a[8:11], v[120:123]
    ds_read_b64_tr_b16 a[98:99], v20 offset:44832
    v_mfma_f32_16x16x32_bf16 v[144:147], a[40:43], a[12:15], v[144:147]
    v_mfma_f32_16x16x32_bf16 v[168:171], a[40:43], a[16:19], v[168:171]
    ds_read_b64_tr_b16 a[100:101], v19 offset:43072
    v_mfma_f32_16x16x32_bf16 v[192:195], a[40:43], a[20:23], v[192:195]
    v_mfma_f32_16x16x32_bf16 v[216:219], a[40:43], a[24:27], v[216:219]
    ds_read_b64_tr_b16 a[102:103], v19 offset:44864
    v_mfma_f32_16x16x32_bf16 v[240:243], a[40:43], a[28:31], v[240:243]
    v_mfma_f32_16x16x32_bf16 v[76:79], a[44:47], a[0:3], v[76:79]
    ds_read_b64_tr_b16 a[104:105], v20 offset:43104
    v_mfma_f32_16x16x32_bf16 v[100:103], a[44:47], a[4:7], v[100:103]
    ds_read_b64_tr_b16 a[106:107], v20 offset:44896
    v_mfma_f32_16x16x32_bf16 v[124:127], a[44:47], a[8:11], v[124:127]
    v_mfma_f32_16x16x32_bf16 v[148:151], a[44:47], a[12:15], v[148:151]
    ds_read_b64_tr_b16 a[108:109], v19 offset:43136
    v_mfma_f32_16x16x32_bf16 v[172:175], a[44:47], a[16:19], v[172:175]
    v_mfma_f32_16x16x32_bf16 v[196:199], a[44:47], a[20:23], v[196:199]
    ds_read_b64_tr_b16 a[110:111], v19 offset:44928
    v_mfma_f32_16x16x32_bf16 v[220:223], a[44:47], a[24:27], v[220:223]
    ds_read_b64_tr_b16 a[112:113], v20 offset:43168
    v_mfma_f32_16x16x32_bf16 v[244:247], a[44:47], a[28:31], v[244:247]
    v_mfma_f32_16x16x32_bf16 v[80:83], a[48:51], a[0:3], v[80:83]
    ds_read_b64_tr_b16 a[114:115], v20 offset:44960
    v_mfma_f32_16x16x32_bf16 v[104:107], a[48:51], a[4:7], v[104:107]
    v_mfma_f32_16x16x32_bf16 v[128:131], a[48:51], a[8:11], v[128:131]
    ds_read_b64_tr_b16 a[116:117], v21 offset:43008
    v_mfma_f32_16x16x32_bf16 v[152:155], a[48:51], a[12:15], v[152:155]
    v_mfma_f32_16x16x32_bf16 v[176:179], a[48:51], a[16:19], v[176:179]
    ds_read_b64_tr_b16 a[118:119], v21 offset:44800
    v_mfma_f32_16x16x32_bf16 v[200:203], a[48:51], a[20:23], v[200:203]
    v_mfma_f32_16x16x32_bf16 v[224:227], a[48:51], a[24:27], v[224:227]
    v_mfma_f32_16x16x32_bf16 v[248:251], a[48:51], a[28:31], v[248:251]
    v_mfma_f32_16x16x32_bf16 v[84:87], a[52:55], a[0:3], v[84:87]
    s_waitcnt lgkmcnt(0)
    v_mfma_f32_16x16x32_bf16 v[108:111], a[52:55], a[4:7], v[108:111]
    v_mfma_f32_16x16x32_bf16 v[132:135], a[52:55], a[8:11], v[132:135]
    v_mfma_f32_16x16x32_bf16 v[156:159], a[52:55], a[12:15], v[156:159]
    v_mfma_f32_16x16x32_bf16 v[180:183], a[52:55], a[16:19], v[180:183]
    v_mfma_f32_16x16x32_bf16 v[204:207], a[52:55], a[20:23], v[204:207]
    v_mfma_f32_16x16x32_bf16 v[228:231], a[52:55], a[24:27], v[228:231]
    v_mfma_f32_16x16x32_bf16 v[252:255], a[52:55], a[28:31], v[252:255]
    v_mfma_f32_16x16x32_bf16 a[128:131], a[56:59], a[0:3], a[128:131]
    v_mfma_f32_16x16x32_bf16 a[132:135], a[56:59], a[4:7], a[132:135]
    v_mfma_f32_16x16x32_bf16 a[136:139], a[56:59], a[8:11], a[136:139]
    v_mfma_f32_16x16x32_bf16 a[140:143], a[56:59], a[12:15], a[140:143]
    v_mfma_f32_16x16x32_bf16 a[144:147], a[56:59], a[16:19], a[144:147]
    v_mfma_f32_16x16x32_bf16 a[148:151], a[56:59], a[20:23], a[148:151]
    v_mfma_f32_16x16x32_bf16 a[152:155], a[56:59], a[24:27], a[152:155]
    v_mfma_f32_16x16x32_bf16 a[156:159], a[56:59], a[28:31], a[156:159]
    v_mfma_f32_16x16x32_bf16 v[64:67], a[92:95], a[60:63], v[64:67]
    v_mfma_f32_16x16x32_bf16 v[88:91], a[92:95], a[64:67], v[88:91]
    v_mfma_f32_16x16x32_bf16 v[112:115], a[92:95], a[68:71], v[112:115]
    v_mfma_f32_16x16x32_bf16 v[136:139], a[92:95], a[72:75], v[136:139]
    v_mfma_f32_16x16x32_bf16 v[160:163], a[92:95], a[76:79], v[160:163]
    v_mfma_f32_16x16x32_bf16 v[184:187], a[92:95], a[80:83], v[184:187]
    v_mfma_f32_16x16x32_bf16 v[208:211], a[92:95], a[84:87], v[208:211]
    v_mfma_f32_16x16x32_bf16 v[232:235], a[92:95], a[88:91], v[232:235]
    v_mfma_f32_16x16x32_bf16 v[68:71], a[96:99], a[60:63], v[68:71]
    v_mfma_f32_16x16x32_bf16 v[92:95], a[96:99], a[64:67], v[92:95]
    v_mfma_f32_16x16x32_bf16 v[116:119], a[96:99], a[68:71], v[116:119]
    v_mfma_f32_16x16x32_bf16 v[140:143], a[96:99], a[72:75], v[140:143]
    v_mfma_f32_16x16x32_bf16 v[164:167], a[96:99], a[76:79], v[164:167]
    v_mfma_f32_16x16x32_bf16 v[188:191], a[96:99], a[80:83], v[188:191]
    v_mfma_f32_16x16x32_bf16 v[212:215], a[96:99], a[84:87], v[212:215]
    v_mfma_f32_16x16x32_bf16 v[236:239], a[96:99], a[88:91], v[236:239]
    v_mfma_f32_16x16x32_bf16 v[72:75], a[100:103], a[60:63], v[72:75]
    v_mfma_f32_16x16x32_bf16 v[96:99], a[100:103], a[64:67], v[96:99]
    v_mfma_f32_16x16x32_bf16 v[120:123], a[100:103], a[68:71], v[120:123]
    v_mfma_f32_16x16x32_bf16 v[144:147], a[100:103], a[72:75], v[144:147]
    v_mfma_f32_16x16x32_bf16 v[168:171], a[100:103], a[76:79], v[168:171]
    v_mfma_f32_16x16x32_bf16 v[192:195], a[100:103], a[80:83], v[192:195]
    v_mfma_f32_16x16x32_bf16 v[216:219], a[100:103], a[84:87], v[216:219]
    v_mfma_f32_16x16x32_bf16 v[240:243], a[100:103], a[88:91], v[240:243]
    v_mfma_f32_16x16x32_bf16 v[76:79], a[104:107], a[60:63], v[76:79]
    v_mfma_f32_16x16x32_bf16 v[100:103], a[104:107], a[64:67], v[100:103]
    v_mfma_f32_16x16x32_bf16 v[124:127], a[104:107], a[68:71], v[124:127]
    v_mfma_f32_16x16x32_bf16 v[148:151], a[104:107], a[72:75], v[148:151]
    v_mfma_f32_16x16x32_bf16 v[172:175], a[104:107], a[76:79], v[172:175]
    v_mfma_f32_16x16x32_bf16 v[196:199], a[104:107], a[80:83], v[196:199]
    v_mfma_f32_16x16x32_bf16 v[220:223], a[104:107], a[84:87], v[220:223]
    v_mfma_f32_16x16x32_bf16 v[244:247], a[104:107], a[88:91], v[244:247]
    v_mfma_f32_16x16x32_bf16 v[80:83], a[108:111], a[60:63], v[80:83]
    v_mfma_f32_16x16x32_bf16 v[104:107], a[108:111], a[64:67], v[104:107]
    v_mfma_f32_16x16x32_bf16 v[128:131], a[108:111], a[68:71], v[128:131]
    v_mfma_f32_16x16x32_bf16 v[152:155], a[108:111], a[72:75], v[152:155]
    v_mfma_f32_16x16x32_bf16 v[176:179], a[108:111], a[76:79], v[176:179]
    v_mfma_f32_16x16x32_bf16 v[200:203], a[108:111], a[80:83], v[200:203]
    v_mfma_f32_16x16x32_bf16 v[224:227], a[108:111], a[84:87], v[224:227]
    v_mfma_f32_16x16x32_bf16 v[248:251], a[108:111], a[88:91], v[248:251]
    v_mfma_f32_16x16x32_bf16 v[84:87], a[112:115], a[60:63], v[84:87]
    v_mfma_f32_16x16x32_bf16 v[108:111], a[112:115], a[64:67], v[108:111]
    v_mfma_f32_16x16x32_bf16 v[132:135], a[112:115], a[68:71], v[132:135]
    v_mfma_f32_16x16x32_bf16 v[156:159], a[112:115], a[72:75], v[156:159]
    v_mfma_f32_16x16x32_bf16 v[180:183], a[112:115], a[76:79], v[180:183]
    v_mfma_f32_16x16x32_bf16 v[204:207], a[112:115], a[80:83], v[204:207]
    v_mfma_f32_16x16x32_bf16 v[228:231], a[112:115], a[84:87], v[228:231]
    v_mfma_f32_16x16x32_bf16 v[252:255], a[112:115], a[88:91], v[252:255]
    v_mfma_f32_16x16x32_bf16 a[128:131], a[116:119], a[60:63], a[128:131]
    v_mfma_f32_16x16x32_bf16 a[132:135], a[116:119], a[64:67], a[132:135]
    v_mfma_f32_16x16x32_bf16 a[136:139], a[116:119], a[68:71], a[136:139]
    v_mfma_f32_16x16x32_bf16 a[140:143], a[116:119], a[72:75], a[140:143]
    v_mfma_f32_16x16x32_bf16 a[144:147], a[116:119], a[76:79], a[144:147]
    v_mfma_f32_16x16x32_bf16 a[148:151], a[116:119], a[80:83], a[148:151]
    v_mfma_f32_16x16x32_bf16 a[152:155], a[116:119], a[84:87], a[152:155]
    v_mfma_f32_16x16x32_bf16 a[156:159], a[116:119], a[88:91], a[156:159]
gated_mix__linear_kernel_hedgehog__mixer_channel_mlp__prompt_kernel_mepi:
    s_waitcnt vmcnt(1)
    v_accvgpr_read_b32 v24, a160
    v_accvgpr_read_b32 v25, a161
    v_accvgpr_read_b32 v26, a162
    v_accvgpr_read_b32 v27, a163
    v_accvgpr_read_b32 v28, a164
    v_accvgpr_read_b32 v29, a165
    v_accvgpr_read_b32 v30, a166
    v_accvgpr_read_b32 v31, a167
    v_accvgpr_read_b32 v32, a168
    v_accvgpr_read_b32 v33, a169
    v_accvgpr_read_b32 v34, a170
    v_add_f32 v26, v26, v27
    v_add_f32 v28, v28, v29
    v_add_f32 v30, v30, v31
    v_add_f32 v32, v32, v33
    v_add_f32 v26, v26, v28
    v_add_f32 v30, v30, v32
    v_add_f32 v26, v26, v30
    v_lshlrev_b32 v34, 16, v34
    v_lshlrev_b32 v35, 2, v0
    v_lshlrev_b32 v36, 3, v0
    v_add_u32 v36, 124672, v36
    ds_write_b64 v36, v[24:25]
    v_add_u32 v35, 122880, v35
    v_cmp_gt_u32 vcc, 224, v0
    s_nop 1
    s_and_saveexec_b64 s[50:51], vcc
    ds_write_b32 v35, v26
    ds_write_b32 v35, v34 offset:896
    s_mov_b64 exec, s[50:51]
    s_waitcnt lgkmcnt(0)
    s_barrier
    s_mov_b32 s16, s52
    s_mov_b32 s17, s53
    s_mov_b32 s18, 18874368
    s_mov_b32 s19, 0x20000
    s_lshl_b32 s44, s35, 1
    s_add_u32 s44, s44, s33
    s_mul_i32 s44, s44, 144
    s_mul_i32 s45, s36, 7
    s_add_u32 s44, s44, s45
    s_mul_i32 s44, s44, 8192
    s_mul_i32 s45, s34, 32768
    s_add_u32 s45, s45, s44
    s_add_u32 s44, s44, 24576
    v_lshlrev_b32 v60, 4, v1
    s_lshl_b32 s46, s34, 3
    v_add_u32 v61, s46, v60
    s_mov_b32 s60, 0xbdd2d3e8
    s_mov_b32 s61, 0xbdd2d3e8
    v_mov_b32 v2, 0xc0135761
    v_mov_b32 v3, 0xc0135761
    v_and_b32 v24, 15, v1
    s_lshl_b32 s46, s33, 7
    v_add_u32 v24, s46, v24
    v_lshlrev_b32 v24, 3, v24
    v_add_u32 v24, 124672, v24
    v_lshrrev_b32 v62, 4, v1
    v_lshlrev_b32 v62, 4, v62
    v_add_u32 v62, 122880, v62
    s_lshl_b32 s46, s34, 9
    v_add_u32 v63, s46, v62
    s_add_u32 s46, s34, 6
    s_lshl_b32 s46, s46, 6
    v_add_u32 v62, s46, v62
    ds_read_b64 v[4:5], v24 offset:0
    ds_read_b64 v[6:7], v24 offset:128
    ds_read_b64 v[8:9], v24 offset:256
    ds_read_b64 v[10:11], v24 offset:384
    ds_read_b64 v[12:13], v24 offset:512
    ds_read_b64 v[14:15], v24 offset:640
    ds_read_b64 v[16:17], v24 offset:768
    ds_read_b64 v[18:19], v24 offset:896
    ds_read_b128 v[20:23], v62
    ds_read_b128 v[24:27], v62 offset:896
    s_waitcnt lgkmcnt(0)
    v_accvgpr_read_b32 v28, a128
    v_accvgpr_read_b32 v29, a129
    v_accvgpr_read_b32 v30, a130
    v_accvgpr_read_b32 v31, a131
    v_accvgpr_read_b32 v32, a132
    v_accvgpr_read_b32 v33, a133
    v_accvgpr_read_b32 v34, a134
    v_accvgpr_read_b32 v35, a135
    v_pk_fma_f32 v[36:37], v[20:21], v[4:5], v[24:25] op_sel:[0,1,0] op_sel_hi:[1,1,1]
    v_pk_fma_f32 v[40:41], v[22:23], v[4:5], v[26:27] op_sel:[0,1,0] op_sel_hi:[1,1,1]
    v_pk_fma_f32 v[36:37], v[28:29], v[4:5], v[36:37] op_sel_hi:[1,0,1]
    v_pk_fma_f32 v[40:41], v[30:31], v[4:5], v[40:41] op_sel_hi:[1,0,1]
    v_pk_mul_f32 v[38:39], v[36:37], v[36:37]
    v_pk_mul_f32 v[42:43], v[40:41], v[40:41]
    v_pk_fma_f32 v[38:39], v[38:39], s[60:61], v[2:3]
    v_pk_fma_f32 v[42:43], v[42:43], s[60:61], v[2:3]
    v_pk_mul_f32 v[38:39], v[38:39], v[36:37]
    v_pk_mul_f32 v[42:43], v[42:43], v[40:41]
    v_exp_f32 v38, v38
    v_exp_f32 v39, v39
    v_exp_f32 v42, v42
    v_exp_f32 v43, v43
    v_pk_add_f32 v[38:39], v[38:39], 1.0 op_sel_hi:[1,0]
    v_pk_add_f32 v[42:43], v[42:43], 1.0 op_sel_hi:[1,0]
    v_rcp_f32 v38, v38
    v_rcp_f32 v39, v39
    v_rcp_f32 v42, v42
    v_rcp_f32 v43, v43
    v_pk_mul_f32 v[36:37], v[36:37], v[38:39]
    v_pk_mul_f32 v[40:41], v[40:41], v[42:43]
    v_cvt_pk_bf16_f32 v52, v36, v37
    v_cvt_pk_bf16_f32 v53, v40, v41
    s_add_u32 s47, s44, 0
    buffer_store_dwordx2 v[52:53], v61, s[16:19], s47 offen sc1
    v_pk_fma_f32 v[44:45], v[20:21], v[6:7], v[24:25] op_sel:[0,1,0] op_sel_hi:[1,1,1]
    v_pk_fma_f32 v[48:49], v[22:23], v[6:7], v[26:27] op_sel:[0,1,0] op_sel_hi:[1,1,1]
    v_pk_fma_f32 v[44:45], v[32:33], v[6:7], v[44:45] op_sel_hi:[1,0,1]
    v_pk_fma_f32 v[48:49], v[34:35], v[6:7], v[48:49] op_sel_hi:[1,0,1]
    v_pk_mul_f32 v[46:47], v[44:45], v[44:45]
    v_pk_mul_f32 v[50:51], v[48:49], v[48:49]
    v_pk_fma_f32 v[46:47], v[46:47], s[60:61], v[2:3]
    v_pk_fma_f32 v[50:51], v[50:51], s[60:61], v[2:3]
    v_pk_mul_f32 v[46:47], v[46:47], v[44:45]
    v_pk_mul_f32 v[50:51], v[50:51], v[48:49]
    v_exp_f32 v46, v46
    v_exp_f32 v47, v47
    v_exp_f32 v50, v50
    v_exp_f32 v51, v51
    v_pk_add_f32 v[46:47], v[46:47], 1.0 op_sel_hi:[1,0]
    v_pk_add_f32 v[50:51], v[50:51], 1.0 op_sel_hi:[1,0]
    v_rcp_f32 v46, v46
    v_rcp_f32 v47, v47
    v_rcp_f32 v50, v50
    v_rcp_f32 v51, v51
    v_pk_mul_f32 v[44:45], v[44:45], v[46:47]
    v_pk_mul_f32 v[48:49], v[48:49], v[50:51]
    v_cvt_pk_bf16_f32 v54, v44, v45
    v_cvt_pk_bf16_f32 v55, v48, v49
    s_add_u32 s47, s44, 1024
    buffer_store_dwordx2 v[54:55], v61, s[16:19], s47 offen sc1
    v_accvgpr_read_b32 v28, a136
    v_accvgpr_read_b32 v29, a137
    v_accvgpr_read_b32 v30, a138
    v_accvgpr_read_b32 v31, a139
    v_accvgpr_read_b32 v32, a140
    v_accvgpr_read_b32 v33, a141
    v_accvgpr_read_b32 v34, a142
    v_accvgpr_read_b32 v35, a143
    v_pk_fma_f32 v[36:37], v[20:21], v[8:9], v[24:25] op_sel:[0,1,0] op_sel_hi:[1,1,1]
    v_pk_fma_f32 v[40:41], v[22:23], v[8:9], v[26:27] op_sel:[0,1,0] op_sel_hi:[1,1,1]
    v_pk_fma_f32 v[36:37], v[28:29], v[8:9], v[36:37] op_sel_hi:[1,0,1]
    v_pk_fma_f32 v[40:41], v[30:31], v[8:9], v[40:41] op_sel_hi:[1,0,1]
    v_pk_mul_f32 v[38:39], v[36:37], v[36:37]
    v_pk_mul_f32 v[42:43], v[40:41], v[40:41]
    v_pk_fma_f32 v[38:39], v[38:39], s[60:61], v[2:3]
    v_pk_fma_f32 v[42:43], v[42:43], s[60:61], v[2:3]
    v_pk_mul_f32 v[38:39], v[38:39], v[36:37]
    v_pk_mul_f32 v[42:43], v[42:43], v[40:41]
    v_exp_f32 v38, v38
    v_exp_f32 v39, v39
    v_exp_f32 v42, v42
    v_exp_f32 v43, v43
    v_pk_add_f32 v[38:39], v[38:39], 1.0 op_sel_hi:[1,0]
    v_pk_add_f32 v[42:43], v[42:43], 1.0 op_sel_hi:[1,0]
    v_rcp_f32 v38, v38
    v_rcp_f32 v39, v39
    v_rcp_f32 v42, v42
    v_rcp_f32 v43, v43
    v_pk_mul_f32 v[36:37], v[36:37], v[38:39]
    v_pk_mul_f32 v[40:41], v[40:41], v[42:43]
    v_cvt_pk_bf16_f32 v56, v36, v37
    v_cvt_pk_bf16_f32 v57, v40, v41
    s_add_u32 s47, s44, 2048
    buffer_store_dwordx2 v[56:57], v61, s[16:19], s47 offen sc1
    v_pk_fma_f32 v[44:45], v[20:21], v[10:11], v[24:25] op_sel:[0,1,0] op_sel_hi:[1,1,1]
    v_pk_fma_f32 v[48:49], v[22:23], v[10:11], v[26:27] op_sel:[0,1,0] op_sel_hi:[1,1,1]
    v_pk_fma_f32 v[44:45], v[32:33], v[10:11], v[44:45] op_sel_hi:[1,0,1]
    v_pk_fma_f32 v[48:49], v[34:35], v[10:11], v[48:49] op_sel_hi:[1,0,1]
    v_pk_mul_f32 v[46:47], v[44:45], v[44:45]
    v_pk_mul_f32 v[50:51], v[48:49], v[48:49]
    v_pk_fma_f32 v[46:47], v[46:47], s[60:61], v[2:3]
    v_pk_fma_f32 v[50:51], v[50:51], s[60:61], v[2:3]
    v_pk_mul_f32 v[46:47], v[46:47], v[44:45]
    v_pk_mul_f32 v[50:51], v[50:51], v[48:49]
    v_exp_f32 v46, v46
    v_exp_f32 v47, v47
    v_exp_f32 v50, v50
    v_exp_f32 v51, v51
    v_pk_add_f32 v[46:47], v[46:47], 1.0 op_sel_hi:[1,0]
    v_pk_add_f32 v[50:51], v[50:51], 1.0 op_sel_hi:[1,0]
    v_rcp_f32 v46, v46
    v_rcp_f32 v47, v47
    v_rcp_f32 v50, v50
    v_rcp_f32 v51, v51
    v_pk_mul_f32 v[44:45], v[44:45], v[46:47]
    v_pk_mul_f32 v[48:49], v[48:49], v[50:51]
    v_cvt_pk_bf16_f32 v58, v44, v45
    v_cvt_pk_bf16_f32 v59, v48, v49
    s_add_u32 s47, s44, 3072
    buffer_store_dwordx2 v[58:59], v61, s[16:19], s47 offen sc1
    v_accvgpr_read_b32 v28, a144
    v_accvgpr_read_b32 v29, a145
    v_accvgpr_read_b32 v30, a146
    v_accvgpr_read_b32 v31, a147
    v_accvgpr_read_b32 v32, a148
    v_accvgpr_read_b32 v33, a149
    v_accvgpr_read_b32 v34, a150
    v_accvgpr_read_b32 v35, a151
    v_pk_fma_f32 v[36:37], v[20:21], v[12:13], v[24:25] op_sel:[0,1,0] op_sel_hi:[1,1,1]
    v_pk_fma_f32 v[40:41], v[22:23], v[12:13], v[26:27] op_sel:[0,1,0] op_sel_hi:[1,1,1]
    v_pk_fma_f32 v[36:37], v[28:29], v[12:13], v[36:37] op_sel_hi:[1,0,1]
    v_pk_fma_f32 v[40:41], v[30:31], v[12:13], v[40:41] op_sel_hi:[1,0,1]
    v_pk_mul_f32 v[38:39], v[36:37], v[36:37]
    v_pk_mul_f32 v[42:43], v[40:41], v[40:41]
    v_pk_fma_f32 v[38:39], v[38:39], s[60:61], v[2:3]
    v_pk_fma_f32 v[42:43], v[42:43], s[60:61], v[2:3]
    v_pk_mul_f32 v[38:39], v[38:39], v[36:37]
    v_pk_mul_f32 v[42:43], v[42:43], v[40:41]
    v_exp_f32 v38, v38
    v_exp_f32 v39, v39
    v_exp_f32 v42, v42
    v_exp_f32 v43, v43
    v_pk_add_f32 v[38:39], v[38:39], 1.0 op_sel_hi:[1,0]
    v_pk_add_f32 v[42:43], v[42:43], 1.0 op_sel_hi:[1,0]
    v_rcp_f32 v38, v38
    v_rcp_f32 v39, v39
    v_rcp_f32 v42, v42
    v_rcp_f32 v43, v43
    v_pk_mul_f32 v[36:37], v[36:37], v[38:39]
    v_pk_mul_f32 v[40:41], v[40:41], v[42:43]
    v_cvt_pk_bf16_f32 v52, v36, v37
    v_cvt_pk_bf16_f32 v53, v40, v41
    s_add_u32 s47, s44, 4096
    buffer_store_dwordx2 v[52:53], v61, s[16:19], s47 offen sc1
    v_pk_fma_f32 v[44:45], v[20:21], v[14:15], v[24:25] op_sel:[0,1,0] op_sel_hi:[1,1,1]
    v_pk_fma_f32 v[48:49], v[22:23], v[14:15], v[26:27] op_sel:[0,1,0] op_sel_hi:[1,1,1]
    v_pk_fma_f32 v[44:45], v[32:33], v[14:15], v[44:45] op_sel_hi:[1,0,1]
    v_pk_fma_f32 v[48:49], v[34:35], v[14:15], v[48:49] op_sel_hi:[1,0,1]
    v_pk_mul_f32 v[46:47], v[44:45], v[44:45]
    v_pk_mul_f32 v[50:51], v[48:49], v[48:49]
    v_pk_fma_f32 v[46:47], v[46:47], s[60:61], v[2:3]
    v_pk_fma_f32 v[50:51], v[50:51], s[60:61], v[2:3]
    v_pk_mul_f32 v[46:47], v[46:47], v[44:45]
    v_pk_mul_f32 v[50:51], v[50:51], v[48:49]
    v_exp_f32 v46, v46
    v_exp_f32 v47, v47
    v_exp_f32 v50, v50
    v_exp_f32 v51, v51
    v_pk_add_f32 v[46:47], v[46:47], 1.0 op_sel_hi:[1,0]
    v_pk_add_f32 v[50:51], v[50:51], 1.0 op_sel_hi:[1,0]
    v_rcp_f32 v46, v46
    v_rcp_f32 v47, v47
    v_rcp_f32 v50, v50
    v_rcp_f32 v51, v51
    v_pk_mul_f32 v[44:45], v[44:45], v[46:47]
    v_pk_mul_f32 v[48:49], v[48:49], v[50:51]
    v_cvt_pk_bf16_f32 v54, v44, v45
    v_cvt_pk_bf16_f32 v55, v48, v49
    s_add_u32 s47, s44, 5120
    buffer_store_dwordx2 v[54:55], v61, s[16:19], s47 offen sc1
    v_accvgpr_read_b32 v28, a152
    v_accvgpr_read_b32 v29, a153
    v_accvgpr_read_b32 v30, a154
    v_accvgpr_read_b32 v31, a155
    v_accvgpr_read_b32 v32, a156
    v_accvgpr_read_b32 v33, a157
    v_accvgpr_read_b32 v34, a158
    v_accvgpr_read_b32 v35, a159
    v_pk_fma_f32 v[36:37], v[20:21], v[16:17], v[24:25] op_sel:[0,1,0] op_sel_hi:[1,1,1]
    v_pk_fma_f32 v[40:41], v[22:23], v[16:17], v[26:27] op_sel:[0,1,0] op_sel_hi:[1,1,1]
    v_pk_fma_f32 v[36:37], v[28:29], v[16:17], v[36:37] op_sel_hi:[1,0,1]
    v_pk_fma_f32 v[40:41], v[30:31], v[16:17], v[40:41] op_sel_hi:[1,0,1]
    v_pk_mul_f32 v[38:39], v[36:37], v[36:37]
    v_pk_mul_f32 v[42:43], v[40:41], v[40:41]
    v_pk_fma_f32 v[38:39], v[38:39], s[60:61], v[2:3]
    v_pk_fma_f32 v[42:43], v[42:43], s[60:61], v[2:3]
    v_pk_mul_f32 v[38:39], v[38:39], v[36:37]
    v_pk_mul_f32 v[42:43], v[42:43], v[40:41]
    v_exp_f32 v38, v38
    v_exp_f32 v39, v39
    v_exp_f32 v42, v42
    v_exp_f32 v43, v43
    v_pk_add_f32 v[38:39], v[38:39], 1.0 op_sel_hi:[1,0]
    v_pk_add_f32 v[42:43], v[42:43], 1.0 op_sel_hi:[1,0]
    v_rcp_f32 v38, v38
    v_rcp_f32 v39, v39
    v_rcp_f32 v42, v42
    v_rcp_f32 v43, v43
    v_pk_mul_f32 v[36:37], v[36:37], v[38:39]
    v_pk_mul_f32 v[40:41], v[40:41], v[42:43]
    v_cvt_pk_bf16_f32 v56, v36, v37
    v_cvt_pk_bf16_f32 v57, v40, v41
    s_add_u32 s47, s44, 6144
    buffer_store_dwordx2 v[56:57], v61, s[16:19], s47 offen sc1
    v_pk_fma_f32 v[44:45], v[20:21], v[18:19], v[24:25] op_sel:[0,1,0] op_sel_hi:[1,1,1]
    v_pk_fma_f32 v[48:49], v[22:23], v[18:19], v[26:27] op_sel:[0,1,0] op_sel_hi:[1,1,1]
    v_pk_fma_f32 v[44:45], v[32:33], v[18:19], v[44:45] op_sel_hi:[1,0,1]
    v_pk_fma_f32 v[48:49], v[34:35], v[18:19], v[48:49] op_sel_hi:[1,0,1]
    v_pk_mul_f32 v[46:47], v[44:45], v[44:45]
    v_pk_mul_f32 v[50:51], v[48:49], v[48:49]
    v_pk_fma_f32 v[46:47], v[46:47], s[60:61], v[2:3]
    v_pk_fma_f32 v[50:51], v[50:51], s[60:61], v[2:3]
    v_pk_mul_f32 v[46:47], v[46:47], v[44:45]
    v_pk_mul_f32 v[50:51], v[50:51], v[48:49]
    v_exp_f32 v46, v46
    v_exp_f32 v47, v47
    v_exp_f32 v50, v50
    v_exp_f32 v51, v51
    v_pk_add_f32 v[46:47], v[46:47], 1.0 op_sel_hi:[1,0]
    v_pk_add_f32 v[50:51], v[50:51], 1.0 op_sel_hi:[1,0]
    v_rcp_f32 v46, v46
    v_rcp_f32 v47, v47
    v_rcp_f32 v50, v50
    v_rcp_f32 v51, v51
    v_pk_mul_f32 v[44:45], v[44:45], v[46:47]
    v_pk_mul_f32 v[48:49], v[48:49], v[50:51]
    v_cvt_pk_bf16_f32 v58, v44, v45
    v_cvt_pk_bf16_f32 v59, v48, v49
    s_add_u32 s47, s44, 7168
    buffer_store_dwordx2 v[58:59], v61, s[16:19], s47 offen sc1
    ds_read_b128 v[20:23], v63 offset:0
    ds_read_b128 v[24:27], v63 offset:896
    ds_read_b128 v[28:31], v63 offset:64
    ds_read_b128 v[32:35], v63 offset:960
    s_waitcnt lgkmcnt(0)
    v_pk_fma_f32 v[36:37], v[20:21], v[4:5], v[24:25] op_sel:[0,1,0] op_sel_hi:[1,1,1]
    v_pk_fma_f32 v[40:41], v[22:23], v[4:5], v[26:27] op_sel:[0,1,0] op_sel_hi:[1,1,1]
    v_pk_fma_f32 v[44:45], v[28:29], v[4:5], v[32:33] op_sel:[0,1,0] op_sel_hi:[1,1,1]
    v_pk_fma_f32 v[48:49], v[30:31], v[4:5], v[34:35] op_sel:[0,1,0] op_sel_hi:[1,1,1]
    v_pk_fma_f32 v[36:37], v[64:65], v[4:5], v[36:37] op_sel_hi:[1,0,1]
    v_pk_fma_f32 v[40:41], v[66:67], v[4:5], v[40:41] op_sel_hi:[1,0,1]
    v_pk_fma_f32 v[44:45], v[68:69], v[4:5], v[44:45] op_sel_hi:[1,0,1]
    v_pk_fma_f32 v[48:49], v[70:71], v[4:5], v[48:49] op_sel_hi:[1,0,1]
    v_pk_mul_f32 v[38:39], v[36:37], v[36:37]
    v_pk_mul_f32 v[42:43], v[40:41], v[40:41]
    v_pk_mul_f32 v[46:47], v[44:45], v[44:45]
    v_pk_mul_f32 v[50:51], v[48:49], v[48:49]
    v_pk_fma_f32 v[38:39], v[38:39], s[60:61], v[2:3]
    v_pk_fma_f32 v[42:43], v[42:43], s[60:61], v[2:3]
    v_pk_fma_f32 v[46:47], v[46:47], s[60:61], v[2:3]
    v_pk_fma_f32 v[50:51], v[50:51], s[60:61], v[2:3]
    v_pk_mul_f32 v[38:39], v[38:39], v[36:37]
    v_pk_mul_f32 v[42:43], v[42:43], v[40:41]
    v_pk_mul_f32 v[46:47], v[46:47], v[44:45]
    v_pk_mul_f32 v[50:51], v[50:51], v[48:49]
    v_exp_f32 v38, v38
    v_exp_f32 v39, v39
    v_exp_f32 v42, v42
    v_exp_f32 v43, v43
    v_exp_f32 v46, v46
    v_exp_f32 v47, v47
    v_exp_f32 v50, v50
    v_exp_f32 v51, v51
    v_pk_add_f32 v[38:39], v[38:39], 1.0 op_sel_hi:[1,0]
    v_pk_add_f32 v[42:43], v[42:43], 1.0 op_sel_hi:[1,0]
    v_pk_add_f32 v[46:47], v[46:47], 1.0 op_sel_hi:[1,0]
    v_pk_add_f32 v[50:51], v[50:51], 1.0 op_sel_hi:[1,0]
    v_rcp_f32 v38, v38
    v_rcp_f32 v39, v39
    v_rcp_f32 v42, v42
    v_rcp_f32 v43, v43
    v_rcp_f32 v46, v46
    v_rcp_f32 v47, v47
    v_rcp_f32 v50, v50
    v_rcp_f32 v51, v51
    v_pk_mul_f32 v[36:37], v[36:37], v[38:39]
    v_pk_mul_f32 v[40:41], v[40:41], v[42:43]
    v_pk_mul_f32 v[44:45], v[44:45], v[46:47]
    v_pk_mul_f32 v[48:49], v[48:49], v[50:51]
    v_cvt_pk_bf16_f32 v52, v36, v37
    v_cvt_pk_bf16_f32 v53, v40, v41
    v_cvt_pk_bf16_f32 v54, v44, v45
    v_cvt_pk_bf16_f32 v55, v48, v49
    s_add_u32 s47, s45, 0
    buffer_store_dwordx4 v[52:55], v60, s[16:19], s47 offen sc1
    v_pk_fma_f32 v[36:37], v[20:21], v[6:7], v[24:25] op_sel:[0,1,0] op_sel_hi:[1,1,1]
    v_pk_fma_f32 v[40:41], v[22:23], v[6:7], v[26:27] op_sel:[0,1,0] op_sel_hi:[1,1,1]
    v_pk_fma_f32 v[44:45], v[28:29], v[6:7], v[32:33] op_sel:[0,1,0] op_sel_hi:[1,1,1]
    v_pk_fma_f32 v[48:49], v[30:31], v[6:7], v[34:35] op_sel:[0,1,0] op_sel_hi:[1,1,1]
    v_pk_fma_f32 v[36:37], v[88:89], v[6:7], v[36:37] op_sel_hi:[1,0,1]
    v_pk_fma_f32 v[40:41], v[90:91], v[6:7], v[40:41] op_sel_hi:[1,0,1]
    v_pk_fma_f32 v[44:45], v[92:93], v[6:7], v[44:45] op_sel_hi:[1,0,1]
    v_pk_fma_f32 v[48:49], v[94:95], v[6:7], v[48:49] op_sel_hi:[1,0,1]
    v_pk_mul_f32 v[38:39], v[36:37], v[36:37]
    v_pk_mul_f32 v[42:43], v[40:41], v[40:41]
    v_pk_mul_f32 v[46:47], v[44:45], v[44:45]
    v_pk_mul_f32 v[50:51], v[48:49], v[48:49]
    v_pk_fma_f32 v[38:39], v[38:39], s[60:61], v[2:3]
    v_pk_fma_f32 v[42:43], v[42:43], s[60:61], v[2:3]
    v_pk_fma_f32 v[46:47], v[46:47], s[60:61], v[2:3]
    v_pk_fma_f32 v[50:51], v[50:51], s[60:61], v[2:3]
    v_pk_mul_f32 v[38:39], v[38:39], v[36:37]
    v_pk_mul_f32 v[42:43], v[42:43], v[40:41]
    v_pk_mul_f32 v[46:47], v[46:47], v[44:45]
    v_pk_mul_f32 v[50:51], v[50:51], v[48:49]
    v_exp_f32 v38, v38
    v_exp_f32 v39, v39
    v_exp_f32 v42, v42
    v_exp_f32 v43, v43
    v_exp_f32 v46, v46
    v_exp_f32 v47, v47
    v_exp_f32 v50, v50
    v_exp_f32 v51, v51
    v_pk_add_f32 v[38:39], v[38:39], 1.0 op_sel_hi:[1,0]
    v_pk_add_f32 v[42:43], v[42:43], 1.0 op_sel_hi:[1,0]
    v_pk_add_f32 v[46:47], v[46:47], 1.0 op_sel_hi:[1,0]
    v_pk_add_f32 v[50:51], v[50:51], 1.0 op_sel_hi:[1,0]
    v_rcp_f32 v38, v38
    v_rcp_f32 v39, v39
    v_rcp_f32 v42, v42
    v_rcp_f32 v43, v43
    v_rcp_f32 v46, v46
    v_rcp_f32 v47, v47
    v_rcp_f32 v50, v50
    v_rcp_f32 v51, v51
    v_pk_mul_f32 v[36:37], v[36:37], v[38:39]
    v_pk_mul_f32 v[40:41], v[40:41], v[42:43]
    v_pk_mul_f32 v[44:45], v[44:45], v[46:47]
    v_pk_mul_f32 v[48:49], v[48:49], v[50:51]
    v_cvt_pk_bf16_f32 v56, v36, v37
    v_cvt_pk_bf16_f32 v57, v40, v41
    v_cvt_pk_bf16_f32 v58, v44, v45
    v_cvt_pk_bf16_f32 v59, v48, v49
    s_add_u32 s47, s45, 1024
    buffer_store_dwordx4 v[56:59], v60, s[16:19], s47 offen sc1
    v_pk_fma_f32 v[36:37], v[20:21], v[8:9], v[24:25] op_sel:[0,1,0] op_sel_hi:[1,1,1]
    v_pk_fma_f32 v[40:41], v[22:23], v[8:9], v[26:27] op_sel:[0,1,0] op_sel_hi:[1,1,1]
    v_pk_fma_f32 v[44:45], v[28:29], v[8:9], v[32:33] op_sel:[0,1,0] op_sel_hi:[1,1,1]
    v_pk_fma_f32 v[48:49], v[30:31], v[8:9], v[34:35] op_sel:[0,1,0] op_sel_hi:[1,1,1]
    v_pk_fma_f32 v[36:37], v[112:113], v[8:9], v[36:37] op_sel_hi:[1,0,1]
    v_pk_fma_f32 v[40:41], v[114:115], v[8:9], v[40:41] op_sel_hi:[1,0,1]
    v_pk_fma_f32 v[44:45], v[116:117], v[8:9], v[44:45] op_sel_hi:[1,0,1]
    v_pk_fma_f32 v[48:49], v[118:119], v[8:9], v[48:49] op_sel_hi:[1,0,1]
    v_pk_mul_f32 v[38:39], v[36:37], v[36:37]
    v_pk_mul_f32 v[42:43], v[40:41], v[40:41]
    v_pk_mul_f32 v[46:47], v[44:45], v[44:45]
    v_pk_mul_f32 v[50:51], v[48:49], v[48:49]
    v_pk_fma_f32 v[38:39], v[38:39], s[60:61], v[2:3]
    v_pk_fma_f32 v[42:43], v[42:43], s[60:61], v[2:3]
    v_pk_fma_f32 v[46:47], v[46:47], s[60:61], v[2:3]
    v_pk_fma_f32 v[50:51], v[50:51], s[60:61], v[2:3]
    v_pk_mul_f32 v[38:39], v[38:39], v[36:37]
    v_pk_mul_f32 v[42:43], v[42:43], v[40:41]
    v_pk_mul_f32 v[46:47], v[46:47], v[44:45]
    v_pk_mul_f32 v[50:51], v[50:51], v[48:49]
    v_exp_f32 v38, v38
    v_exp_f32 v39, v39
    v_exp_f32 v42, v42
    v_exp_f32 v43, v43
    v_exp_f32 v46, v46
    v_exp_f32 v47, v47
    v_exp_f32 v50, v50
    v_exp_f32 v51, v51
    v_pk_add_f32 v[38:39], v[38:39], 1.0 op_sel_hi:[1,0]
    v_pk_add_f32 v[42:43], v[42:43], 1.0 op_sel_hi:[1,0]
    v_pk_add_f32 v[46:47], v[46:47], 1.0 op_sel_hi:[1,0]
    v_pk_add_f32 v[50:51], v[50:51], 1.0 op_sel_hi:[1,0]
    v_rcp_f32 v38, v38
    v_rcp_f32 v39, v39
    v_rcp_f32 v42, v42
    v_rcp_f32 v43, v43
    v_rcp_f32 v46, v46
    v_rcp_f32 v47, v47
    v_rcp_f32 v50, v50
    v_rcp_f32 v51, v51
    v_pk_mul_f32 v[36:37], v[36:37], v[38:39]
    v_pk_mul_f32 v[40:41], v[40:41], v[42:43]
    v_pk_mul_f32 v[44:45], v[44:45], v[46:47]
    v_pk_mul_f32 v[48:49], v[48:49], v[50:51]
    v_cvt_pk_bf16_f32 v52, v36, v37
    v_cvt_pk_bf16_f32 v53, v40, v41
    v_cvt_pk_bf16_f32 v54, v44, v45
    v_cvt_pk_bf16_f32 v55, v48, v49
    s_add_u32 s47, s45, 2048
    buffer_store_dwordx4 v[52:55], v60, s[16:19], s47 offen sc1
    v_pk_fma_f32 v[36:37], v[20:21], v[10:11], v[24:25] op_sel:[0,1,0] op_sel_hi:[1,1,1]
    v_pk_fma_f32 v[40:41], v[22:23], v[10:11], v[26:27] op_sel:[0,1,0] op_sel_hi:[1,1,1]
    v_pk_fma_f32 v[44:45], v[28:29], v[10:11], v[32:33] op_sel:[0,1,0] op_sel_hi:[1,1,1]
    v_pk_fma_f32 v[48:49], v[30:31], v[10:11], v[34:35] op_sel:[0,1,0] op_sel_hi:[1,1,1]
    v_pk_fma_f32 v[36:37], v[136:137], v[10:11], v[36:37] op_sel_hi:[1,0,1]
    v_pk_fma_f32 v[40:41], v[138:139], v[10:11], v[40:41] op_sel_hi:[1,0,1]
    v_pk_fma_f32 v[44:45], v[140:141], v[10:11], v[44:45] op_sel_hi:[1,0,1]
    v_pk_fma_f32 v[48:49], v[142:143], v[10:11], v[48:49] op_sel_hi:[1,0,1]
    v_pk_mul_f32 v[38:39], v[36:37], v[36:37]
    v_pk_mul_f32 v[42:43], v[40:41], v[40:41]
    v_pk_mul_f32 v[46:47], v[44:45], v[44:45]
    v_pk_mul_f32 v[50:51], v[48:49], v[48:49]
    v_pk_fma_f32 v[38:39], v[38:39], s[60:61], v[2:3]
    v_pk_fma_f32 v[42:43], v[42:43], s[60:61], v[2:3]
    v_pk_fma_f32 v[46:47], v[46:47], s[60:61], v[2:3]
    v_pk_fma_f32 v[50:51], v[50:51], s[60:61], v[2:3]
    v_pk_mul_f32 v[38:39], v[38:39], v[36:37]
    v_pk_mul_f32 v[42:43], v[42:43], v[40:41]
    v_pk_mul_f32 v[46:47], v[46:47], v[44:45]
    v_pk_mul_f32 v[50:51], v[50:51], v[48:49]
    v_exp_f32 v38, v38
    v_exp_f32 v39, v39
    v_exp_f32 v42, v42
    v_exp_f32 v43, v43
    v_exp_f32 v46, v46
    v_exp_f32 v47, v47
    v_exp_f32 v50, v50
    v_exp_f32 v51, v51
    v_pk_add_f32 v[38:39], v[38:39], 1.0 op_sel_hi:[1,0]
    v_pk_add_f32 v[42:43], v[42:43], 1.0 op_sel_hi:[1,0]
    v_pk_add_f32 v[46:47], v[46:47], 1.0 op_sel_hi:[1,0]
    v_pk_add_f32 v[50:51], v[50:51], 1.0 op_sel_hi:[1,0]
    v_rcp_f32 v38, v38
    v_rcp_f32 v39, v39
    v_rcp_f32 v42, v42
    v_rcp_f32 v43, v43
    v_rcp_f32 v46, v46
    v_rcp_f32 v47, v47
    v_rcp_f32 v50, v50
    v_rcp_f32 v51, v51
    v_pk_mul_f32 v[36:37], v[36:37], v[38:39]
    v_pk_mul_f32 v[40:41], v[40:41], v[42:43]
    v_pk_mul_f32 v[44:45], v[44:45], v[46:47]
    v_pk_mul_f32 v[48:49], v[48:49], v[50:51]
    v_cvt_pk_bf16_f32 v56, v36, v37
    v_cvt_pk_bf16_f32 v57, v40, v41
    v_cvt_pk_bf16_f32 v58, v44, v45
    v_cvt_pk_bf16_f32 v59, v48, v49
    s_add_u32 s47, s45, 3072
    buffer_store_dwordx4 v[56:59], v60, s[16:19], s47 offen sc1
    v_pk_fma_f32 v[36:37], v[20:21], v[12:13], v[24:25] op_sel:[0,1,0] op_sel_hi:[1,1,1]
    v_pk_fma_f32 v[40:41], v[22:23], v[12:13], v[26:27] op_sel:[0,1,0] op_sel_hi:[1,1,1]
    v_pk_fma_f32 v[44:45], v[28:29], v[12:13], v[32:33] op_sel:[0,1,0] op_sel_hi:[1,1,1]
    v_pk_fma_f32 v[48:49], v[30:31], v[12:13], v[34:35] op_sel:[0,1,0] op_sel_hi:[1,1,1]
    v_pk_fma_f32 v[36:37], v[160:161], v[12:13], v[36:37] op_sel_hi:[1,0,1]
    v_pk_fma_f32 v[40:41], v[162:163], v[12:13], v[40:41] op_sel_hi:[1,0,1]
    v_pk_fma_f32 v[44:45], v[164:165], v[12:13], v[44:45] op_sel_hi:[1,0,1]
    v_pk_fma_f32 v[48:49], v[166:167], v[12:13], v[48:49] op_sel_hi:[1,0,1]
    v_pk_mul_f32 v[38:39], v[36:37], v[36:37]
    v_pk_mul_f32 v[42:43], v[40:41], v[40:41]
    v_pk_mul_f32 v[46:47], v[44:45], v[44:45]
    v_pk_mul_f32 v[50:51], v[48:49], v[48:49]
    v_pk_fma_f32 v[38:39], v[38:39], s[60:61], v[2:3]
    v_pk_fma_f32 v[42:43], v[42:43], s[60:61], v[2:3]
    v_pk_fma_f32 v[46:47], v[46:47], s[60:61], v[2:3]
    v_pk_fma_f32 v[50:51], v[50:51], s[60:61], v[2:3]
    v_pk_mul_f32 v[38:39], v[38:39], v[36:37]
    v_pk_mul_f32 v[42:43], v[42:43], v[40:41]
    v_pk_mul_f32 v[46:47], v[46:47], v[44:45]
    v_pk_mul_f32 v[50:51], v[50:51], v[48:49]
    v_exp_f32 v38, v38
    v_exp_f32 v39, v39
    v_exp_f32 v42, v42
    v_exp_f32 v43, v43
    v_exp_f32 v46, v46
    v_exp_f32 v47, v47
    v_exp_f32 v50, v50
    v_exp_f32 v51, v51
    v_pk_add_f32 v[38:39], v[38:39], 1.0 op_sel_hi:[1,0]
    v_pk_add_f32 v[42:43], v[42:43], 1.0 op_sel_hi:[1,0]
    v_pk_add_f32 v[46:47], v[46:47], 1.0 op_sel_hi:[1,0]
    v_pk_add_f32 v[50:51], v[50:51], 1.0 op_sel_hi:[1,0]
    v_rcp_f32 v38, v38
    v_rcp_f32 v39, v39
    v_rcp_f32 v42, v42
    v_rcp_f32 v43, v43
    v_rcp_f32 v46, v46
    v_rcp_f32 v47, v47
    v_rcp_f32 v50, v50
    v_rcp_f32 v51, v51
    v_pk_mul_f32 v[36:37], v[36:37], v[38:39]
    v_pk_mul_f32 v[40:41], v[40:41], v[42:43]
    v_pk_mul_f32 v[44:45], v[44:45], v[46:47]
    v_pk_mul_f32 v[48:49], v[48:49], v[50:51]
    v_cvt_pk_bf16_f32 v52, v36, v37
    v_cvt_pk_bf16_f32 v53, v40, v41
    v_cvt_pk_bf16_f32 v54, v44, v45
    v_cvt_pk_bf16_f32 v55, v48, v49
    s_add_u32 s47, s45, 4096
    buffer_store_dwordx4 v[52:55], v60, s[16:19], s47 offen sc1
    v_pk_fma_f32 v[36:37], v[20:21], v[14:15], v[24:25] op_sel:[0,1,0] op_sel_hi:[1,1,1]
    v_pk_fma_f32 v[40:41], v[22:23], v[14:15], v[26:27] op_sel:[0,1,0] op_sel_hi:[1,1,1]
    v_pk_fma_f32 v[44:45], v[28:29], v[14:15], v[32:33] op_sel:[0,1,0] op_sel_hi:[1,1,1]
    v_pk_fma_f32 v[48:49], v[30:31], v[14:15], v[34:35] op_sel:[0,1,0] op_sel_hi:[1,1,1]
    v_pk_fma_f32 v[36:37], v[184:185], v[14:15], v[36:37] op_sel_hi:[1,0,1]
    v_pk_fma_f32 v[40:41], v[186:187], v[14:15], v[40:41] op_sel_hi:[1,0,1]
    v_pk_fma_f32 v[44:45], v[188:189], v[14:15], v[44:45] op_sel_hi:[1,0,1]
    v_pk_fma_f32 v[48:49], v[190:191], v[14:15], v[48:49] op_sel_hi:[1,0,1]
    v_pk_mul_f32 v[38:39], v[36:37], v[36:37]
    v_pk_mul_f32 v[42:43], v[40:41], v[40:41]
    v_pk_mul_f32 v[46:47], v[44:45], v[44:45]
    v_pk_mul_f32 v[50:51], v[48:49], v[48:49]
    v_pk_fma_f32 v[38:39], v[38:39], s[60:61], v[2:3]
    v_pk_fma_f32 v[42:43], v[42:43], s[60:61], v[2:3]
    v_pk_fma_f32 v[46:47], v[46:47], s[60:61], v[2:3]
    v_pk_fma_f32 v[50:51], v[50:51], s[60:61], v[2:3]
    v_pk_mul_f32 v[38:39], v[38:39], v[36:37]
    v_pk_mul_f32 v[42:43], v[42:43], v[40:41]
    v_pk_mul_f32 v[46:47], v[46:47], v[44:45]
    v_pk_mul_f32 v[50:51], v[50:51], v[48:49]
    v_exp_f32 v38, v38
    v_exp_f32 v39, v39
    v_exp_f32 v42, v42
    v_exp_f32 v43, v43
    v_exp_f32 v46, v46
    v_exp_f32 v47, v47
    v_exp_f32 v50, v50
    v_exp_f32 v51, v51
    v_pk_add_f32 v[38:39], v[38:39], 1.0 op_sel_hi:[1,0]
    v_pk_add_f32 v[42:43], v[42:43], 1.0 op_sel_hi:[1,0]
    v_pk_add_f32 v[46:47], v[46:47], 1.0 op_sel_hi:[1,0]
    v_pk_add_f32 v[50:51], v[50:51], 1.0 op_sel_hi:[1,0]
    v_rcp_f32 v38, v38
    v_rcp_f32 v39, v39
    v_rcp_f32 v42, v42
    v_rcp_f32 v43, v43
    v_rcp_f32 v46, v46
    v_rcp_f32 v47, v47
    v_rcp_f32 v50, v50
    v_rcp_f32 v51, v51
    v_pk_mul_f32 v[36:37], v[36:37], v[38:39]
    v_pk_mul_f32 v[40:41], v[40:41], v[42:43]
    v_pk_mul_f32 v[44:45], v[44:45], v[46:47]
    v_pk_mul_f32 v[48:49], v[48:49], v[50:51]
    v_cvt_pk_bf16_f32 v56, v36, v37
    v_cvt_pk_bf16_f32 v57, v40, v41
    v_cvt_pk_bf16_f32 v58, v44, v45
    v_cvt_pk_bf16_f32 v59, v48, v49
    s_add_u32 s47, s45, 5120
    buffer_store_dwordx4 v[56:59], v60, s[16:19], s47 offen sc1
    v_pk_fma_f32 v[36:37], v[20:21], v[16:17], v[24:25] op_sel:[0,1,0] op_sel_hi:[1,1,1]
    v_pk_fma_f32 v[40:41], v[22:23], v[16:17], v[26:27] op_sel:[0,1,0] op_sel_hi:[1,1,1]
    v_pk_fma_f32 v[44:45], v[28:29], v[16:17], v[32:33] op_sel:[0,1,0] op_sel_hi:[1,1,1]
    v_pk_fma_f32 v[48:49], v[30:31], v[16:17], v[34:35] op_sel:[0,1,0] op_sel_hi:[1,1,1]
    v_pk_fma_f32 v[36:37], v[208:209], v[16:17], v[36:37] op_sel_hi:[1,0,1]
    v_pk_fma_f32 v[40:41], v[210:211], v[16:17], v[40:41] op_sel_hi:[1,0,1]
    v_pk_fma_f32 v[44:45], v[212:213], v[16:17], v[44:45] op_sel_hi:[1,0,1]
    v_pk_fma_f32 v[48:49], v[214:215], v[16:17], v[48:49] op_sel_hi:[1,0,1]
    v_pk_mul_f32 v[38:39], v[36:37], v[36:37]
    v_pk_mul_f32 v[42:43], v[40:41], v[40:41]
    v_pk_mul_f32 v[46:47], v[44:45], v[44:45]
    v_pk_mul_f32 v[50:51], v[48:49], v[48:49]
    v_pk_fma_f32 v[38:39], v[38:39], s[60:61], v[2:3]
    v_pk_fma_f32 v[42:43], v[42:43], s[60:61], v[2:3]
    v_pk_fma_f32 v[46:47], v[46:47], s[60:61], v[2:3]
    v_pk_fma_f32 v[50:51], v[50:51], s[60:61], v[2:3]
    v_pk_mul_f32 v[38:39], v[38:39], v[36:37]
    v_pk_mul_f32 v[42:43], v[42:43], v[40:41]
    v_pk_mul_f32 v[46:47], v[46:47], v[44:45]
    v_pk_mul_f32 v[50:51], v[50:51], v[48:49]
    v_exp_f32 v38, v38
    v_exp_f32 v39, v39
    v_exp_f32 v42, v42
    v_exp_f32 v43, v43
    v_exp_f32 v46, v46
    v_exp_f32 v47, v47
    v_exp_f32 v50, v50
    v_exp_f32 v51, v51
    v_pk_add_f32 v[38:39], v[38:39], 1.0 op_sel_hi:[1,0]
    v_pk_add_f32 v[42:43], v[42:43], 1.0 op_sel_hi:[1,0]
    v_pk_add_f32 v[46:47], v[46:47], 1.0 op_sel_hi:[1,0]
    v_pk_add_f32 v[50:51], v[50:51], 1.0 op_sel_hi:[1,0]
    v_rcp_f32 v38, v38
    v_rcp_f32 v39, v39
    v_rcp_f32 v42, v42
    v_rcp_f32 v43, v43
    v_rcp_f32 v46, v46
    v_rcp_f32 v47, v47
    v_rcp_f32 v50, v50
    v_rcp_f32 v51, v51
    v_pk_mul_f32 v[36:37], v[36:37], v[38:39]
    v_pk_mul_f32 v[40:41], v[40:41], v[42:43]
    v_pk_mul_f32 v[44:45], v[44:45], v[46:47]
    v_pk_mul_f32 v[48:49], v[48:49], v[50:51]
    v_cvt_pk_bf16_f32 v52, v36, v37
    v_cvt_pk_bf16_f32 v53, v40, v41
    v_cvt_pk_bf16_f32 v54, v44, v45
    v_cvt_pk_bf16_f32 v55, v48, v49
    s_add_u32 s47, s45, 6144
    buffer_store_dwordx4 v[52:55], v60, s[16:19], s47 offen sc1
    v_pk_fma_f32 v[36:37], v[20:21], v[18:19], v[24:25] op_sel:[0,1,0] op_sel_hi:[1,1,1]
    v_pk_fma_f32 v[40:41], v[22:23], v[18:19], v[26:27] op_sel:[0,1,0] op_sel_hi:[1,1,1]
    v_pk_fma_f32 v[44:45], v[28:29], v[18:19], v[32:33] op_sel:[0,1,0] op_sel_hi:[1,1,1]
    v_pk_fma_f32 v[48:49], v[30:31], v[18:19], v[34:35] op_sel:[0,1,0] op_sel_hi:[1,1,1]
    v_pk_fma_f32 v[36:37], v[232:233], v[18:19], v[36:37] op_sel_hi:[1,0,1]
    v_pk_fma_f32 v[40:41], v[234:235], v[18:19], v[40:41] op_sel_hi:[1,0,1]
    v_pk_fma_f32 v[44:45], v[236:237], v[18:19], v[44:45] op_sel_hi:[1,0,1]
    v_pk_fma_f32 v[48:49], v[238:239], v[18:19], v[48:49] op_sel_hi:[1,0,1]
    v_pk_mul_f32 v[38:39], v[36:37], v[36:37]
    v_pk_mul_f32 v[42:43], v[40:41], v[40:41]
    v_pk_mul_f32 v[46:47], v[44:45], v[44:45]
    v_pk_mul_f32 v[50:51], v[48:49], v[48:49]
    v_pk_fma_f32 v[38:39], v[38:39], s[60:61], v[2:3]
    v_pk_fma_f32 v[42:43], v[42:43], s[60:61], v[2:3]
    v_pk_fma_f32 v[46:47], v[46:47], s[60:61], v[2:3]
    v_pk_fma_f32 v[50:51], v[50:51], s[60:61], v[2:3]
    v_pk_mul_f32 v[38:39], v[38:39], v[36:37]
    v_pk_mul_f32 v[42:43], v[42:43], v[40:41]
    v_pk_mul_f32 v[46:47], v[46:47], v[44:45]
    v_pk_mul_f32 v[50:51], v[50:51], v[48:49]
    v_exp_f32 v38, v38
    v_exp_f32 v39, v39
    v_exp_f32 v42, v42
    v_exp_f32 v43, v43
    v_exp_f32 v46, v46
    v_exp_f32 v47, v47
    v_exp_f32 v50, v50
    v_exp_f32 v51, v51
    v_pk_add_f32 v[38:39], v[38:39], 1.0 op_sel_hi:[1,0]
    v_pk_add_f32 v[42:43], v[42:43], 1.0 op_sel_hi:[1,0]
    v_pk_add_f32 v[46:47], v[46:47], 1.0 op_sel_hi:[1,0]
    v_pk_add_f32 v[50:51], v[50:51], 1.0 op_sel_hi:[1,0]
    v_rcp_f32 v38, v38
    v_rcp_f32 v39, v39
    v_rcp_f32 v42, v42
    v_rcp_f32 v43, v43
    v_rcp_f32 v46, v46
    v_rcp_f32 v47, v47
    v_rcp_f32 v50, v50
    v_rcp_f32 v51, v51
    v_pk_mul_f32 v[36:37], v[36:37], v[38:39]
    v_pk_mul_f32 v[40:41], v[40:41], v[42:43]
    v_pk_mul_f32 v[44:45], v[44:45], v[46:47]
    v_pk_mul_f32 v[48:49], v[48:49], v[50:51]
    v_cvt_pk_bf16_f32 v56, v36, v37
    v_cvt_pk_bf16_f32 v57, v40, v41
    v_cvt_pk_bf16_f32 v58, v44, v45
    v_cvt_pk_bf16_f32 v59, v48, v49
    s_add_u32 s47, s45, 7168
    buffer_store_dwordx4 v[56:59], v60, s[16:19], s47 offen sc1
    ds_read_b128 v[20:23], v63 offset:128
    ds_read_b128 v[24:27], v63 offset:1024
    ds_read_b128 v[28:31], v63 offset:192
    ds_read_b128 v[32:35], v63 offset:1088
    s_waitcnt lgkmcnt(0)
    v_pk_fma_f32 v[36:37], v[20:21], v[4:5], v[24:25] op_sel:[0,1,0] op_sel_hi:[1,1,1]
    v_pk_fma_f32 v[40:41], v[22:23], v[4:5], v[26:27] op_sel:[0,1,0] op_sel_hi:[1,1,1]
    v_pk_fma_f32 v[44:45], v[28:29], v[4:5], v[32:33] op_sel:[0,1,0] op_sel_hi:[1,1,1]
    v_pk_fma_f32 v[48:49], v[30:31], v[4:5], v[34:35] op_sel:[0,1,0] op_sel_hi:[1,1,1]
    v_pk_fma_f32 v[36:37], v[72:73], v[4:5], v[36:37] op_sel_hi:[1,0,1]
    v_pk_fma_f32 v[40:41], v[74:75], v[4:5], v[40:41] op_sel_hi:[1,0,1]
    v_pk_fma_f32 v[44:45], v[76:77], v[4:5], v[44:45] op_sel_hi:[1,0,1]
    v_pk_fma_f32 v[48:49], v[78:79], v[4:5], v[48:49] op_sel_hi:[1,0,1]
    v_pk_mul_f32 v[38:39], v[36:37], v[36:37]
    v_pk_mul_f32 v[42:43], v[40:41], v[40:41]
    v_pk_mul_f32 v[46:47], v[44:45], v[44:45]
    v_pk_mul_f32 v[50:51], v[48:49], v[48:49]
    v_pk_fma_f32 v[38:39], v[38:39], s[60:61], v[2:3]
    v_pk_fma_f32 v[42:43], v[42:43], s[60:61], v[2:3]
    v_pk_fma_f32 v[46:47], v[46:47], s[60:61], v[2:3]
    v_pk_fma_f32 v[50:51], v[50:51], s[60:61], v[2:3]
    v_pk_mul_f32 v[38:39], v[38:39], v[36:37]
    v_pk_mul_f32 v[42:43], v[42:43], v[40:41]
    v_pk_mul_f32 v[46:47], v[46:47], v[44:45]
    v_pk_mul_f32 v[50:51], v[50:51], v[48:49]
    v_exp_f32 v38, v38
    v_exp_f32 v39, v39
    v_exp_f32 v42, v42
    v_exp_f32 v43, v43
    v_exp_f32 v46, v46
    v_exp_f32 v47, v47
    v_exp_f32 v50, v50
    v_exp_f32 v51, v51
    v_pk_add_f32 v[38:39], v[38:39], 1.0 op_sel_hi:[1,0]
    v_pk_add_f32 v[42:43], v[42:43], 1.0 op_sel_hi:[1,0]
    v_pk_add_f32 v[46:47], v[46:47], 1.0 op_sel_hi:[1,0]
    v_pk_add_f32 v[50:51], v[50:51], 1.0 op_sel_hi:[1,0]
    v_rcp_f32 v38, v38
    v_rcp_f32 v39, v39
    v_rcp_f32 v42, v42
    v_rcp_f32 v43, v43
    v_rcp_f32 v46, v46
    v_rcp_f32 v47, v47
    v_rcp_f32 v50, v50
    v_rcp_f32 v51, v51
    v_pk_mul_f32 v[36:37], v[36:37], v[38:39]
    v_pk_mul_f32 v[40:41], v[40:41], v[42:43]
    v_pk_mul_f32 v[44:45], v[44:45], v[46:47]
    v_pk_mul_f32 v[48:49], v[48:49], v[50:51]
    v_cvt_pk_bf16_f32 v52, v36, v37
    v_cvt_pk_bf16_f32 v53, v40, v41
    v_cvt_pk_bf16_f32 v54, v44, v45
    v_cvt_pk_bf16_f32 v55, v48, v49
    s_add_u32 s47, s45, 8192
    buffer_store_dwordx4 v[52:55], v60, s[16:19], s47 offen sc1
    v_pk_fma_f32 v[36:37], v[20:21], v[6:7], v[24:25] op_sel:[0,1,0] op_sel_hi:[1,1,1]
    v_pk_fma_f32 v[40:41], v[22:23], v[6:7], v[26:27] op_sel:[0,1,0] op_sel_hi:[1,1,1]
    v_pk_fma_f32 v[44:45], v[28:29], v[6:7], v[32:33] op_sel:[0,1,0] op_sel_hi:[1,1,1]
    v_pk_fma_f32 v[48:49], v[30:31], v[6:7], v[34:35] op_sel:[0,1,0] op_sel_hi:[1,1,1]
    v_pk_fma_f32 v[36:37], v[96:97], v[6:7], v[36:37] op_sel_hi:[1,0,1]
    v_pk_fma_f32 v[40:41], v[98:99], v[6:7], v[40:41] op_sel_hi:[1,0,1]
    v_pk_fma_f32 v[44:45], v[100:101], v[6:7], v[44:45] op_sel_hi:[1,0,1]
    v_pk_fma_f32 v[48:49], v[102:103], v[6:7], v[48:49] op_sel_hi:[1,0,1]
    v_pk_mul_f32 v[38:39], v[36:37], v[36:37]
    v_pk_mul_f32 v[42:43], v[40:41], v[40:41]
    v_pk_mul_f32 v[46:47], v[44:45], v[44:45]
    v_pk_mul_f32 v[50:51], v[48:49], v[48:49]
    v_pk_fma_f32 v[38:39], v[38:39], s[60:61], v[2:3]
    v_pk_fma_f32 v[42:43], v[42:43], s[60:61], v[2:3]
    v_pk_fma_f32 v[46:47], v[46:47], s[60:61], v[2:3]
    v_pk_fma_f32 v[50:51], v[50:51], s[60:61], v[2:3]
    v_pk_mul_f32 v[38:39], v[38:39], v[36:37]
    v_pk_mul_f32 v[42:43], v[42:43], v[40:41]
    v_pk_mul_f32 v[46:47], v[46:47], v[44:45]
    v_pk_mul_f32 v[50:51], v[50:51], v[48:49]
    v_exp_f32 v38, v38
    v_exp_f32 v39, v39
    v_exp_f32 v42, v42
    v_exp_f32 v43, v43
    v_exp_f32 v46, v46
    v_exp_f32 v47, v47
    v_exp_f32 v50, v50
    v_exp_f32 v51, v51
    v_pk_add_f32 v[38:39], v[38:39], 1.0 op_sel_hi:[1,0]
    v_pk_add_f32 v[42:43], v[42:43], 1.0 op_sel_hi:[1,0]
    v_pk_add_f32 v[46:47], v[46:47], 1.0 op_sel_hi:[1,0]
    v_pk_add_f32 v[50:51], v[50:51], 1.0 op_sel_hi:[1,0]
    v_rcp_f32 v38, v38
    v_rcp_f32 v39, v39
    v_rcp_f32 v42, v42
    v_rcp_f32 v43, v43
    v_rcp_f32 v46, v46
    v_rcp_f32 v47, v47
    v_rcp_f32 v50, v50
    v_rcp_f32 v51, v51
    v_pk_mul_f32 v[36:37], v[36:37], v[38:39]
    v_pk_mul_f32 v[40:41], v[40:41], v[42:43]
    v_pk_mul_f32 v[44:45], v[44:45], v[46:47]
    v_pk_mul_f32 v[48:49], v[48:49], v[50:51]
    v_cvt_pk_bf16_f32 v56, v36, v37
    v_cvt_pk_bf16_f32 v57, v40, v41
    v_cvt_pk_bf16_f32 v58, v44, v45
    v_cvt_pk_bf16_f32 v59, v48, v49
    s_add_u32 s47, s45, 9216
    buffer_store_dwordx4 v[56:59], v60, s[16:19], s47 offen sc1
    v_pk_fma_f32 v[36:37], v[20:21], v[8:9], v[24:25] op_sel:[0,1,0] op_sel_hi:[1,1,1]
    v_pk_fma_f32 v[40:41], v[22:23], v[8:9], v[26:27] op_sel:[0,1,0] op_sel_hi:[1,1,1]
    v_pk_fma_f32 v[44:45], v[28:29], v[8:9], v[32:33] op_sel:[0,1,0] op_sel_hi:[1,1,1]
    v_pk_fma_f32 v[48:49], v[30:31], v[8:9], v[34:35] op_sel:[0,1,0] op_sel_hi:[1,1,1]
    v_pk_fma_f32 v[36:37], v[120:121], v[8:9], v[36:37] op_sel_hi:[1,0,1]
    v_pk_fma_f32 v[40:41], v[122:123], v[8:9], v[40:41] op_sel_hi:[1,0,1]
    v_pk_fma_f32 v[44:45], v[124:125], v[8:9], v[44:45] op_sel_hi:[1,0,1]
    v_pk_fma_f32 v[48:49], v[126:127], v[8:9], v[48:49] op_sel_hi:[1,0,1]
    v_pk_mul_f32 v[38:39], v[36:37], v[36:37]
    v_pk_mul_f32 v[42:43], v[40:41], v[40:41]
    v_pk_mul_f32 v[46:47], v[44:45], v[44:45]
    v_pk_mul_f32 v[50:51], v[48:49], v[48:49]
    v_pk_fma_f32 v[38:39], v[38:39], s[60:61], v[2:3]
    v_pk_fma_f32 v[42:43], v[42:43], s[60:61], v[2:3]
    v_pk_fma_f32 v[46:47], v[46:47], s[60:61], v[2:3]
    v_pk_fma_f32 v[50:51], v[50:51], s[60:61], v[2:3]
    v_pk_mul_f32 v[38:39], v[38:39], v[36:37]
    v_pk_mul_f32 v[42:43], v[42:43], v[40:41]
    v_pk_mul_f32 v[46:47], v[46:47], v[44:45]
    v_pk_mul_f32 v[50:51], v[50:51], v[48:49]
    v_exp_f32 v38, v38
    v_exp_f32 v39, v39
    v_exp_f32 v42, v42
    v_exp_f32 v43, v43
    v_exp_f32 v46, v46
    v_exp_f32 v47, v47
    v_exp_f32 v50, v50
    v_exp_f32 v51, v51
    v_pk_add_f32 v[38:39], v[38:39], 1.0 op_sel_hi:[1,0]
    v_pk_add_f32 v[42:43], v[42:43], 1.0 op_sel_hi:[1,0]
    v_pk_add_f32 v[46:47], v[46:47], 1.0 op_sel_hi:[1,0]
    v_pk_add_f32 v[50:51], v[50:51], 1.0 op_sel_hi:[1,0]
    v_rcp_f32 v38, v38
    v_rcp_f32 v39, v39
    v_rcp_f32 v42, v42
    v_rcp_f32 v43, v43
    v_rcp_f32 v46, v46
    v_rcp_f32 v47, v47
    v_rcp_f32 v50, v50
    v_rcp_f32 v51, v51
    v_pk_mul_f32 v[36:37], v[36:37], v[38:39]
    v_pk_mul_f32 v[40:41], v[40:41], v[42:43]
    v_pk_mul_f32 v[44:45], v[44:45], v[46:47]
    v_pk_mul_f32 v[48:49], v[48:49], v[50:51]
    v_cvt_pk_bf16_f32 v52, v36, v37
    v_cvt_pk_bf16_f32 v53, v40, v41
    v_cvt_pk_bf16_f32 v54, v44, v45
    v_cvt_pk_bf16_f32 v55, v48, v49
    s_add_u32 s47, s45, 10240
    buffer_store_dwordx4 v[52:55], v60, s[16:19], s47 offen sc1
    v_pk_fma_f32 v[36:37], v[20:21], v[10:11], v[24:25] op_sel:[0,1,0] op_sel_hi:[1,1,1]
    v_pk_fma_f32 v[40:41], v[22:23], v[10:11], v[26:27] op_sel:[0,1,0] op_sel_hi:[1,1,1]
    v_pk_fma_f32 v[44:45], v[28:29], v[10:11], v[32:33] op_sel:[0,1,0] op_sel_hi:[1,1,1]
    v_pk_fma_f32 v[48:49], v[30:31], v[10:11], v[34:35] op_sel:[0,1,0] op_sel_hi:[1,1,1]
    v_pk_fma_f32 v[36:37], v[144:145], v[10:11], v[36:37] op_sel_hi:[1,0,1]
    v_pk_fma_f32 v[40:41], v[146:147], v[10:11], v[40:41] op_sel_hi:[1,0,1]
    v_pk_fma_f32 v[44:45], v[148:149], v[10:11], v[44:45] op_sel_hi:[1,0,1]
    v_pk_fma_f32 v[48:49], v[150:151], v[10:11], v[48:49] op_sel_hi:[1,0,1]
    v_pk_mul_f32 v[38:39], v[36:37], v[36:37]
    v_pk_mul_f32 v[42:43], v[40:41], v[40:41]
    v_pk_mul_f32 v[46:47], v[44:45], v[44:45]
    v_pk_mul_f32 v[50:51], v[48:49], v[48:49]
    v_pk_fma_f32 v[38:39], v[38:39], s[60:61], v[2:3]
    v_pk_fma_f32 v[42:43], v[42:43], s[60:61], v[2:3]
    v_pk_fma_f32 v[46:47], v[46:47], s[60:61], v[2:3]
    v_pk_fma_f32 v[50:51], v[50:51], s[60:61], v[2:3]
    v_pk_mul_f32 v[38:39], v[38:39], v[36:37]
    v_pk_mul_f32 v[42:43], v[42:43], v[40:41]
    v_pk_mul_f32 v[46:47], v[46:47], v[44:45]
    v_pk_mul_f32 v[50:51], v[50:51], v[48:49]
    v_exp_f32 v38, v38
    v_exp_f32 v39, v39
    v_exp_f32 v42, v42
    v_exp_f32 v43, v43
    v_exp_f32 v46, v46
    v_exp_f32 v47, v47
    v_exp_f32 v50, v50
    v_exp_f32 v51, v51
    v_pk_add_f32 v[38:39], v[38:39], 1.0 op_sel_hi:[1,0]
    v_pk_add_f32 v[42:43], v[42:43], 1.0 op_sel_hi:[1,0]
    v_pk_add_f32 v[46:47], v[46:47], 1.0 op_sel_hi:[1,0]
    v_pk_add_f32 v[50:51], v[50:51], 1.0 op_sel_hi:[1,0]
    v_rcp_f32 v38, v38
    v_rcp_f32 v39, v39
    v_rcp_f32 v42, v42
    v_rcp_f32 v43, v43
    v_rcp_f32 v46, v46
    v_rcp_f32 v47, v47
    v_rcp_f32 v50, v50
    v_rcp_f32 v51, v51
    v_pk_mul_f32 v[36:37], v[36:37], v[38:39]
    v_pk_mul_f32 v[40:41], v[40:41], v[42:43]
    v_pk_mul_f32 v[44:45], v[44:45], v[46:47]
    v_pk_mul_f32 v[48:49], v[48:49], v[50:51]
    v_cvt_pk_bf16_f32 v56, v36, v37
    v_cvt_pk_bf16_f32 v57, v40, v41
    v_cvt_pk_bf16_f32 v58, v44, v45
    v_cvt_pk_bf16_f32 v59, v48, v49
    s_add_u32 s47, s45, 11264
    buffer_store_dwordx4 v[56:59], v60, s[16:19], s47 offen sc1
    v_pk_fma_f32 v[36:37], v[20:21], v[12:13], v[24:25] op_sel:[0,1,0] op_sel_hi:[1,1,1]
    v_pk_fma_f32 v[40:41], v[22:23], v[12:13], v[26:27] op_sel:[0,1,0] op_sel_hi:[1,1,1]
    v_pk_fma_f32 v[44:45], v[28:29], v[12:13], v[32:33] op_sel:[0,1,0] op_sel_hi:[1,1,1]
    v_pk_fma_f32 v[48:49], v[30:31], v[12:13], v[34:35] op_sel:[0,1,0] op_sel_hi:[1,1,1]
    v_pk_fma_f32 v[36:37], v[168:169], v[12:13], v[36:37] op_sel_hi:[1,0,1]
    v_pk_fma_f32 v[40:41], v[170:171], v[12:13], v[40:41] op_sel_hi:[1,0,1]
    v_pk_fma_f32 v[44:45], v[172:173], v[12:13], v[44:45] op_sel_hi:[1,0,1]
    v_pk_fma_f32 v[48:49], v[174:175], v[12:13], v[48:49] op_sel_hi:[1,0,1]
    v_pk_mul_f32 v[38:39], v[36:37], v[36:37]
    v_pk_mul_f32 v[42:43], v[40:41], v[40:41]
    v_pk_mul_f32 v[46:47], v[44:45], v[44:45]
    v_pk_mul_f32 v[50:51], v[48:49], v[48:49]
    v_pk_fma_f32 v[38:39], v[38:39], s[60:61], v[2:3]
    v_pk_fma_f32 v[42:43], v[42:43], s[60:61], v[2:3]
    v_pk_fma_f32 v[46:47], v[46:47], s[60:61], v[2:3]
    v_pk_fma_f32 v[50:51], v[50:51], s[60:61], v[2:3]
    v_pk_mul_f32 v[38:39], v[38:39], v[36:37]
    v_pk_mul_f32 v[42:43], v[42:43], v[40:41]
    v_pk_mul_f32 v[46:47], v[46:47], v[44:45]
    v_pk_mul_f32 v[50:51], v[50:51], v[48:49]
    v_exp_f32 v38, v38
    v_exp_f32 v39, v39
    v_exp_f32 v42, v42
    v_exp_f32 v43, v43
    v_exp_f32 v46, v46
    v_exp_f32 v47, v47
    v_exp_f32 v50, v50
    v_exp_f32 v51, v51
    v_pk_add_f32 v[38:39], v[38:39], 1.0 op_sel_hi:[1,0]
    v_pk_add_f32 v[42:43], v[42:43], 1.0 op_sel_hi:[1,0]
    v_pk_add_f32 v[46:47], v[46:47], 1.0 op_sel_hi:[1,0]
    v_pk_add_f32 v[50:51], v[50:51], 1.0 op_sel_hi:[1,0]
    v_rcp_f32 v38, v38
    v_rcp_f32 v39, v39
    v_rcp_f32 v42, v42
    v_rcp_f32 v43, v43
    v_rcp_f32 v46, v46
    v_rcp_f32 v47, v47
    v_rcp_f32 v50, v50
    v_rcp_f32 v51, v51
    v_pk_mul_f32 v[36:37], v[36:37], v[38:39]
    v_pk_mul_f32 v[40:41], v[40:41], v[42:43]
    v_pk_mul_f32 v[44:45], v[44:45], v[46:47]
    v_pk_mul_f32 v[48:49], v[48:49], v[50:51]
    v_cvt_pk_bf16_f32 v52, v36, v37
    v_cvt_pk_bf16_f32 v53, v40, v41
    v_cvt_pk_bf16_f32 v54, v44, v45
    v_cvt_pk_bf16_f32 v55, v48, v49
    s_add_u32 s47, s45, 12288
    buffer_store_dwordx4 v[52:55], v60, s[16:19], s47 offen sc1
    v_pk_fma_f32 v[36:37], v[20:21], v[14:15], v[24:25] op_sel:[0,1,0] op_sel_hi:[1,1,1]
    v_pk_fma_f32 v[40:41], v[22:23], v[14:15], v[26:27] op_sel:[0,1,0] op_sel_hi:[1,1,1]
    v_pk_fma_f32 v[44:45], v[28:29], v[14:15], v[32:33] op_sel:[0,1,0] op_sel_hi:[1,1,1]
    v_pk_fma_f32 v[48:49], v[30:31], v[14:15], v[34:35] op_sel:[0,1,0] op_sel_hi:[1,1,1]
    v_pk_fma_f32 v[36:37], v[192:193], v[14:15], v[36:37] op_sel_hi:[1,0,1]
    v_pk_fma_f32 v[40:41], v[194:195], v[14:15], v[40:41] op_sel_hi:[1,0,1]
    v_pk_fma_f32 v[44:45], v[196:197], v[14:15], v[44:45] op_sel_hi:[1,0,1]
    v_pk_fma_f32 v[48:49], v[198:199], v[14:15], v[48:49] op_sel_hi:[1,0,1]
    v_pk_mul_f32 v[38:39], v[36:37], v[36:37]
    v_pk_mul_f32 v[42:43], v[40:41], v[40:41]
    v_pk_mul_f32 v[46:47], v[44:45], v[44:45]
    v_pk_mul_f32 v[50:51], v[48:49], v[48:49]
    v_pk_fma_f32 v[38:39], v[38:39], s[60:61], v[2:3]
    v_pk_fma_f32 v[42:43], v[42:43], s[60:61], v[2:3]
    v_pk_fma_f32 v[46:47], v[46:47], s[60:61], v[2:3]
    v_pk_fma_f32 v[50:51], v[50:51], s[60:61], v[2:3]
    v_pk_mul_f32 v[38:39], v[38:39], v[36:37]
    v_pk_mul_f32 v[42:43], v[42:43], v[40:41]
    v_pk_mul_f32 v[46:47], v[46:47], v[44:45]
    v_pk_mul_f32 v[50:51], v[50:51], v[48:49]
    v_exp_f32 v38, v38
    v_exp_f32 v39, v39
    v_exp_f32 v42, v42
    v_exp_f32 v43, v43
    v_exp_f32 v46, v46
    v_exp_f32 v47, v47
    v_exp_f32 v50, v50
    v_exp_f32 v51, v51
    v_pk_add_f32 v[38:39], v[38:39], 1.0 op_sel_hi:[1,0]
    v_pk_add_f32 v[42:43], v[42:43], 1.0 op_sel_hi:[1,0]
    v_pk_add_f32 v[46:47], v[46:47], 1.0 op_sel_hi:[1,0]
    v_pk_add_f32 v[50:51], v[50:51], 1.0 op_sel_hi:[1,0]
    v_rcp_f32 v38, v38
    v_rcp_f32 v39, v39
    v_rcp_f32 v42, v42
    v_rcp_f32 v43, v43
    v_rcp_f32 v46, v46
    v_rcp_f32 v47, v47
    v_rcp_f32 v50, v50
    v_rcp_f32 v51, v51
    v_pk_mul_f32 v[36:37], v[36:37], v[38:39]
    v_pk_mul_f32 v[40:41], v[40:41], v[42:43]
    v_pk_mul_f32 v[44:45], v[44:45], v[46:47]
    v_pk_mul_f32 v[48:49], v[48:49], v[50:51]
    v_cvt_pk_bf16_f32 v56, v36, v37
    v_cvt_pk_bf16_f32 v57, v40, v41
    v_cvt_pk_bf16_f32 v58, v44, v45
    v_cvt_pk_bf16_f32 v59, v48, v49
    s_add_u32 s47, s45, 13312
    buffer_store_dwordx4 v[56:59], v60, s[16:19], s47 offen sc1
    v_pk_fma_f32 v[36:37], v[20:21], v[16:17], v[24:25] op_sel:[0,1,0] op_sel_hi:[1,1,1]
    v_pk_fma_f32 v[40:41], v[22:23], v[16:17], v[26:27] op_sel:[0,1,0] op_sel_hi:[1,1,1]
    v_pk_fma_f32 v[44:45], v[28:29], v[16:17], v[32:33] op_sel:[0,1,0] op_sel_hi:[1,1,1]
    v_pk_fma_f32 v[48:49], v[30:31], v[16:17], v[34:35] op_sel:[0,1,0] op_sel_hi:[1,1,1]
    v_pk_fma_f32 v[36:37], v[216:217], v[16:17], v[36:37] op_sel_hi:[1,0,1]
    v_pk_fma_f32 v[40:41], v[218:219], v[16:17], v[40:41] op_sel_hi:[1,0,1]
    v_pk_fma_f32 v[44:45], v[220:221], v[16:17], v[44:45] op_sel_hi:[1,0,1]
    v_pk_fma_f32 v[48:49], v[222:223], v[16:17], v[48:49] op_sel_hi:[1,0,1]
    v_pk_mul_f32 v[38:39], v[36:37], v[36:37]
    v_pk_mul_f32 v[42:43], v[40:41], v[40:41]
    v_pk_mul_f32 v[46:47], v[44:45], v[44:45]
    v_pk_mul_f32 v[50:51], v[48:49], v[48:49]
    v_pk_fma_f32 v[38:39], v[38:39], s[60:61], v[2:3]
    v_pk_fma_f32 v[42:43], v[42:43], s[60:61], v[2:3]
    v_pk_fma_f32 v[46:47], v[46:47], s[60:61], v[2:3]
    v_pk_fma_f32 v[50:51], v[50:51], s[60:61], v[2:3]
    v_pk_mul_f32 v[38:39], v[38:39], v[36:37]
    v_pk_mul_f32 v[42:43], v[42:43], v[40:41]
    v_pk_mul_f32 v[46:47], v[46:47], v[44:45]
    v_pk_mul_f32 v[50:51], v[50:51], v[48:49]
    v_exp_f32 v38, v38
    v_exp_f32 v39, v39
    v_exp_f32 v42, v42
    v_exp_f32 v43, v43
    v_exp_f32 v46, v46
    v_exp_f32 v47, v47
    v_exp_f32 v50, v50
    v_exp_f32 v51, v51
    v_pk_add_f32 v[38:39], v[38:39], 1.0 op_sel_hi:[1,0]
    v_pk_add_f32 v[42:43], v[42:43], 1.0 op_sel_hi:[1,0]
    v_pk_add_f32 v[46:47], v[46:47], 1.0 op_sel_hi:[1,0]
    v_pk_add_f32 v[50:51], v[50:51], 1.0 op_sel_hi:[1,0]
    v_rcp_f32 v38, v38
    v_rcp_f32 v39, v39
    v_rcp_f32 v42, v42
    v_rcp_f32 v43, v43
    v_rcp_f32 v46, v46
    v_rcp_f32 v47, v47
    v_rcp_f32 v50, v50
    v_rcp_f32 v51, v51
    v_pk_mul_f32 v[36:37], v[36:37], v[38:39]
    v_pk_mul_f32 v[40:41], v[40:41], v[42:43]
    v_pk_mul_f32 v[44:45], v[44:45], v[46:47]
    v_pk_mul_f32 v[48:49], v[48:49], v[50:51]
    v_cvt_pk_bf16_f32 v52, v36, v37
    v_cvt_pk_bf16_f32 v53, v40, v41
    v_cvt_pk_bf16_f32 v54, v44, v45
    v_cvt_pk_bf16_f32 v55, v48, v49
    s_add_u32 s47, s45, 14336
    buffer_store_dwordx4 v[52:55], v60, s[16:19], s47 offen sc1
    v_pk_fma_f32 v[36:37], v[20:21], v[18:19], v[24:25] op_sel:[0,1,0] op_sel_hi:[1,1,1]
    v_pk_fma_f32 v[40:41], v[22:23], v[18:19], v[26:27] op_sel:[0,1,0] op_sel_hi:[1,1,1]
    v_pk_fma_f32 v[44:45], v[28:29], v[18:19], v[32:33] op_sel:[0,1,0] op_sel_hi:[1,1,1]
    v_pk_fma_f32 v[48:49], v[30:31], v[18:19], v[34:35] op_sel:[0,1,0] op_sel_hi:[1,1,1]
    v_pk_fma_f32 v[36:37], v[240:241], v[18:19], v[36:37] op_sel_hi:[1,0,1]
    v_pk_fma_f32 v[40:41], v[242:243], v[18:19], v[40:41] op_sel_hi:[1,0,1]
    v_pk_fma_f32 v[44:45], v[244:245], v[18:19], v[44:45] op_sel_hi:[1,0,1]
    v_pk_fma_f32 v[48:49], v[246:247], v[18:19], v[48:49] op_sel_hi:[1,0,1]
    v_pk_mul_f32 v[38:39], v[36:37], v[36:37]
    v_pk_mul_f32 v[42:43], v[40:41], v[40:41]
    v_pk_mul_f32 v[46:47], v[44:45], v[44:45]
    v_pk_mul_f32 v[50:51], v[48:49], v[48:49]
    v_pk_fma_f32 v[38:39], v[38:39], s[60:61], v[2:3]
    v_pk_fma_f32 v[42:43], v[42:43], s[60:61], v[2:3]
    v_pk_fma_f32 v[46:47], v[46:47], s[60:61], v[2:3]
    v_pk_fma_f32 v[50:51], v[50:51], s[60:61], v[2:3]
    v_pk_mul_f32 v[38:39], v[38:39], v[36:37]
    v_pk_mul_f32 v[42:43], v[42:43], v[40:41]
    v_pk_mul_f32 v[46:47], v[46:47], v[44:45]
    v_pk_mul_f32 v[50:51], v[50:51], v[48:49]
    v_exp_f32 v38, v38
    v_exp_f32 v39, v39
    v_exp_f32 v42, v42
    v_exp_f32 v43, v43
    v_exp_f32 v46, v46
    v_exp_f32 v47, v47
    v_exp_f32 v50, v50
    v_exp_f32 v51, v51
    v_pk_add_f32 v[38:39], v[38:39], 1.0 op_sel_hi:[1,0]
    v_pk_add_f32 v[42:43], v[42:43], 1.0 op_sel_hi:[1,0]
    v_pk_add_f32 v[46:47], v[46:47], 1.0 op_sel_hi:[1,0]
    v_pk_add_f32 v[50:51], v[50:51], 1.0 op_sel_hi:[1,0]
    v_rcp_f32 v38, v38
    v_rcp_f32 v39, v39
    v_rcp_f32 v42, v42
    v_rcp_f32 v43, v43
    v_rcp_f32 v46, v46
    v_rcp_f32 v47, v47
    v_rcp_f32 v50, v50
    v_rcp_f32 v51, v51
    v_pk_mul_f32 v[36:37], v[36:37], v[38:39]
    v_pk_mul_f32 v[40:41], v[40:41], v[42:43]
    v_pk_mul_f32 v[44:45], v[44:45], v[46:47]
    v_pk_mul_f32 v[48:49], v[48:49], v[50:51]
    v_cvt_pk_bf16_f32 v56, v36, v37
    v_cvt_pk_bf16_f32 v57, v40, v41
    v_cvt_pk_bf16_f32 v58, v44, v45
    v_cvt_pk_bf16_f32 v59, v48, v49
    s_add_u32 s47, s45, 15360
    buffer_store_dwordx4 v[56:59], v60, s[16:19], s47 offen sc1
    ds_read_b128 v[20:23], v63 offset:256
    ds_read_b128 v[24:27], v63 offset:1152
    ds_read_b128 v[28:31], v63 offset:320
    ds_read_b128 v[32:35], v63 offset:1216
    s_waitcnt lgkmcnt(0)
    v_pk_fma_f32 v[36:37], v[20:21], v[4:5], v[24:25] op_sel:[0,1,0] op_sel_hi:[1,1,1]
    v_pk_fma_f32 v[40:41], v[22:23], v[4:5], v[26:27] op_sel:[0,1,0] op_sel_hi:[1,1,1]
    v_pk_fma_f32 v[44:45], v[28:29], v[4:5], v[32:33] op_sel:[0,1,0] op_sel_hi:[1,1,1]
    v_pk_fma_f32 v[48:49], v[30:31], v[4:5], v[34:35] op_sel:[0,1,0] op_sel_hi:[1,1,1]
    v_pk_fma_f32 v[36:37], v[80:81], v[4:5], v[36:37] op_sel_hi:[1,0,1]
    v_pk_fma_f32 v[40:41], v[82:83], v[4:5], v[40:41] op_sel_hi:[1,0,1]
    v_pk_fma_f32 v[44:45], v[84:85], v[4:5], v[44:45] op_sel_hi:[1,0,1]
    v_pk_fma_f32 v[48:49], v[86:87], v[4:5], v[48:49] op_sel_hi:[1,0,1]
    v_pk_mul_f32 v[38:39], v[36:37], v[36:37]
    v_pk_mul_f32 v[42:43], v[40:41], v[40:41]
    v_pk_mul_f32 v[46:47], v[44:45], v[44:45]
    v_pk_mul_f32 v[50:51], v[48:49], v[48:49]
    v_pk_fma_f32 v[38:39], v[38:39], s[60:61], v[2:3]
    v_pk_fma_f32 v[42:43], v[42:43], s[60:61], v[2:3]
    v_pk_fma_f32 v[46:47], v[46:47], s[60:61], v[2:3]
    v_pk_fma_f32 v[50:51], v[50:51], s[60:61], v[2:3]
    v_pk_mul_f32 v[38:39], v[38:39], v[36:37]
    v_pk_mul_f32 v[42:43], v[42:43], v[40:41]
    v_pk_mul_f32 v[46:47], v[46:47], v[44:45]
    v_pk_mul_f32 v[50:51], v[50:51], v[48:49]
    v_exp_f32 v38, v38
    v_exp_f32 v39, v39
    v_exp_f32 v42, v42
    v_exp_f32 v43, v43
    v_exp_f32 v46, v46
    v_exp_f32 v47, v47
    v_exp_f32 v50, v50
    v_exp_f32 v51, v51
    v_pk_add_f32 v[38:39], v[38:39], 1.0 op_sel_hi:[1,0]
    v_pk_add_f32 v[42:43], v[42:43], 1.0 op_sel_hi:[1,0]
    v_pk_add_f32 v[46:47], v[46:47], 1.0 op_sel_hi:[1,0]
    v_pk_add_f32 v[50:51], v[50:51], 1.0 op_sel_hi:[1,0]
    v_rcp_f32 v38, v38
    v_rcp_f32 v39, v39
    v_rcp_f32 v42, v42
    v_rcp_f32 v43, v43
    v_rcp_f32 v46, v46
    v_rcp_f32 v47, v47
    v_rcp_f32 v50, v50
    v_rcp_f32 v51, v51
    v_pk_mul_f32 v[36:37], v[36:37], v[38:39]
    v_pk_mul_f32 v[40:41], v[40:41], v[42:43]
    v_pk_mul_f32 v[44:45], v[44:45], v[46:47]
    v_pk_mul_f32 v[48:49], v[48:49], v[50:51]
    v_cvt_pk_bf16_f32 v52, v36, v37
    v_cvt_pk_bf16_f32 v53, v40, v41
    v_cvt_pk_bf16_f32 v54, v44, v45
    v_cvt_pk_bf16_f32 v55, v48, v49
    s_add_u32 s47, s45, 16384
    buffer_store_dwordx4 v[52:55], v60, s[16:19], s47 offen sc1
    v_pk_fma_f32 v[36:37], v[20:21], v[6:7], v[24:25] op_sel:[0,1,0] op_sel_hi:[1,1,1]
    v_pk_fma_f32 v[40:41], v[22:23], v[6:7], v[26:27] op_sel:[0,1,0] op_sel_hi:[1,1,1]
    v_pk_fma_f32 v[44:45], v[28:29], v[6:7], v[32:33] op_sel:[0,1,0] op_sel_hi:[1,1,1]
    v_pk_fma_f32 v[48:49], v[30:31], v[6:7], v[34:35] op_sel:[0,1,0] op_sel_hi:[1,1,1]
    v_pk_fma_f32 v[36:37], v[104:105], v[6:7], v[36:37] op_sel_hi:[1,0,1]
    v_pk_fma_f32 v[40:41], v[106:107], v[6:7], v[40:41] op_sel_hi:[1,0,1]
    v_pk_fma_f32 v[44:45], v[108:109], v[6:7], v[44:45] op_sel_hi:[1,0,1]
    v_pk_fma_f32 v[48:49], v[110:111], v[6:7], v[48:49] op_sel_hi:[1,0,1]
    v_pk_mul_f32 v[38:39], v[36:37], v[36:37]
    v_pk_mul_f32 v[42:43], v[40:41], v[40:41]
    v_pk_mul_f32 v[46:47], v[44:45], v[44:45]
    v_pk_mul_f32 v[50:51], v[48:49], v[48:49]
    v_pk_fma_f32 v[38:39], v[38:39], s[60:61], v[2:3]
    v_pk_fma_f32 v[42:43], v[42:43], s[60:61], v[2:3]
    v_pk_fma_f32 v[46:47], v[46:47], s[60:61], v[2:3]
    v_pk_fma_f32 v[50:51], v[50:51], s[60:61], v[2:3]
    v_pk_mul_f32 v[38:39], v[38:39], v[36:37]
    v_pk_mul_f32 v[42:43], v[42:43], v[40:41]
    v_pk_mul_f32 v[46:47], v[46:47], v[44:45]
    v_pk_mul_f32 v[50:51], v[50:51], v[48:49]
    v_exp_f32 v38, v38
    v_exp_f32 v39, v39
    v_exp_f32 v42, v42
    v_exp_f32 v43, v43
    v_exp_f32 v46, v46
    v_exp_f32 v47, v47
    v_exp_f32 v50, v50
    v_exp_f32 v51, v51
    v_pk_add_f32 v[38:39], v[38:39], 1.0 op_sel_hi:[1,0]
    v_pk_add_f32 v[42:43], v[42:43], 1.0 op_sel_hi:[1,0]
    v_pk_add_f32 v[46:47], v[46:47], 1.0 op_sel_hi:[1,0]
    v_pk_add_f32 v[50:51], v[50:51], 1.0 op_sel_hi:[1,0]
    v_rcp_f32 v38, v38
    v_rcp_f32 v39, v39
    v_rcp_f32 v42, v42
    v_rcp_f32 v43, v43
    v_rcp_f32 v46, v46
    v_rcp_f32 v47, v47
    v_rcp_f32 v50, v50
    v_rcp_f32 v51, v51
    v_pk_mul_f32 v[36:37], v[36:37], v[38:39]
    v_pk_mul_f32 v[40:41], v[40:41], v[42:43]
    v_pk_mul_f32 v[44:45], v[44:45], v[46:47]
    v_pk_mul_f32 v[48:49], v[48:49], v[50:51]
    v_cvt_pk_bf16_f32 v56, v36, v37
    v_cvt_pk_bf16_f32 v57, v40, v41
    v_cvt_pk_bf16_f32 v58, v44, v45
    v_cvt_pk_bf16_f32 v59, v48, v49
    s_add_u32 s47, s45, 17408
    buffer_store_dwordx4 v[56:59], v60, s[16:19], s47 offen sc1
    v_pk_fma_f32 v[36:37], v[20:21], v[8:9], v[24:25] op_sel:[0,1,0] op_sel_hi:[1,1,1]
    v_pk_fma_f32 v[40:41], v[22:23], v[8:9], v[26:27] op_sel:[0,1,0] op_sel_hi:[1,1,1]
    v_pk_fma_f32 v[44:45], v[28:29], v[8:9], v[32:33] op_sel:[0,1,0] op_sel_hi:[1,1,1]
    v_pk_fma_f32 v[48:49], v[30:31], v[8:9], v[34:35] op_sel:[0,1,0] op_sel_hi:[1,1,1]
    v_pk_fma_f32 v[36:37], v[128:129], v[8:9], v[36:37] op_sel_hi:[1,0,1]
    v_pk_fma_f32 v[40:41], v[130:131], v[8:9], v[40:41] op_sel_hi:[1,0,1]
    v_pk_fma_f32 v[44:45], v[132:133], v[8:9], v[44:45] op_sel_hi:[1,0,1]
    v_pk_fma_f32 v[48:49], v[134:135], v[8:9], v[48:49] op_sel_hi:[1,0,1]
    v_pk_mul_f32 v[38:39], v[36:37], v[36:37]
    v_pk_mul_f32 v[42:43], v[40:41], v[40:41]
    v_pk_mul_f32 v[46:47], v[44:45], v[44:45]
    v_pk_mul_f32 v[50:51], v[48:49], v[48:49]
    v_pk_fma_f32 v[38:39], v[38:39], s[60:61], v[2:3]
    v_pk_fma_f32 v[42:43], v[42:43], s[60:61], v[2:3]
    v_pk_fma_f32 v[46:47], v[46:47], s[60:61], v[2:3]
    v_pk_fma_f32 v[50:51], v[50:51], s[60:61], v[2:3]
    v_pk_mul_f32 v[38:39], v[38:39], v[36:37]
    v_pk_mul_f32 v[42:43], v[42:43], v[40:41]
    v_pk_mul_f32 v[46:47], v[46:47], v[44:45]
    v_pk_mul_f32 v[50:51], v[50:51], v[48:49]
    v_exp_f32 v38, v38
    v_exp_f32 v39, v39
    v_exp_f32 v42, v42
    v_exp_f32 v43, v43
    v_exp_f32 v46, v46
    v_exp_f32 v47, v47
    v_exp_f32 v50, v50
    v_exp_f32 v51, v51
    v_pk_add_f32 v[38:39], v[38:39], 1.0 op_sel_hi:[1,0]
    v_pk_add_f32 v[42:43], v[42:43], 1.0 op_sel_hi:[1,0]
    v_pk_add_f32 v[46:47], v[46:47], 1.0 op_sel_hi:[1,0]
    v_pk_add_f32 v[50:51], v[50:51], 1.0 op_sel_hi:[1,0]
    v_rcp_f32 v38, v38
    v_rcp_f32 v39, v39
    v_rcp_f32 v42, v42
    v_rcp_f32 v43, v43
    v_rcp_f32 v46, v46
    v_rcp_f32 v47, v47
    v_rcp_f32 v50, v50
    v_rcp_f32 v51, v51
    v_pk_mul_f32 v[36:37], v[36:37], v[38:39]
    v_pk_mul_f32 v[40:41], v[40:41], v[42:43]
    v_pk_mul_f32 v[44:45], v[44:45], v[46:47]
    v_pk_mul_f32 v[48:49], v[48:49], v[50:51]
    v_cvt_pk_bf16_f32 v52, v36, v37
    v_cvt_pk_bf16_f32 v53, v40, v41
    v_cvt_pk_bf16_f32 v54, v44, v45
    v_cvt_pk_bf16_f32 v55, v48, v49
    s_add_u32 s47, s45, 18432
    buffer_store_dwordx4 v[52:55], v60, s[16:19], s47 offen sc1
    v_pk_fma_f32 v[36:37], v[20:21], v[10:11], v[24:25] op_sel:[0,1,0] op_sel_hi:[1,1,1]
    v_pk_fma_f32 v[40:41], v[22:23], v[10:11], v[26:27] op_sel:[0,1,0] op_sel_hi:[1,1,1]
    v_pk_fma_f32 v[44:45], v[28:29], v[10:11], v[32:33] op_sel:[0,1,0] op_sel_hi:[1,1,1]
    v_pk_fma_f32 v[48:49], v[30:31], v[10:11], v[34:35] op_sel:[0,1,0] op_sel_hi:[1,1,1]
    v_pk_fma_f32 v[36:37], v[152:153], v[10:11], v[36:37] op_sel_hi:[1,0,1]
    v_pk_fma_f32 v[40:41], v[154:155], v[10:11], v[40:41] op_sel_hi:[1,0,1]
    v_pk_fma_f32 v[44:45], v[156:157], v[10:11], v[44:45] op_sel_hi:[1,0,1]
    v_pk_fma_f32 v[48:49], v[158:159], v[10:11], v[48:49] op_sel_hi:[1,0,1]
    v_pk_mul_f32 v[38:39], v[36:37], v[36:37]
    v_pk_mul_f32 v[42:43], v[40:41], v[40:41]
    v_pk_mul_f32 v[46:47], v[44:45], v[44:45]
    v_pk_mul_f32 v[50:51], v[48:49], v[48:49]
    v_pk_fma_f32 v[38:39], v[38:39], s[60:61], v[2:3]
    v_pk_fma_f32 v[42:43], v[42:43], s[60:61], v[2:3]
    v_pk_fma_f32 v[46:47], v[46:47], s[60:61], v[2:3]
    v_pk_fma_f32 v[50:51], v[50:51], s[60:61], v[2:3]
    v_pk_mul_f32 v[38:39], v[38:39], v[36:37]
    v_pk_mul_f32 v[42:43], v[42:43], v[40:41]
    v_pk_mul_f32 v[46:47], v[46:47], v[44:45]
    v_pk_mul_f32 v[50:51], v[50:51], v[48:49]
    v_exp_f32 v38, v38
    v_exp_f32 v39, v39
    v_exp_f32 v42, v42
    v_exp_f32 v43, v43
    v_exp_f32 v46, v46
    v_exp_f32 v47, v47
    v_exp_f32 v50, v50
    v_exp_f32 v51, v51
    v_pk_add_f32 v[38:39], v[38:39], 1.0 op_sel_hi:[1,0]
    v_pk_add_f32 v[42:43], v[42:43], 1.0 op_sel_hi:[1,0]
    v_pk_add_f32 v[46:47], v[46:47], 1.0 op_sel_hi:[1,0]
    v_pk_add_f32 v[50:51], v[50:51], 1.0 op_sel_hi:[1,0]
    v_rcp_f32 v38, v38
    v_rcp_f32 v39, v39
    v_rcp_f32 v42, v42
    v_rcp_f32 v43, v43
    v_rcp_f32 v46, v46
    v_rcp_f32 v47, v47
    v_rcp_f32 v50, v50
    v_rcp_f32 v51, v51
    v_pk_mul_f32 v[36:37], v[36:37], v[38:39]
    v_pk_mul_f32 v[40:41], v[40:41], v[42:43]
    v_pk_mul_f32 v[44:45], v[44:45], v[46:47]
    v_pk_mul_f32 v[48:49], v[48:49], v[50:51]
    v_cvt_pk_bf16_f32 v56, v36, v37
    v_cvt_pk_bf16_f32 v57, v40, v41
    v_cvt_pk_bf16_f32 v58, v44, v45
    v_cvt_pk_bf16_f32 v59, v48, v49
    s_add_u32 s47, s45, 19456
    buffer_store_dwordx4 v[56:59], v60, s[16:19], s47 offen sc1
    v_pk_fma_f32 v[36:37], v[20:21], v[12:13], v[24:25] op_sel:[0,1,0] op_sel_hi:[1,1,1]
    v_pk_fma_f32 v[40:41], v[22:23], v[12:13], v[26:27] op_sel:[0,1,0] op_sel_hi:[1,1,1]
    v_pk_fma_f32 v[44:45], v[28:29], v[12:13], v[32:33] op_sel:[0,1,0] op_sel_hi:[1,1,1]
    v_pk_fma_f32 v[48:49], v[30:31], v[12:13], v[34:35] op_sel:[0,1,0] op_sel_hi:[1,1,1]
    v_pk_fma_f32 v[36:37], v[176:177], v[12:13], v[36:37] op_sel_hi:[1,0,1]
    v_pk_fma_f32 v[40:41], v[178:179], v[12:13], v[40:41] op_sel_hi:[1,0,1]
    v_pk_fma_f32 v[44:45], v[180:181], v[12:13], v[44:45] op_sel_hi:[1,0,1]
    v_pk_fma_f32 v[48:49], v[182:183], v[12:13], v[48:49] op_sel_hi:[1,0,1]
    v_pk_mul_f32 v[38:39], v[36:37], v[36:37]
    v_pk_mul_f32 v[42:43], v[40:41], v[40:41]
    v_pk_mul_f32 v[46:47], v[44:45], v[44:45]
    v_pk_mul_f32 v[50:51], v[48:49], v[48:49]
    v_pk_fma_f32 v[38:39], v[38:39], s[60:61], v[2:3]
    v_pk_fma_f32 v[42:43], v[42:43], s[60:61], v[2:3]
    v_pk_fma_f32 v[46:47], v[46:47], s[60:61], v[2:3]
    v_pk_fma_f32 v[50:51], v[50:51], s[60:61], v[2:3]
    v_pk_mul_f32 v[38:39], v[38:39], v[36:37]
    v_pk_mul_f32 v[42:43], v[42:43], v[40:41]
    v_pk_mul_f32 v[46:47], v[46:47], v[44:45]
    v_pk_mul_f32 v[50:51], v[50:51], v[48:49]
    v_exp_f32 v38, v38
    v_exp_f32 v39, v39
    v_exp_f32 v42, v42
    v_exp_f32 v43, v43
    v_exp_f32 v46, v46
    v_exp_f32 v47, v47
    v_exp_f32 v50, v50
    v_exp_f32 v51, v51
    v_pk_add_f32 v[38:39], v[38:39], 1.0 op_sel_hi:[1,0]
    v_pk_add_f32 v[42:43], v[42:43], 1.0 op_sel_hi:[1,0]
    v_pk_add_f32 v[46:47], v[46:47], 1.0 op_sel_hi:[1,0]
    v_pk_add_f32 v[50:51], v[50:51], 1.0 op_sel_hi:[1,0]
    v_rcp_f32 v38, v38
    v_rcp_f32 v39, v39
    v_rcp_f32 v42, v42
    v_rcp_f32 v43, v43
    v_rcp_f32 v46, v46
    v_rcp_f32 v47, v47
    v_rcp_f32 v50, v50
    v_rcp_f32 v51, v51
    v_pk_mul_f32 v[36:37], v[36:37], v[38:39]
    v_pk_mul_f32 v[40:41], v[40:41], v[42:43]
    v_pk_mul_f32 v[44:45], v[44:45], v[46:47]
    v_pk_mul_f32 v[48:49], v[48:49], v[50:51]
    v_cvt_pk_bf16_f32 v52, v36, v37
    v_cvt_pk_bf16_f32 v53, v40, v41
    v_cvt_pk_bf16_f32 v54, v44, v45
    v_cvt_pk_bf16_f32 v55, v48, v49
    s_add_u32 s47, s45, 20480
    buffer_store_dwordx4 v[52:55], v60, s[16:19], s47 offen sc1
    v_pk_fma_f32 v[36:37], v[20:21], v[14:15], v[24:25] op_sel:[0,1,0] op_sel_hi:[1,1,1]
    v_pk_fma_f32 v[40:41], v[22:23], v[14:15], v[26:27] op_sel:[0,1,0] op_sel_hi:[1,1,1]
    v_pk_fma_f32 v[44:45], v[28:29], v[14:15], v[32:33] op_sel:[0,1,0] op_sel_hi:[1,1,1]
    v_pk_fma_f32 v[48:49], v[30:31], v[14:15], v[34:35] op_sel:[0,1,0] op_sel_hi:[1,1,1]
    v_pk_fma_f32 v[36:37], v[200:201], v[14:15], v[36:37] op_sel_hi:[1,0,1]
    v_pk_fma_f32 v[40:41], v[202:203], v[14:15], v[40:41] op_sel_hi:[1,0,1]
    v_pk_fma_f32 v[44:45], v[204:205], v[14:15], v[44:45] op_sel_hi:[1,0,1]
    v_pk_fma_f32 v[48:49], v[206:207], v[14:15], v[48:49] op_sel_hi:[1,0,1]
    v_pk_mul_f32 v[38:39], v[36:37], v[36:37]
    v_pk_mul_f32 v[42:43], v[40:41], v[40:41]
    v_pk_mul_f32 v[46:47], v[44:45], v[44:45]
    v_pk_mul_f32 v[50:51], v[48:49], v[48:49]
    v_pk_fma_f32 v[38:39], v[38:39], s[60:61], v[2:3]
    v_pk_fma_f32 v[42:43], v[42:43], s[60:61], v[2:3]
    v_pk_fma_f32 v[46:47], v[46:47], s[60:61], v[2:3]
    v_pk_fma_f32 v[50:51], v[50:51], s[60:61], v[2:3]
    v_pk_mul_f32 v[38:39], v[38:39], v[36:37]
    v_pk_mul_f32 v[42:43], v[42:43], v[40:41]
    v_pk_mul_f32 v[46:47], v[46:47], v[44:45]
    v_pk_mul_f32 v[50:51], v[50:51], v[48:49]
    v_exp_f32 v38, v38
    v_exp_f32 v39, v39
    v_exp_f32 v42, v42
    v_exp_f32 v43, v43
    v_exp_f32 v46, v46
    v_exp_f32 v47, v47
    v_exp_f32 v50, v50
    v_exp_f32 v51, v51
    v_pk_add_f32 v[38:39], v[38:39], 1.0 op_sel_hi:[1,0]
    v_pk_add_f32 v[42:43], v[42:43], 1.0 op_sel_hi:[1,0]
    v_pk_add_f32 v[46:47], v[46:47], 1.0 op_sel_hi:[1,0]
    v_pk_add_f32 v[50:51], v[50:51], 1.0 op_sel_hi:[1,0]
    v_rcp_f32 v38, v38
    v_rcp_f32 v39, v39
    v_rcp_f32 v42, v42
    v_rcp_f32 v43, v43
    v_rcp_f32 v46, v46
    v_rcp_f32 v47, v47
    v_rcp_f32 v50, v50
    v_rcp_f32 v51, v51
    v_pk_mul_f32 v[36:37], v[36:37], v[38:39]
    v_pk_mul_f32 v[40:41], v[40:41], v[42:43]
    v_pk_mul_f32 v[44:45], v[44:45], v[46:47]
    v_pk_mul_f32 v[48:49], v[48:49], v[50:51]
    v_cvt_pk_bf16_f32 v56, v36, v37
    v_cvt_pk_bf16_f32 v57, v40, v41
    v_cvt_pk_bf16_f32 v58, v44, v45
    v_cvt_pk_bf16_f32 v59, v48, v49
    s_add_u32 s47, s45, 21504
    buffer_store_dwordx4 v[56:59], v60, s[16:19], s47 offen sc1
    v_pk_fma_f32 v[36:37], v[20:21], v[16:17], v[24:25] op_sel:[0,1,0] op_sel_hi:[1,1,1]
    v_pk_fma_f32 v[40:41], v[22:23], v[16:17], v[26:27] op_sel:[0,1,0] op_sel_hi:[1,1,1]
    v_pk_fma_f32 v[44:45], v[28:29], v[16:17], v[32:33] op_sel:[0,1,0] op_sel_hi:[1,1,1]
    v_pk_fma_f32 v[48:49], v[30:31], v[16:17], v[34:35] op_sel:[0,1,0] op_sel_hi:[1,1,1]
    v_pk_fma_f32 v[36:37], v[224:225], v[16:17], v[36:37] op_sel_hi:[1,0,1]
    v_pk_fma_f32 v[40:41], v[226:227], v[16:17], v[40:41] op_sel_hi:[1,0,1]
    v_pk_fma_f32 v[44:45], v[228:229], v[16:17], v[44:45] op_sel_hi:[1,0,1]
    v_pk_fma_f32 v[48:49], v[230:231], v[16:17], v[48:49] op_sel_hi:[1,0,1]
    v_pk_mul_f32 v[38:39], v[36:37], v[36:37]
    v_pk_mul_f32 v[42:43], v[40:41], v[40:41]
    v_pk_mul_f32 v[46:47], v[44:45], v[44:45]
    v_pk_mul_f32 v[50:51], v[48:49], v[48:49]
    v_pk_fma_f32 v[38:39], v[38:39], s[60:61], v[2:3]
    v_pk_fma_f32 v[42:43], v[42:43], s[60:61], v[2:3]
    v_pk_fma_f32 v[46:47], v[46:47], s[60:61], v[2:3]
    v_pk_fma_f32 v[50:51], v[50:51], s[60:61], v[2:3]
    v_pk_mul_f32 v[38:39], v[38:39], v[36:37]
    v_pk_mul_f32 v[42:43], v[42:43], v[40:41]
    v_pk_mul_f32 v[46:47], v[46:47], v[44:45]
    v_pk_mul_f32 v[50:51], v[50:51], v[48:49]
    v_exp_f32 v38, v38
    v_exp_f32 v39, v39
    v_exp_f32 v42, v42
    v_exp_f32 v43, v43
    v_exp_f32 v46, v46
    v_exp_f32 v47, v47
    v_exp_f32 v50, v50
    v_exp_f32 v51, v51
    v_pk_add_f32 v[38:39], v[38:39], 1.0 op_sel_hi:[1,0]
    v_pk_add_f32 v[42:43], v[42:43], 1.0 op_sel_hi:[1,0]
    v_pk_add_f32 v[46:47], v[46:47], 1.0 op_sel_hi:[1,0]
    v_pk_add_f32 v[50:51], v[50:51], 1.0 op_sel_hi:[1,0]
    v_rcp_f32 v38, v38
    v_rcp_f32 v39, v39
    v_rcp_f32 v42, v42
    v_rcp_f32 v43, v43
    v_rcp_f32 v46, v46
    v_rcp_f32 v47, v47
    v_rcp_f32 v50, v50
    v_rcp_f32 v51, v51
    v_pk_mul_f32 v[36:37], v[36:37], v[38:39]
    v_pk_mul_f32 v[40:41], v[40:41], v[42:43]
    v_pk_mul_f32 v[44:45], v[44:45], v[46:47]
    v_pk_mul_f32 v[48:49], v[48:49], v[50:51]
    v_cvt_pk_bf16_f32 v52, v36, v37
    v_cvt_pk_bf16_f32 v53, v40, v41
    v_cvt_pk_bf16_f32 v54, v44, v45
    v_cvt_pk_bf16_f32 v55, v48, v49
    s_add_u32 s47, s45, 22528
    buffer_store_dwordx4 v[52:55], v60, s[16:19], s47 offen sc1
    v_pk_fma_f32 v[36:37], v[20:21], v[18:19], v[24:25] op_sel:[0,1,0] op_sel_hi:[1,1,1]
    v_pk_fma_f32 v[40:41], v[22:23], v[18:19], v[26:27] op_sel:[0,1,0] op_sel_hi:[1,1,1]
    v_pk_fma_f32 v[44:45], v[28:29], v[18:19], v[32:33] op_sel:[0,1,0] op_sel_hi:[1,1,1]
    v_pk_fma_f32 v[48:49], v[30:31], v[18:19], v[34:35] op_sel:[0,1,0] op_sel_hi:[1,1,1]
    v_pk_fma_f32 v[36:37], v[248:249], v[18:19], v[36:37] op_sel_hi:[1,0,1]
    v_pk_fma_f32 v[40:41], v[250:251], v[18:19], v[40:41] op_sel_hi:[1,0,1]
    v_pk_fma_f32 v[44:45], v[252:253], v[18:19], v[44:45] op_sel_hi:[1,0,1]
    v_pk_fma_f32 v[48:49], v[254:255], v[18:19], v[48:49] op_sel_hi:[1,0,1]
    v_pk_mul_f32 v[38:39], v[36:37], v[36:37]
    v_pk_mul_f32 v[42:43], v[40:41], v[40:41]
    v_pk_mul_f32 v[46:47], v[44:45], v[44:45]
    v_pk_mul_f32 v[50:51], v[48:49], v[48:49]
    v_pk_fma_f32 v[38:39], v[38:39], s[60:61], v[2:3]
    v_pk_fma_f32 v[42:43], v[42:43], s[60:61], v[2:3]
    v_pk_fma_f32 v[46:47], v[46:47], s[60:61], v[2:3]
    v_pk_fma_f32 v[50:51], v[50:51], s[60:61], v[2:3]
    v_pk_mul_f32 v[38:39], v[38:39], v[36:37]
    v_pk_mul_f32 v[42:43], v[42:43], v[40:41]
    v_pk_mul_f32 v[46:47], v[46:47], v[44:45]
    v_pk_mul_f32 v[50:51], v[50:51], v[48:49]
    v_exp_f32 v38, v38
    v_exp_f32 v39, v39
    v_exp_f32 v42, v42
    v_exp_f32 v43, v43
    v_exp_f32 v46, v46
    v_exp_f32 v47, v47
    v_exp_f32 v50, v50
    v_exp_f32 v51, v51
    v_pk_add_f32 v[38:39], v[38:39], 1.0 op_sel_hi:[1,0]
    v_pk_add_f32 v[42:43], v[42:43], 1.0 op_sel_hi:[1,0]
    v_pk_add_f32 v[46:47], v[46:47], 1.0 op_sel_hi:[1,0]
    v_pk_add_f32 v[50:51], v[50:51], 1.0 op_sel_hi:[1,0]
    v_rcp_f32 v38, v38
    v_rcp_f32 v39, v39
    v_rcp_f32 v42, v42
    v_rcp_f32 v43, v43
    v_rcp_f32 v46, v46
    v_rcp_f32 v47, v47
    v_rcp_f32 v50, v50
    v_rcp_f32 v51, v51
    v_pk_mul_f32 v[36:37], v[36:37], v[38:39]
    v_pk_mul_f32 v[40:41], v[40:41], v[42:43]
    v_pk_mul_f32 v[44:45], v[44:45], v[46:47]
    v_pk_mul_f32 v[48:49], v[48:49], v[50:51]
    v_cvt_pk_bf16_f32 v56, v36, v37
    v_cvt_pk_bf16_f32 v57, v40, v41
    v_cvt_pk_bf16_f32 v58, v44, v45
    v_cvt_pk_bf16_f32 v59, v48, v49
    s_add_u32 s47, s45, 23552
    buffer_store_dwordx4 v[56:59], v60, s[16:19], s47 offen sc1
    s_add_u32 s78, s36, 0
    s_add_u32 s72, s52, 23592960
    s_addc_u32 s73, s53, 0
    s_mov_b32 s74, 65536
    s_mov_b32 s75, 0x20000
    v_and_b32 v60, 1, v1
    v_lshrrev_b32 v61, 1, v1
    v_mov_b32 v56, v60
    v_mov_b32 v57, s35
    v_and_b32 v58, 3, v57
    v_lshl_add_u32 v56, v58, 1, v56
    v_lshrrev_b32 v57, 2, v57
    v_mov_b32 v58, v61
    v_and_b32 v59, 3, v58
    v_lshl_add_u32 v56, v59, 3, v56
    v_lshrrev_b32 v58, 2, v58
    v_lshl_add_u32 v57, v58, 1, v57
    v_lshl_add_u32 v56, v56, 3, v57
    v_lshlrev_b32 v56, 6, v56
    v_add_u32 v56, s78, v56
    v_lshlrev_b32 v56, 2, v56
    v_mov_b32 v57, 0x7ffffff0
    v_cmp_gt_u32 vcc, 32, v1
    s_nop 1
    v_cndmask_b32 v56, v57, v56, vcc
    v_mov_b32 v62, v56
    s_branch gated_mix__linear_kernel_hedgehog__mixer_channel_mlp__prompt_kernel_p2
gated_mix__linear_kernel_hedgehog__mixer_channel_mlp__prompt_kernel_qkv:
    s_lshl_b32 s44, s35, 19
    s_add_u32 s8, s4, s44
    s_addc_u32 s9, s5, 0
    s_mov_b32 s10, 524288
    s_mov_b32 s11, 0x20000
    s_lshl_b32 s44, s36, 7
    s_add_u32 s12, s70, s44
    s_addc_u32 s13, s71, 0
    s_sub_u32 s14, 6291456, s44
    s_mov_b32 s15, 0x20000
    s_movk_i32 s46, 6144
    s_cmp_lt_u32 s32, 2
    s_cselect_b32 s20, s12, s8
    s_cselect_b32 s21, s13, s9
    s_cselect_b32 s22, s14, s10
    s_mov_b32 s23, 0x20000
    s_movk_i32 s45, 128
    s_cselect_b32 s43, 393216, s45
    s_and_b32 s44, s35, 3
    s_lshl_b32 s44, s44, 4
    s_lshl_b32 s45, s32, 3
    s_add_u32 s44, s44, s45
    v_lshrrev_b32 v24, 2, v1
    v_add_u32 v24, s44, v24
    v_mul_u32_u24 v24, s46, v24
    v_and_b32 v25, 3, v1
    v_min_u32 v25, 2, v25
    v_lshlrev_b32 v25, 11, v25
    v_add_u32 v24, v24, v25
    s_and_b32 s44, s36, 3
    s_lshl_b32 s44, s44, 1
    s_add_u32 s44, s44, s38
    s_lshl_b32 s44, s44, 5
    s_and_b32 s45, s32, 1
    s_lshl_b32 s45, s45, 4
    s_add_u32 s44, s44, s45
    v_add_u32 v25, s44, v1
    v_lshlrev_b32 v25, 11, v25
    s_cmp_lt_u32 s32, 2
    s_cselect_b32 s44, 32, 16
    s_cselect_b64 vcc, -1, 0
    v_cndmask_b32 v24, v25, v24, vcc
    v_cmp_gt_u32 vcc, s44, v1
    v_mov_b32 v25, 0x7ffffff0
    s_nop 0
    v_cndmask_b32 v22, v25, v24, vcc
    s_mov_b32 s42, 0
    buffer_load_dword a251, v22, s[20:23], s42 offen
    s_add_u32 s42, s42, s43
    buffer_load_dword a251, v22, s[20:23], s42 offen
    s_add_u32 s42, s42, s43
    buffer_load_dword a251, v22, s[20:23], s42 offen
    s_add_u32 s42, s42, s43
    v_lshrrev_b32 v24, 3, v1
    s_lshl_b32 s44, s32, 6
    v_add_u32 v24, s44, v24
    v_lshlrev_b32 v24, 11, v24
    v_and_b32 v25, 7, v1
    v_lshrrev_b32 v26, 4, v1
    v_xor_b32 v25, v25, v26
    v_lshlrev_b32 v25, 4, v25
    v_add_u32 v2, v24, v25
    v_xor_b32 v24, 64, v2
    v_add_u32 v3, 15360, v24
    v_add_u32 v4, 30720, v2
    v_xor_b32 v24, 64, v2
    v_add_u32 v5, 46080, v24
    v_add_u32 v6, 65536, v2
    v_xor_b32 v24, 64, v2
    v_add_u32 v7, 80896, v24
    v_add_u32 v8, 96256, v2
    v_xor_b32 v24, 64, v2
    v_add_u32 v9, 111616, v24
    s_mul_i32 s44, s32, 384
    s_movk_i32 s45, 2731
    s_movk_i32 s46, 6144
    v_add_u32 v24, s44, v1
    v_mul_u32_u24 v25, s45, v24
    v_lshrrev_b32 v25, 16, v25
    v_mul_u32_u24 v26, 24, v25
    v_sub_u32 v26, v24, v26
    v_bfe_u32 v27, v25, 1, 1
    v_bfe_u32 v28, v25, 3, 1
    v_lshlrev_b32 v28, 1, v28
    v_or_b32 v27, v27, v28
    v_lshlrev_b32 v27, 1, v27
    v_xor_b32 v26, v26, v27
    v_lshrrev_b32 v27, 3, v26
    v_and_b32 v26, 7, v26
    v_lshlrev_b32 v26, 4, v26
    v_lshlrev_b32 v27, 11, v27
    v_add_u32 v26, v26, v27
    v_mul_u32_u24 v25, s46, v25
    v_add_u32 v10, v25, v26
    v_add_u32 v24, s44, v1
    v_add_u32 v24, 64, v24
    v_mul_u32_u24 v25, s45, v24
    v_lshrrev_b32 v25, 16, v25
    v_mul_u32_u24 v26, 24, v25
    v_sub_u32 v26, v24, v26
    v_bfe_u32 v27, v25, 1, 1
    v_bfe_u32 v28, v25, 3, 1
    v_lshlrev_b32 v28, 1, v28
    v_or_b32 v27, v27, v28
    v_lshlrev_b32 v27, 1, v27
    v_xor_b32 v26, v26, v27
    v_lshrrev_b32 v27, 3, v26
    v_and_b32 v26, 7, v26
    v_lshlrev_b32 v26, 4, v26
    v_lshlrev_b32 v27, 11, v27
    v_add_u32 v26, v26, v27
    v_mul_u32_u24 v25, s46, v25
    v_add_u32 v11, v25, v26
    v_subrev_u32 v11, 1024, v11
    v_add_u32 v24, s44, v1
    v_add_u32 v24, 128, v24
    v_mul_u32_u24 v25, s45, v24
    v_lshrrev_b32 v25, 16, v25
    v_mul_u32_u24 v26, 24, v25
    v_sub_u32 v26, v24, v26
    v_bfe_u32 v27, v25, 1, 1
    v_bfe_u32 v28, v25, 3, 1
    v_lshlrev_b32 v28, 1, v28
    v_or_b32 v27, v27, v28
    v_lshlrev_b32 v27, 1, v27
    v_xor_b32 v26, v26, v27
    v_lshrrev_b32 v27, 3, v26
    v_and_b32 v26, 7, v26
    v_lshlrev_b32 v26, 4, v26
    v_lshlrev_b32 v27, 11, v27
    v_add_u32 v26, v26, v27
    v_mul_u32_u24 v25, s46, v25
    v_add_u32 v12, v25, v26
    v_subrev_u32 v12, 2048, v12
    v_add_u32 v24, s44, v1
    v_add_u32 v24, 192, v24
    v_mul_u32_u24 v25, s45, v24
    v_lshrrev_b32 v25, 16, v25
    v_mul_u32_u24 v26, 24, v25
    v_sub_u32 v26, v24, v26
    v_bfe_u32 v27, v25, 1, 1
    v_bfe_u32 v28, v25, 3, 1
    v_lshlrev_b32 v28, 1, v28
    v_or_b32 v27, v27, v28
    v_lshlrev_b32 v27, 1, v27
    v_xor_b32 v26, v26, v27
    v_lshrrev_b32 v27, 3, v26
    v_and_b32 v26, 7, v26
    v_lshlrev_b32 v26, 4, v26
    v_lshlrev_b32 v27, 11, v27
    v_add_u32 v26, v26, v27
    v_mul_u32_u24 v25, s46, v25
    v_add_u32 v13, v25, v26
    v_subrev_u32 v13, 3072, v13
    v_add_u32 v24, s44, v1
    v_add_u32 v24, 256, v24
    v_mul_u32_u24 v25, s45, v24
    v_lshrrev_b32 v25, 16, v25
    v_mul_u32_u24 v26, 24, v25
    v_sub_u32 v26, v24, v26
    v_bfe_u32 v27, v25, 1, 1
    v_bfe_u32 v28, v25, 3, 1
    v_lshlrev_b32 v28, 1, v28
    v_or_b32 v27, v27, v28
    v_lshlrev_b32 v27, 1, v27
    v_xor_b32 v26, v26, v27
    v_lshrrev_b32 v27, 3, v26
    v_and_b32 v26, 7, v26
    v_lshlrev_b32 v26, 4, v26
    v_lshlrev_b32 v27, 11, v27
    v_add_u32 v26, v26, v27
    v_mul_u32_u24 v25, s46, v25
    v_add_u32 v14, v25, v26
    v_add_u32 v24, s44, v1
    v_add_u32 v24, 320, v24
    v_mul_u32_u24 v25, s45, v24
    v_lshrrev_b32 v25, 16, v25
    v_mul_u32_u24 v26, 24, v25
    v_sub_u32 v26, v24, v26
    v_bfe_u32 v27, v25, 1, 1
    v_bfe_u32 v28, v25, 3, 1
    v_lshlrev_b32 v28, 1, v28
    v_or_b32 v27, v27, v28
    v_lshlrev_b32 v27, 1, v27
    v_xor_b32 v26, v26, v27
    v_lshrrev_b32 v27, 3, v26
    v_and_b32 v26, 7, v26
    v_lshlrev_b32 v26, 4, v26
    v_lshlrev_b32 v27, 11, v27
    v_add_u32 v26, v26, v27
    v_mul_u32_u24 v25, s46, v25
    v_add_u32 v15, v25, v26
    v_subrev_u32 v15, 1024, v15
    s_lshl_b32 s44, s32, 13
    s_add_u32 s24, s44, 0
    s_add_u32 s25, s24, 4096
    s_mul_i32 s44, s32, 6144
    s_add_u32 s26, s44, 65536
    s_add_u32 s27, s26, 4096
    s_lshl_b32 s44, s32, 13
    s_add_u32 s28, s44, 32768
    s_add_u32 s29, s28, 4096
    s_mul_i32 s44, s32, 6144
    s_add_u32 s30, s44, 90112
    s_add_u32 s31, s30, 4096
    s_mov_b32 s40, 0
    s_mov_b32 s41, 0
    v_and_b32 v24, 15, v1
    v_lshrrev_b32 v25, 4, v1
    s_lshl_b32 s44, s33, 7
    v_add_u32 v26, s44, v24
    v_lshlrev_b32 v26, 7, v26
    v_lshrrev_b32 v27, 1, v24
    v_xor_b32 v27, v27, v25
    v_lshlrev_b32 v27, 4, v27
    v_add_u32 v17, v26, v27
    v_xor_b32 v18, 64, v17
    v_lshrrev_b32 v26, 2, v24
    v_lshlrev_b32 v27, 3, v25
    v_add_u32 v26, v26, v27
    s_movk_i32 s45, 384
    v_mul_u32_u24 v26, s45, v26
    v_and_b32 v27, 3, v1
    v_lshlrev_b32 v27, 3, v27
    v_add_u32 v26, v26, v27
    v_add_u32 v26, 65536, v26
    v_bfe_u32 v27, v24, 3, 1
    v_and_b32 v28, 1, v25
    v_lshlrev_b32 v28, 1, v28
    v_or_b32 v27, v27, v28
    s_lshl_b32 s44, s34, 1
    v_xor_b32 v28, s44, v27
    v_lshlrev_b32 v28, 5, v28
    v_add_u32 v19, v26, v28
    v_xor_b32 v28, s44, v27
    v_xor_b32 v28, 1, v28
    v_lshlrev_b32 v28, 5, v28
    v_add_u32 v20, v26, v28
    s_mov_b32 m0, s24
    s_nop 0
    buffer_load_dwordx4 v2, s[8:11], s40 offen lds
    buffer_load_dwordx4 v3, s[8:11], s40 offen offset:1024 lds
    buffer_load_dwordx4 v4, s[8:11], s40 offen offset:2048 lds
    buffer_load_dwordx4 v5, s[8:11], s40 offen offset:3072 lds
    s_mov_b32 m0, s25
    s_nop 0
    buffer_load_dwordx4 v6, s[8:11], s40 offen lds
    buffer_load_dwordx4 v7, s[8:11], s40 offen offset:1024 lds
    buffer_load_dwordx4 v8, s[8:11], s40 offen offset:2048 lds
    buffer_load_dwordx4 v9, s[8:11], s40 offen offset:3072 lds
    s_mov_b32 m0, s26
    s_nop 0
    buffer_load_dwordx4 v10, s[12:15], s41 offen lds
    buffer_load_dwordx4 v11, s[12:15], s41 offen offset:1024 lds
    buffer_load_dwordx4 v12, s[12:15], s41 offen offset:2048 lds
    buffer_load_dwordx4 v13, s[12:15], s41 offen offset:3072 lds
    s_mov_b32 m0, s27
    s_nop 0
    buffer_load_dwordx4 v14, s[12:15], s41 offen lds
    buffer_load_dwordx4 v15, s[12:15], s41 offen offset:1024 lds
    s_add_u32 s40, s40, 128
    s_add_u32 s41, s41, 393216
    s_mov_b32 m0, s28
    s_nop 0
    buffer_load_dwordx4 v2, s[8:11], s40 offen lds
    buffer_load_dwordx4 v3, s[8:11], s40 offen offset:1024 lds
    buffer_load_dwordx4 v4, s[8:11], s40 offen offset:2048 lds
    buffer_load_dwordx4 v5, s[8:11], s40 offen offset:3072 lds
    s_mov_b32 m0, s29
    s_nop 0
    buffer_load_dwordx4 v6, s[8:11], s40 offen lds
    buffer_load_dwordx4 v7, s[8:11], s40 offen offset:1024 lds
    buffer_load_dwordx4 v8, s[8:11], s40 offen offset:2048 lds
    buffer_load_dwordx4 v9, s[8:11], s40 offen offset:3072 lds
    s_mov_b32 m0, s30
    s_nop 0
    buffer_load_dwordx4 v10, s[12:15], s41 offen lds
    buffer_load_dwordx4 v11, s[12:15], s41 offen offset:1024 lds
    buffer_load_dwordx4 v12, s[12:15], s41 offen offset:2048 lds
    buffer_load_dwordx4 v13, s[12:15], s41 offen offset:3072 lds
    s_mov_b32 m0, s31
    s_nop 0
    buffer_load_dwordx4 v14, s[12:15], s41 offen lds
    buffer_load_dwordx4 v15, s[12:15], s41 offen offset:1024 lds
    s_add_u32 s40, s40, 128
    s_add_u32 s41, s41, 393216
    buffer_load_dword a251, v22, s[20:23], s42 offen
    s_add_u32 s42, s42, s43
    s_lshl_b32 s44, s36, 12
    s_add_u32 s56, s74, s44
    s_addc_u32 s57, s75, 0
    s_mov_b32 s58, 4096
    s_mov_b32 s59, 0x20000
    v_lshlrev_b32 v63, 4, v0
    s_lshl_b32 s44, s32, 10
    s_add_u32 s44, s44, 114688
    s_mov_b32 m0, s44
    s_nop 0
    buffer_load_dwordx4 v63, s[56:59], 0 offen lds
    v_lshrrev_b32 v25, 4, v1
    v_bfe_u32 v26, v1, 2, 2
    v_cmp_eq_u32 vcc, v25, v26
    v_and_b32 v27, 1, v1
    v_lshlrev_b32 v27, 4, v27
    v_mov_b32 v28, 0x3f80
    v_lshlrev_b32 v28, v27, v28
    v_cndmask_b32 v28, 0, v28, vcc
    v_and_b32 v27, 2, v1
    v_cmp_eq_u32 vcc, 0, v27
    s_nop 1
    v_cndmask_b32 v29, 0, v28, vcc
    v_sub_u32 v30, v28, v29
    v_accvgpr_write_b32 a208, 0
    v_accvgpr_write_b32 a209, 0
    v_accvgpr_write_b32 a210, v29
    v_accvgpr_write_b32 a211, v30
    v_accvgpr_write_b32 a212, 0
    v_accvgpr_write_b32 a213, 0
    v_mov_b32 v31, 0x3f803f80
    v_accvgpr_write_b32 a216, v31
    v_accvgpr_write_b32 a217, v31
    v_accvgpr_write_b32 a218, v31
    v_accvgpr_write_b32 a219, v31
    s_lshl_b32 s44, s35, 4
    s_add_u32 s44, s44, s36
    s_lshl_b32 s44, s44, 2
    s_add_u32 s44, s44, s32
    s_lshl_b32 s44, s44, 13
    s_add_u32 s56, s4, s44
    s_addc_u32 s57, s5, 0
    s_mov_b32 s58, 8192
    s_mov_b32 s59, 0x20000
    v_lshlrev_b32 v62, 4, v1
    s_mov_b32 s16, s6
    s_mov_b32 s17, s7
    s_mov_b32 s18, 2048
    s_mov_b32 s19, 0x20000
    buffer_load_dwordx4 v[40:43], v62, s[16:19], 0 offen
    buffer_load_dwordx4 v[44:47], v62, s[16:19], 0 offen offset:1024
    s_mov_b32 s67, 0
    s_waitcnt vmcnt(18)
    s_barrier
    ds_read_b64_tr_b16 a[32:33], v19 offset:0
    ds_read_b64_tr_b16 a[34:35], v19 offset:1536
    ds_read_b128 a[0:3], v17 offset:0
    ds_read_b128 a[4:7], v17 offset:2048
    ds_read_b128 a[8:11], v17 offset:4096
    ds_read_b128 a[12:15], v17 offset:6144
    ds_read_b128 a[16:19], v17 offset:8192
    ds_read_b128 a[20:23], v17 offset:10240
    ds_read_b128 a[24:27], v17 offset:12288
    ds_read_b128 a[28:31], v17 offset:14336
    ds_read_b64_tr_b16 a[36:37], v20 offset:0
    ds_read_b64_tr_b16 a[38:39], v20 offset:1536
    ds_read_b64_tr_b16 a[40:41], v19 offset:128
    ds_read_b64_tr_b16 a[42:43], v19 offset:1664
    ds_read_b64_tr_b16 a[44:45], v20 offset:128
    ds_read_b64_tr_b16 a[46:47], v20 offset:1664
    ds_read_b64_tr_b16 a[48:49], v19 offset:256
    ds_read_b64_tr_b16 a[50:51], v19 offset:1792
    ds_read_b64_tr_b16 a[52:53], v20 offset:256
    ds_read_b64_tr_b16 a[54:55], v20 offset:1792
    s_mov_b32 s72, s52
    s_mov_b32 s73, s53
    s_mov_b32 s74, 0
    s_mov_b32 s75, 0x20000
    s_cmp_lg_u32 s32, 0
    s_cbranch_scc1 ini_17
    v_mov_b32 v56, 0
    v_mov_b32 v57, 1
    v_cmp_eq_u32 vcc, 0, v1
    s_nop 1
    s_and_saveexec_b64 s[50:51], vcc
    global_atomic_add v56, v57, s[68:69] sc1
    s_mov_b64 exec, s[50:51]
ini_17:
    v_mov_b32 v61, 0
    s_waitcnt lgkmcnt(0)
    v_mfma_f32_16x16x32_bf16 v[64:67], a[32:35], a[0:3], 0
    ds_read_b64_tr_b16 a[88:89], v19 offset:12288
    v_mfma_f32_16x16x32_bf16 v[88:91], a[32:35], a[4:7], 0
    ds_read_b64_tr_b16 a[90:91], v19 offset:13824
    v_mfma_f32_16x16x32_bf16 v[112:115], a[32:35], a[8:11], 0
    v_mfma_f32_16x16x32_bf16 v[136:139], a[32:35], a[12:15], 0
    ds_read_b128 a[56:59], v18 offset:0
    v_mfma_f32_16x16x32_bf16 v[160:163], a[32:35], a[16:19], 0
    ds_read_b128 a[60:63], v18 offset:2048
    v_mfma_f32_16x16x32_bf16 v[184:187], a[32:35], a[20:23], 0
    v_mfma_f32_16x16x32_bf16 v[208:211], a[32:35], a[24:27], 0
    ds_read_b128 a[64:67], v18 offset:4096
    v_mfma_f32_16x16x32_bf16 v[232:235], a[32:35], a[28:31], 0
    ds_read_b128 a[68:71], v18 offset:6144
    v_mfma_f32_16x16x32_bf16 v[68:71], a[36:39], a[0:3], 0
    v_mfma_f32_16x16x32_bf16 v[92:95], a[36:39], a[4:7], 0
    ds_read_b128 a[72:75], v18 offset:8192
    v_mfma_f32_16x16x32_bf16 v[116:119], a[36:39], a[8:11], 0
    v_mfma_f32_16x16x32_bf16 v[140:143], a[36:39], a[12:15], 0
    ds_read_b128 a[76:79], v18 offset:10240
    v_mfma_f32_16x16x32_bf16 v[164:167], a[36:39], a[16:19], 0
    ds_read_b128 a[80:83], v18 offset:12288
    v_mfma_f32_16x16x32_bf16 v[188:191], a[36:39], a[20:23], 0
    v_mfma_f32_16x16x32_bf16 v[212:215], a[36:39], a[24:27], 0
    ds_read_b128 a[84:87], v18 offset:14336
    v_mfma_f32_16x16x32_bf16 v[236:239], a[36:39], a[28:31], 0
    ds_read_b64_tr_b16 a[92:93], v20 offset:12288
    v_mfma_f32_16x16x32_bf16 v[72:75], a[40:43], a[0:3], 0
    v_mfma_f32_16x16x32_bf16 v[96:99], a[40:43], a[4:7], 0
    ds_read_b64_tr_b16 a[94:95], v20 offset:13824
    v_mfma_f32_16x16x32_bf16 v[120:123], a[40:43], a[8:11], 0
    ds_read_b64_tr_b16 a[96:97], v19 offset:12416
    v_mfma_f32_16x16x32_bf16 v[144:147], a[40:43], a[12:15], 0
    v_mfma_f32_16x16x32_bf16 v[168:171], a[40:43], a[16:19], 0
    ds_read_b64_tr_b16 a[98:99], v19 offset:13952
    v_mfma_f32_16x16x32_bf16 v[192:195], a[40:43], a[20:23], 0
    v_mfma_f32_16x16x32_bf16 v[216:219], a[40:43], a[24:27], 0
    ds_read_b64_tr_b16 a[100:101], v20 offset:12416
    v_mfma_f32_16x16x32_bf16 v[240:243], a[40:43], a[28:31], 0
    ds_read_b64_tr_b16 a[102:103], v20 offset:13952
    v_mfma_f32_16x16x32_bf16 v[76:79], a[44:47], a[0:3], 0
    v_mfma_f32_16x16x32_bf16 v[100:103], a[44:47], a[4:7], 0
    ds_read_b64_tr_b16 a[104:105], v19 offset:12544
    v_mfma_f32_16x16x32_bf16 v[124:127], a[44:47], a[8:11], 0
    ds_read_b64_tr_b16 a[106:107], v19 offset:14080
    v_mfma_f32_16x16x32_bf16 v[148:151], a[44:47], a[12:15], 0
    v_mfma_f32_16x16x32_bf16 v[172:175], a[44:47], a[16:19], 0
    ds_read_b64_tr_b16 a[108:109], v20 offset:12544
    v_mfma_f32_16x16x32_bf16 v[196:199], a[44:47], a[20:23], 0
    v_mfma_f32_16x16x32_bf16 v[220:223], a[44:47], a[24:27], 0
    ds_read_b64_tr_b16 a[110:111], v20 offset:14080
    v_mfma_f32_16x16x32_bf16 v[244:247], a[44:47], a[28:31], 0
    v_mfma_f32_16x16x32_bf16 v[80:83], a[0:3], a[48:51], 0
    v_mfma_f32_16x16x32_bf16 v[104:107], a[4:7], a[48:51], 0
    v_mfma_f32_16x16x32_bf16 v[128:131], a[8:11], a[48:51], 0
    s_waitcnt vmcnt(4) lgkmcnt(0)
    s_barrier
    v_mfma_f32_16x16x32_bf16 v[152:155], a[12:15], a[48:51], 0
    s_mov_b32 m0, s24
    v_mfma_f32_16x16x32_bf16 v[176:179], a[16:19], a[48:51], 0
    v_mfma_f32_16x16x32_bf16 v[200:203], a[20:23], a[48:51], 0
    v_mfma_f32_16x16x32_bf16 v[224:227], a[24:27], a[48:51], 0
    buffer_load_dwordx4 v2, s[8:11], s40 offen lds
    v_mfma_f32_16x16x32_bf16 v[248:251], a[28:31], a[48:51], 0
    v_mfma_f32_16x16x32_bf16 v[84:87], a[0:3], a[52:55], 0
    v_mfma_f32_16x16x32_bf16 v[108:111], a[4:7], a[52:55], 0
    buffer_load_dwordx4 v3, s[8:11], s40 offen offset:1024 lds
    v_mfma_f32_16x16x32_bf16 v[132:135], a[8:11], a[52:55], 0
    v_mfma_f32_16x16x32_bf16 v[156:159], a[12:15], a[52:55], 0
    v_mfma_f32_16x16x32_bf16 v[180:183], a[16:19], a[52:55], 0
    buffer_load_dwordx4 v4, s[8:11], s40 offen offset:2048 lds
    v_mfma_f32_16x16x32_bf16 v[204:207], a[20:23], a[52:55], 0
    v_mfma_f32_16x16x32_bf16 v[228:231], a[24:27], a[52:55], 0
    v_mfma_f32_16x16x32_bf16 v[252:255], a[28:31], a[52:55], 0
    buffer_load_dwordx4 v5, s[8:11], s40 offen offset:3072 lds
    v_mfma_f32_16x16x32_bf16 v[64:67], a[88:91], a[56:59], v[64:67]
    ds_read_b64_tr_b16 a[32:33], v19 offset:24576
    v_mfma_f32_16x16x32_bf16 v[88:91], a[88:91], a[60:63], v[88:91]
    ds_read_b64_tr_b16 a[34:35], v19 offset:26112
    v_mfma_f32_16x16x32_bf16 v[112:115], a[88:91], a[64:67], v[112:115]
    s_mov_b32 m0, s25
    v_mfma_f32_16x16x32_bf16 v[136:139], a[88:91], a[68:71], v[136:139]
    ds_read_b128 a[0:3], v17 offset:32768
    v_mfma_f32_16x16x32_bf16 v[160:163], a[88:91], a[72:75], v[160:163]
    v_mfma_f32_16x16x32_bf16 v[184:187], a[88:91], a[76:79], v[184:187]
    buffer_load_dwordx4 v6, s[8:11], s40 offen lds
    ds_read_b128 a[4:7], v17 offset:34816
    v_mfma_f32_16x16x32_bf16 v[208:211], a[88:91], a[80:83], v[208:211]
    v_mfma_f32_16x16x32_bf16 v[232:235], a[88:91], a[84:87], v[232:235]
    ds_read_b128 a[8:11], v17 offset:36864
    v_mfma_f32_16x16x32_bf16 v[68:71], a[92:95], a[56:59], v[68:71]
    buffer_load_dwordx4 v7, s[8:11], s40 offen offset:1024 lds
    ds_read_b128 a[12:15], v17 offset:38912
    v_mfma_f32_16x16x32_bf16 v[92:95], a[92:95], a[60:63], v[92:95]
    v_mfma_f32_16x16x32_bf16 v[116:119], a[92:95], a[64:67], v[116:119]
    ds_read_b128 a[16:19], v17 offset:40960
    v_mfma_f32_16x16x32_bf16 v[140:143], a[92:95], a[68:71], v[140:143]
    buffer_load_dwordx4 v8, s[8:11], s40 offen offset:2048 lds
    v_mfma_f32_16x16x32_bf16 v[164:167], a[92:95], a[72:75], v[164:167]
    ds_read_b128 a[20:23], v17 offset:43008
    v_mfma_f32_16x16x32_bf16 v[188:191], a[92:95], a[76:79], v[188:191]
    v_mfma_f32_16x16x32_bf16 v[212:215], a[92:95], a[80:83], v[212:215]
    ds_read_b128 a[24:27], v17 offset:45056
    v_mfma_f32_16x16x32_bf16 v[236:239], a[92:95], a[84:87], v[236:239]
    buffer_load_dwordx4 v9, s[8:11], s40 offen offset:3072 lds
    v_mfma_f32_16x16x32_bf16 v[72:75], a[96:99], a[56:59], v[72:75]
    ds_read_b128 a[28:31], v17 offset:47104
    v_mfma_f32_16x16x32_bf16 v[96:99], a[96:99], a[60:63], v[96:99]
    ds_read_b64_tr_b16 a[36:37], v20 offset:24576
    v_mfma_f32_16x16x32_bf16 v[120:123], a[96:99], a[64:67], v[120:123]
    s_mov_b32 m0, s26
    v_mfma_f32_16x16x32_bf16 v[144:147], a[96:99], a[68:71], v[144:147]
    ds_read_b64_tr_b16 a[38:39], v20 offset:26112
    v_mfma_f32_16x16x32_bf16 v[168:171], a[96:99], a[72:75], v[168:171]
    v_mfma_f32_16x16x32_bf16 v[192:195], a[96:99], a[76:79], v[192:195]
    buffer_load_dwordx4 v10, s[12:15], s41 offen lds
    ds_read_b64_tr_b16 a[40:41], v19 offset:24704
    v_mfma_f32_16x16x32_bf16 v[216:219], a[96:99], a[80:83], v[216:219]
    v_mfma_f32_16x16x32_bf16 v[240:243], a[96:99], a[84:87], v[240:243]
    ds_read_b64_tr_b16 a[42:43], v19 offset:26240
    v_mfma_f32_16x16x32_bf16 v[76:79], a[100:103], a[56:59], v[76:79]
    buffer_load_dwordx4 v11, s[12:15], s41 offen offset:1024 lds
    v_mfma_f32_16x16x32_bf16 v[100:103], a[100:103], a[60:63], v[100:103]
    ds_read_b64_tr_b16 a[44:45], v20 offset:24704
    v_mfma_f32_16x16x32_bf16 v[124:127], a[100:103], a[64:67], v[124:127]
    ds_read_b64_tr_b16 a[46:47], v20 offset:26240
    v_mfma_f32_16x16x32_bf16 v[148:151], a[100:103], a[68:71], v[148:151]
    buffer_load_dwordx4 v12, s[12:15], s41 offen offset:2048 lds
    v_mfma_f32_16x16x32_bf16 v[172:175], a[100:103], a[72:75], v[172:175]
    ds_read_b64_tr_b16 a[48:49], v19 offset:24832
    v_mfma_f32_16x16x32_bf16 v[196:199], a[100:103], a[76:79], v[196:199]
    v_mfma_f32_16x16x32_bf16 v[220:223], a[100:103], a[80:83], v[220:223]
    buffer_load_dwordx4 v13, s[12:15], s41 offen offset:3072 lds
    ds_read_b64_tr_b16 a[50:51], v19 offset:26368
    v_mfma_f32_16x16x32_bf16 v[244:247], a[100:103], a[84:87], v[244:247]
    v_mfma_f32_16x16x32_bf16 v[80:83], a[56:59], a[104:107], v[80:83]
    ds_read_b64_tr_b16 a[52:53], v20 offset:24832
    v_mfma_f32_16x16x32_bf16 v[104:107], a[60:63], a[104:107], v[104:107]
    s_mov_b32 m0, s27
    v_mfma_f32_16x16x32_bf16 v[128:131], a[64:67], a[104:107], v[128:131]
    ds_read_b64_tr_b16 a[54:55], v20 offset:26368
    v_mfma_f32_16x16x32_bf16 v[152:155], a[68:71], a[104:107], v[152:155]
    v_mfma_f32_16x16x32_bf16 v[176:179], a[72:75], a[104:107], v[176:179]
    buffer_load_dwordx4 v14, s[12:15], s41 offen lds
    v_mfma_f32_16x16x32_bf16 v[200:203], a[76:79], a[104:107], v[200:203]
    v_mfma_f32_16x16x32_bf16 v[224:227], a[80:83], a[104:107], v[224:227]
    v_mfma_f32_16x16x32_bf16 v[248:251], a[84:87], a[104:107], v[248:251]
    v_mfma_f32_16x16x32_bf16 v[84:87], a[56:59], a[108:111], v[84:87]
    buffer_load_dwordx4 v15, s[12:15], s41 offen offset:1024 lds
    v_mfma_f32_16x16x32_bf16 v[108:111], a[60:63], a[108:111], v[108:111]
    s_add_u32 s40, s40, 128
    s_add_u32 s41, s41, 393216
    v_mfma_f32_16x16x32_bf16 v[132:135], a[64:67], a[108:111], v[132:135]
    buffer_load_dword a251, v22, s[20:23], s42 offen
    s_add_u32 s42, s42, s43
    v_mfma_f32_16x16x32_bf16 v[156:159], a[68:71], a[108:111], v[156:159]
    v_mfma_f32_16x16x32_bf16 v[180:183], a[72:75], a[108:111], v[180:183]
    v_mfma_f32_16x16x32_bf16 v[204:207], a[76:79], a[108:111], v[204:207]
    v_mfma_f32_16x16x32_bf16 v[228:231], a[80:83], a[108:111], v[228:231]
    v_mfma_f32_16x16x32_bf16 v[252:255], a[84:87], a[108:111], v[252:255]
    s_waitcnt lgkmcnt(0)
    v_mfma_f32_16x16x32_bf16 v[64:67], a[32:35], a[0:3], v[64:67]
    ds_read_b64_tr_b16 a[88:89], v19 offset:36864
    v_mfma_f32_16x16x32_bf16 v[88:91], a[32:35], a[4:7], v[88:91]
    ds_read_b64_tr_b16 a[90:91], v19 offset:38400
    v_mfma_f32_16x16x32_bf16 v[112:115], a[32:35], a[8:11], v[112:115]
    v_mfma_f32_16x16x32_bf16 v[136:139], a[32:35], a[12:15], v[136:139]
    ds_read_b128 a[56:59], v18 offset:32768
    v_mfma_f32_16x16x32_bf16 v[160:163], a[32:35], a[16:19], v[160:163]
    ds_read_b128 a[60:63], v18 offset:34816
    v_mfma_f32_16x16x32_bf16 v[184:187], a[32:35], a[20:23], v[184:187]
    v_mfma_f32_16x16x32_bf16 v[208:211], a[32:35], a[24:27], v[208:211]
    ds_read_b128 a[64:67], v18 offset:36864
    v_mfma_f32_16x16x32_bf16 v[232:235], a[32:35], a[28:31], v[232:235]
    ds_read_b128 a[68:71], v18 offset:38912
    v_mfma_f32_16x16x32_bf16 v[68:71], a[36:39], a[0:3], v[68:71]
    v_mfma_f32_16x16x32_bf16 v[92:95], a[36:39], a[4:7], v[92:95]
    ds_read_b128 a[72:75], v18 offset:40960
    v_mfma_f32_16x16x32_bf16 v[116:119], a[36:39], a[8:11], v[116:119]
    v_mfma_f32_16x16x32_bf16 v[140:143], a[36:39], a[12:15], v[140:143]
    ds_read_b128 a[76:79], v18 offset:43008
    v_mfma_f32_16x16x32_bf16 v[164:167], a[36:39], a[16:19], v[164:167]
    ds_read_b128 a[80:83], v18 offset:45056
    v_mfma_f32_16x16x32_bf16 v[188:191], a[36:39], a[20:23], v[188:191]
    v_mfma_f32_16x16x32_bf16 v[212:215], a[36:39], a[24:27], v[212:215]
    ds_read_b128 a[84:87], v18 offset:47104
    v_mfma_f32_16x16x32_bf16 v[236:239], a[36:39], a[28:31], v[236:239]
    ds_read_b64_tr_b16 a[92:93], v20 offset:36864
    v_mfma_f32_16x16x32_bf16 v[72:75], a[40:43], a[0:3], v[72:75]
    v_mfma_f32_16x16x32_bf16 v[96:99], a[40:43], a[4:7], v[96:99]
    ds_read_b64_tr_b16 a[94:95], v20 offset:38400
    v_mfma_f32_16x16x32_bf16 v[120:123], a[40:43], a[8:11], v[120:123]
    ds_read_b64_tr_b16 a[96:97], v19 offset:36992
    v_mfma_f32_16x16x32_bf16 v[144:147], a[40:43], a[12:15], v[144:147]
    v_mfma_f32_16x16x32_bf16 v[168:171], a[40:43], a[16:19], v[168:171]
    ds_read_b64_tr_b16 a[98:99], v19 offset:38528
    v_mfma_f32_16x16x32_bf16 v[192:195], a[40:43], a[20:23], v[192:195]
    v_mfma_f32_16x16x32_bf16 v[216:219], a[40:43], a[24:27], v[216:219]
    ds_read_b64_tr_b16 a[100:101], v20 offset:36992
    v_mfma_f32_16x16x32_bf16 v[240:243], a[40:43], a[28:31], v[240:243]
    ds_read_b64_tr_b16 a[102:103], v20 offset:38528
    v_mfma_f32_16x16x32_bf16 v[76:79], a[44:47], a[0:3], v[76:79]
    v_mfma_f32_16x16x32_bf16 v[100:103], a[44:47], a[4:7], v[100:103]
    ds_read_b64_tr_b16 a[104:105], v19 offset:37120
    v_mfma_f32_16x16x32_bf16 v[124:127], a[44:47], a[8:11], v[124:127]
    ds_read_b64_tr_b16 a[106:107], v19 offset:38656
    v_mfma_f32_16x16x32_bf16 v[148:151], a[44:47], a[12:15], v[148:151]
    v_mfma_f32_16x16x32_bf16 v[172:175], a[44:47], a[16:19], v[172:175]
    ds_read_b64_tr_b16 a[108:109], v20 offset:37120
    v_mfma_f32_16x16x32_bf16 v[196:199], a[44:47], a[20:23], v[196:199]
    v_mfma_f32_16x16x32_bf16 v[220:223], a[44:47], a[24:27], v[220:223]
    ds_read_b64_tr_b16 a[110:111], v20 offset:38656
    v_mfma_f32_16x16x32_bf16 v[244:247], a[44:47], a[28:31], v[244:247]
    v_mfma_f32_16x16x32_bf16 v[80:83], a[0:3], a[48:51], v[80:83]
    v_mfma_f32_16x16x32_bf16 v[104:107], a[4:7], a[48:51], v[104:107]
    v_mfma_f32_16x16x32_bf16 v[128:131], a[8:11], a[48:51], v[128:131]
    s_waitcnt vmcnt(1) lgkmcnt(0)
    s_barrier
    v_mfma_f32_16x16x32_bf16 v[152:155], a[12:15], a[48:51], v[152:155]
    s_mov_b32 m0, s28
    v_mfma_f32_16x16x32_bf16 v[176:179], a[16:19], a[48:51], v[176:179]
    v_mfma_f32_16x16x32_bf16 v[200:203], a[20:23], a[48:51], v[200:203]
    v_mfma_f32_16x16x32_bf16 v[224:227], a[24:27], a[48:51], v[224:227]
    buffer_load_dwordx4 v2, s[8:11], s40 offen lds
    v_mfma_f32_16x16x32_bf16 v[248:251], a[28:31], a[48:51], v[248:251]
    v_mfma_f32_16x16x32_bf16 v[84:87], a[0:3], a[52:55], v[84:87]
    v_mfma_f32_16x16x32_bf16 v[108:111], a[4:7], a[52:55], v[108:111]
    buffer_load_dwordx4 v3, s[8:11], s40 offen offset:1024 lds
    v_mfma_f32_16x16x32_bf16 v[132:135], a[8:11], a[52:55], v[132:135]
    v_mfma_f32_16x16x32_bf16 v[156:159], a[12:15], a[52:55], v[156:159]
    v_mfma_f32_16x16x32_bf16 v[180:183], a[16:19], a[52:55], v[180:183]
    buffer_load_dwordx4 v4, s[8:11], s40 offen offset:2048 lds
    v_mfma_f32_16x16x32_bf16 v[204:207], a[20:23], a[52:55], v[204:207]
    v_mfma_f32_16x16x32_bf16 v[228:231], a[24:27], a[52:55], v[228:231]
    v_mfma_f32_16x16x32_bf16 v[252:255], a[28:31], a[52:55], v[252:255]
    buffer_load_dwordx4 v5, s[8:11], s40 offen offset:3072 lds
    v_mfma_f32_16x16x32_bf16 v[64:67], a[88:91], a[56:59], v[64:67]
    ds_read_b64_tr_b16 a[32:33], v19 offset:0
    v_mfma_f32_16x16x32_bf16 v[88:91], a[88:91], a[60:63], v[88:91]
    ds_read_b64_tr_b16 a[34:35], v19 offset:1536
    v_mfma_f32_16x16x32_bf16 v[112:115], a[88:91], a[64:67], v[112:115]
    s_mov_b32 m0, s29
    v_mfma_f32_16x16x32_bf16 v[136:139], a[88:91], a[68:71], v[136:139]
    ds_read_b128 a[0:3], v17 offset:0
    v_mfma_f32_16x16x32_bf16 v[160:163], a[88:91], a[72:75], v[160:163]
    v_mfma_f32_16x16x32_bf16 v[184:187], a[88:91], a[76:79], v[184:187]
    buffer_load_dwordx4 v6, s[8:11], s40 offen lds
    ds_read_b128 a[4:7], v17 offset:2048
    v_mfma_f32_16x16x32_bf16 v[208:211], a[88:91], a[80:83], v[208:211]
    v_mfma_f32_16x16x32_bf16 v[232:235], a[88:91], a[84:87], v[232:235]
    ds_read_b128 a[8:11], v17 offset:4096
    v_mfma_f32_16x16x32_bf16 v[68:71], a[92:95], a[56:59], v[68:71]
    buffer_load_dwordx4 v7, s[8:11], s40 offen offset:1024 lds
    ds_read_b128 a[12:15], v17 offset:6144
    v_mfma_f32_16x16x32_bf16 v[92:95], a[92:95], a[60:63], v[92:95]
    v_mfma_f32_16x16x32_bf16 v[116:119], a[92:95], a[64:67], v[116:119]
    ds_read_b128 a[16:19], v17 offset:8192
    v_mfma_f32_16x16x32_bf16 v[140:143], a[92:95], a[68:71], v[140:143]
    buffer_load_dwordx4 v8, s[8:11], s40 offen offset:2048 lds
    v_mfma_f32_16x16x32_bf16 v[164:167], a[92:95], a[72:75], v[164:167]
    ds_read_b128 a[20:23], v17 offset:10240
    v_mfma_f32_16x16x32_bf16 v[188:191], a[92:95], a[76:79], v[188:191]
    v_mfma_f32_16x16x32_bf16 v[212:215], a[92:95], a[80:83], v[212:215]
    ds_read_b128 a[24:27], v17 offset:12288
    v_mfma_f32_16x16x32_bf16 v[236:239], a[92:95], a[84:87], v[236:239]
    buffer_load_dwordx4 v9, s[8:11], s40 offen offset:3072 lds
    v_mfma_f32_16x16x32_bf16 v[72:75], a[96:99], a[56:59], v[72:75]
    ds_read_b128 a[28:31], v17 offset:14336
    v_mfma_f32_16x16x32_bf16 v[96:99], a[96:99], a[60:63], v[96:99]
    ds_read_b64_tr_b16 a[36:37], v20 offset:0
    v_mfma_f32_16x16x32_bf16 v[120:123], a[96:99], a[64:67], v[120:123]
    s_mov_b32 m0, s30
    v_mfma_f32_16x16x32_bf16 v[144:147], a[96:99], a[68:71], v[144:147]
    ds_read_b64_tr_b16 a[38:39], v20 offset:1536
    v_mfma_f32_16x16x32_bf16 v[168:171], a[96:99], a[72:75], v[168:171]
    v_mfma_f32_16x16x32_bf16 v[192:195], a[96:99], a[76:79], v[192:195]
    buffer_load_dwordx4 v10, s[12:15], s41 offen lds
    ds_read_b64_tr_b16 a[40:41], v19 offset:128
    v_mfma_f32_16x16x32_bf16 v[216:219], a[96:99], a[80:83], v[216:219]
    v_mfma_f32_16x16x32_bf16 v[240:243], a[96:99], a[84:87], v[240:243]
    ds_read_b64_tr_b16 a[42:43], v19 offset:1664
    v_mfma_f32_16x16x32_bf16 v[76:79], a[100:103], a[56:59], v[76:79]
    buffer_load_dwordx4 v11, s[12:15], s41 offen offset:1024 lds
    v_mfma_f32_16x16x32_bf16 v[100:103], a[100:103], a[60:63], v[100:103]
    ds_read_b64_tr_b16 a[44:45], v20 offset:128
    v_mfma_f32_16x16x32_bf16 v[124:127], a[100:103], a[64:67], v[124:127]
    ds_read_b64_tr_b16 a[46:47], v20 offset:1664
    v_mfma_f32_16x16x32_bf16 v[148:151], a[100:103], a[68:71], v[148:151]
    buffer_load_dwordx4 v12, s[12:15], s41 offen offset:2048 lds
    v_mfma_f32_16x16x32_bf16 v[172:175], a[100:103], a[72:75], v[172:175]
    ds_read_b64_tr_b16 a[48:49], v19 offset:256
    v_mfma_f32_16x16x32_bf16 v[196:199], a[100:103], a[76:79], v[196:199]
    v_mfma_f32_16x16x32_bf16 v[220:223], a[100:103], a[80:83], v[220:223]
    buffer_load_dwordx4 v13, s[12:15], s41 offen offset:3072 lds
    ds_read_b64_tr_b16 a[50:51], v19 offset:1792
    v_mfma_f32_16x16x32_bf16 v[244:247], a[100:103], a[84:87], v[244:247]
    v_mfma_f32_16x16x32_bf16 v[80:83], a[56:59], a[104:107], v[80:83]
    ds_read_b64_tr_b16 a[52:53], v20 offset:256
    v_mfma_f32_16x16x32_bf16 v[104:107], a[60:63], a[104:107], v[104:107]
    s_mov_b32 m0, s31
    v_mfma_f32_16x16x32_bf16 v[128:131], a[64:67], a[104:107], v[128:131]
    ds_read_b64_tr_b16 a[54:55], v20 offset:1792
    v_mfma_f32_16x16x32_bf16 v[152:155], a[68:71], a[104:107], v[152:155]
    v_mfma_f32_16x16x32_bf16 v[176:179], a[72:75], a[104:107], v[176:179]
    buffer_load_dwordx4 v14, s[12:15], s41 offen lds
    v_mfma_f32_16x16x32_bf16 v[200:203], a[76:79], a[104:107], v[200:203]
    v_mfma_f32_16x16x32_bf16 v[224:227], a[80:83], a[104:107], v[224:227]
    v_mfma_f32_16x16x32_bf16 v[248:251], a[84:87], a[104:107], v[248:251]
    v_mfma_f32_16x16x32_bf16 v[84:87], a[56:59], a[108:111], v[84:87]
    buffer_load_dwordx4 v15, s[12:15], s41 offen offset:1024 lds
    v_mfma_f32_16x16x32_bf16 v[108:111], a[60:63], a[108:111], v[108:111]
    s_add_u32 s40, s40, 128
    s_add_u32 s41, s41, 393216
    v_mfma_f32_16x16x32_bf16 v[132:135], a[64:67], a[108:111], v[132:135]
    buffer_load_dword a251, v22, s[20:23], s42 offen
    s_add_u32 s42, s42, s43
    v_mfma_f32_16x16x32_bf16 v[156:159], a[68:71], a[108:111], v[156:159]
    v_mfma_f32_16x16x32_bf16 v[180:183], a[72:75], a[108:111], v[180:183]
    v_mfma_f32_16x16x32_bf16 v[204:207], a[76:79], a[108:111], v[204:207]
    v_mfma_f32_16x16x32_bf16 v[228:231], a[80:83], a[108:111], v[228:231]
    v_mfma_f32_16x16x32_bf16 v[252:255], a[84:87], a[108:111], v[252:255]
    s_mov_b32 s37, 6
.p2align 6
gated_mix__linear_kernel_hedgehog__mixer_channel_mlp__prompt_kernel_q_loop:
    s_waitcnt lgkmcnt(0)
    v_mfma_f32_16x16x32_bf16 v[64:67], a[32:35], a[0:3], v[64:67]
    ds_read_b64_tr_b16 a[88:89], v19 offset:12288
    v_mfma_f32_16x16x32_bf16 v[88:91], a[32:35], a[4:7], v[88:91]
    ds_read_b64_tr_b16 a[90:91], v19 offset:13824
    buffer_load_dwordx4 v[24:27], v62, s[56:59], s67 offen
    v_mfma_f32_16x16x32_bf16 v[112:115], a[32:35], a[8:11], v[112:115]
    v_mfma_f32_16x16x32_bf16 v[136:139], a[32:35], a[12:15], v[136:139]
    ds_read_b128 a[56:59], v18 offset:0
    buffer_load_dwordx4 v[28:31], v62, s[56:59], s67 offen offset:1024
    v_mfma_f32_16x16x32_bf16 v[160:163], a[32:35], a[16:19], v[160:163]
    ds_read_b128 a[60:63], v18 offset:2048
    v_mfma_f32_16x16x32_bf16 v[184:187], a[32:35], a[20:23], v[184:187]
    v_mfma_f32_16x16x32_bf16 v[208:211], a[32:35], a[24:27], v[208:211]
    ds_read_b128 a[64:67], v18 offset:4096
    s_add_u32 s67, s67, 2048
    v_mfma_f32_16x16x32_bf16 v[232:235], a[32:35], a[28:31], v[232:235]
    ds_read_b128 a[68:71], v18 offset:6144
    v_mfma_f32_16x16x32_bf16 v[68:71], a[36:39], a[0:3], v[68:71]
    buffer_load_dwordx4 v[32:35], v62, s[56:59], s67 offen
    v_mfma_f32_16x16x32_bf16 v[92:95], a[36:39], a[4:7], v[92:95]
    ds_read_b128 a[72:75], v18 offset:8192
    v_mfma_f32_16x16x32_bf16 v[116:119], a[36:39], a[8:11], v[116:119]
    v_mfma_f32_16x16x32_bf16 v[140:143], a[36:39], a[12:15], v[140:143]
    ds_read_b128 a[76:79], v18 offset:10240
    buffer_load_dwordx4 v[36:39], v62, s[56:59], s67 offen offset:1024
    v_mfma_f32_16x16x32_bf16 v[164:167], a[36:39], a[16:19], v[164:167]
    ds_read_b128 a[80:83], v18 offset:12288
    v_mfma_f32_16x16x32_bf16 v[188:191], a[36:39], a[20:23], v[188:191]
    v_mfma_f32_16x16x32_bf16 v[212:215], a[36:39], a[24:27], v[212:215]
    ds_read_b128 a[84:87], v18 offset:14336
    s_add_u32 s67, s67, 2048
    v_mfma_f32_16x16x32_bf16 v[236:239], a[36:39], a[28:31], v[236:239]
    ds_read_b64_tr_b16 a[92:93], v20 offset:12288
    v_mfma_f32_16x16x32_bf16 v[72:75], a[40:43], a[0:3], v[72:75]
    v_mfma_f32_16x16x32_bf16 v[96:99], a[40:43], a[4:7], v[96:99]
    ds_read_b64_tr_b16 a[94:95], v20 offset:13824
    v_mfma_f32_16x16x32_bf16 v[120:123], a[40:43], a[8:11], v[120:123]
    ds_read_b64_tr_b16 a[96:97], v19 offset:12416
    v_mfma_f32_16x16x32_bf16 v[144:147], a[40:43], a[12:15], v[144:147]
    v_mfma_f32_16x16x32_bf16 v[168:171], a[40:43], a[16:19], v[168:171]
    ds_read_b64_tr_b16 a[98:99], v19 offset:13952
    v_mfma_f32_16x16x32_bf16 v[192:195], a[40:43], a[20:23], v[192:195]
    v_mfma_f32_16x16x32_bf16 v[216:219], a[40:43], a[24:27], v[216:219]
    ds_read_b64_tr_b16 a[100:101], v20 offset:12416
    v_mfma_f32_16x16x32_bf16 v[240:243], a[40:43], a[28:31], v[240:243]
    ds_read_b64_tr_b16 a[102:103], v20 offset:13952
    v_mfma_f32_16x16x32_bf16 v[76:79], a[44:47], a[0:3], v[76:79]
    v_mfma_f32_16x16x32_bf16 v[100:103], a[44:47], a[4:7], v[100:103]
    ds_read_b64_tr_b16 a[104:105], v19 offset:12544
    v_mfma_f32_16x16x32_bf16 v[124:127], a[44:47], a[8:11], v[124:127]
    ds_read_b64_tr_b16 a[106:107], v19 offset:14080
    v_mfma_f32_16x16x32_bf16 v[148:151], a[44:47], a[12:15], v[148:151]
    v_mfma_f32_16x16x32_bf16 v[172:175], a[44:47], a[16:19], v[172:175]
    ds_read_b64_tr_b16 a[108:109], v20 offset:12544
    v_mfma_f32_16x16x32_bf16 v[196:199], a[44:47], a[20:23], v[196:199]
    v_mfma_f32_16x16x32_bf16 v[220:223], a[44:47], a[24:27], v[220:223]
    ds_read_b64_tr_b16 a[110:111], v20 offset:14080
    v_mfma_f32_16x16x32_bf16 v[244:247], a[44:47], a[28:31], v[244:247]
    v_mfma_f32_16x16x32_bf16 v[80:83], a[0:3], a[48:51], v[80:83]
    v_mfma_f32_16x16x32_bf16 v[104:107], a[4:7], a[48:51], v[104:107]
    v_mfma_f32_16x16x32_bf16 v[128:131], a[8:11], a[48:51], v[128:131]
    s_waitcnt vmcnt(5) lgkmcnt(0)
    s_barrier
    v_mfma_f32_16x16x32_bf16 v[152:155], a[12:15], a[48:51], v[152:155]
    s_mov_b32 m0, s24
    v_mfma_f32_16x16x32_bf16 v[176:179], a[16:19], a[48:51], v[176:179]
    v_mfma_f32_16x16x32_bf16 v[200:203], a[20:23], a[48:51], v[200:203]
    v_mfma_f32_16x16x32_bf16 v[224:227], a[24:27], a[48:51], v[224:227]
    buffer_load_dwordx4 v2, s[8:11], s40 offen lds
    v_mfma_f32_16x16x32_bf16 v[248:251], a[28:31], a[48:51], v[248:251]
    v_mfma_f32_16x16x32_bf16 v[84:87], a[0:3], a[52:55], v[84:87]
    v_mfma_f32_16x16x32_bf16 v[108:111], a[4:7], a[52:55], v[108:111]
    buffer_load_dwordx4 v3, s[8:11], s40 offen offset:1024 lds
    v_mfma_f32_16x16x32_bf16 v[132:135], a[8:11], a[52:55], v[132:135]
    v_mfma_f32_16x16x32_bf16 v[156:159], a[12:15], a[52:55], v[156:159]
    v_mfma_f32_16x16x32_bf16 v[180:183], a[16:19], a[52:55], v[180:183]
    buffer_load_dwordx4 v4, s[8:11], s40 offen offset:2048 lds
    v_mfma_f32_16x16x32_bf16 v[204:207], a[20:23], a[52:55], v[204:207]
    v_mfma_f32_16x16x32_bf16 v[228:231], a[24:27], a[52:55], v[228:231]
    v_mfma_f32_16x16x32_bf16 v[252:255], a[28:31], a[52:55], v[252:255]
    buffer_load_dwordx4 v5, s[8:11], s40 offen offset:3072 lds
    v_mfma_f32_16x16x32_bf16 v[64:67], a[88:91], a[56:59], v[64:67]
    ds_read_b64_tr_b16 a[32:33], v19 offset:24576
    v_mfma_f32_16x16x32_bf16 v[88:91], a[88:91], a[60:63], v[88:91]
    ds_read_b64_tr_b16 a[34:35], v19 offset:26112
    v_mfma_f32_16x16x32_bf16 v[112:115], a[88:91], a[64:67], v[112:115]
    s_mov_b32 m0, s25
    v_mfma_f32_16x16x32_bf16 v[136:139], a[88:91], a[68:71], v[136:139]
    ds_read_b128 a[0:3], v17 offset:32768
    v_mfma_f32_16x16x32_bf16 v[160:163], a[88:91], a[72:75], v[160:163]
    v_mfma_f32_16x16x32_bf16 v[184:187], a[88:91], a[76:79], v[184:187]
    buffer_load_dwordx4 v6, s[8:11], s40 offen lds
    ds_read_b128 a[4:7], v17 offset:34816
    v_mfma_f32_16x16x32_bf16 v[208:211], a[88:91], a[80:83], v[208:211]
    v_mfma_f32_16x16x32_bf16 v[232:235], a[88:91], a[84:87], v[232:235]
    ds_read_b128 a[8:11], v17 offset:36864
    v_mfma_f32_16x16x32_bf16 v[68:71], a[92:95], a[56:59], v[68:71]
    buffer_load_dwordx4 v7, s[8:11], s40 offen offset:1024 lds
    ds_read_b128 a[12:15], v17 offset:38912
    v_mfma_f32_16x16x32_bf16 v[92:95], a[92:95], a[60:63], v[92:95]
    v_mfma_f32_16x16x32_bf16 v[116:119], a[92:95], a[64:67], v[116:119]
    ds_read_b128 a[16:19], v17 offset:40960
    v_mfma_f32_16x16x32_bf16 v[140:143], a[92:95], a[68:71], v[140:143]
    buffer_load_dwordx4 v8, s[8:11], s40 offen offset:2048 lds
    v_mfma_f32_16x16x32_bf16 v[164:167], a[92:95], a[72:75], v[164:167]
    ds_read_b128 a[20:23], v17 offset:43008
    v_mfma_f32_16x16x32_bf16 v[188:191], a[92:95], a[76:79], v[188:191]
    v_mfma_f32_16x16x32_bf16 v[212:215], a[92:95], a[80:83], v[212:215]
    ds_read_b128 a[24:27], v17 offset:45056
    v_mfma_f32_16x16x32_bf16 v[236:239], a[92:95], a[84:87], v[236:239]
    buffer_load_dwordx4 v9, s[8:11], s40 offen offset:3072 lds
    v_mfma_f32_16x16x32_bf16 v[72:75], a[96:99], a[56:59], v[72:75]
    ds_read_b128 a[28:31], v17 offset:47104
    v_mfma_f32_16x16x32_bf16 v[96:99], a[96:99], a[60:63], v[96:99]
    ds_read_b64_tr_b16 a[36:37], v20 offset:24576
    v_mfma_f32_16x16x32_bf16 v[120:123], a[96:99], a[64:67], v[120:123]
    s_mov_b32 m0, s26
    v_mfma_f32_16x16x32_bf16 v[144:147], a[96:99], a[68:71], v[144:147]
    ds_read_b64_tr_b16 a[38:39], v20 offset:26112
    v_mfma_f32_16x16x32_bf16 v[168:171], a[96:99], a[72:75], v[168:171]
    v_mfma_f32_16x16x32_bf16 v[192:195], a[96:99], a[76:79], v[192:195]
    buffer_load_dwordx4 v10, s[12:15], s41 offen lds
    ds_read_b64_tr_b16 a[40:41], v19 offset:24704
    v_mfma_f32_16x16x32_bf16 v[216:219], a[96:99], a[80:83], v[216:219]
    v_mfma_f32_16x16x32_bf16 v[240:243], a[96:99], a[84:87], v[240:243]
    ds_read_b64_tr_b16 a[42:43], v19 offset:26240
    v_mfma_f32_16x16x32_bf16 v[76:79], a[100:103], a[56:59], v[76:79]
    buffer_load_dwordx4 v11, s[12:15], s41 offen offset:1024 lds
    v_mfma_f32_16x16x32_bf16 v[100:103], a[100:103], a[60:63], v[100:103]
    ds_read_b64_tr_b16 a[44:45], v20 offset:24704
    v_mfma_f32_16x16x32_bf16 v[124:127], a[100:103], a[64:67], v[124:127]
    ds_read_b64_tr_b16 a[46:47], v20 offset:26240
    v_mfma_f32_16x16x32_bf16 v[148:151], a[100:103], a[68:71], v[148:151]
    buffer_load_dwordx4 v12, s[12:15], s41 offen offset:2048 lds
    v_mfma_f32_16x16x32_bf16 v[172:175], a[100:103], a[72:75], v[172:175]
    ds_read_b64_tr_b16 a[48:49], v19 offset:24832
    v_mfma_f32_16x16x32_bf16 v[196:199], a[100:103], a[76:79], v[196:199]
    v_mfma_f32_16x16x32_bf16 v[220:223], a[100:103], a[80:83], v[220:223]
    buffer_load_dwordx4 v13, s[12:15], s41 offen offset:3072 lds
    ds_read_b64_tr_b16 a[50:51], v19 offset:26368
    v_mfma_f32_16x16x32_bf16 v[244:247], a[100:103], a[84:87], v[244:247]
    v_mfma_f32_16x16x32_bf16 v[80:83], a[56:59], a[104:107], v[80:83]
    ds_read_b64_tr_b16 a[52:53], v20 offset:24832
    v_mfma_f32_16x16x32_bf16 v[104:107], a[60:63], a[104:107], v[104:107]
    s_mov_b32 m0, s27
    v_mfma_f32_16x16x32_bf16 v[128:131], a[64:67], a[104:107], v[128:131]
    ds_read_b64_tr_b16 a[54:55], v20 offset:26368
    v_mfma_f32_16x16x32_bf16 v[152:155], a[68:71], a[104:107], v[152:155]
    v_mfma_f32_16x16x32_bf16 v[176:179], a[72:75], a[104:107], v[176:179]
    buffer_load_dwordx4 v14, s[12:15], s41 offen lds
    v_mfma_f32_16x16x32_bf16 v[200:203], a[76:79], a[104:107], v[200:203]
    v_mfma_f32_16x16x32_bf16 v[224:227], a[80:83], a[104:107], v[224:227]
    v_mfma_f32_16x16x32_bf16 v[248:251], a[84:87], a[104:107], v[248:251]
    v_mfma_f32_16x16x32_bf16 v[84:87], a[56:59], a[108:111], v[84:87]
    buffer_load_dwordx4 v15, s[12:15], s41 offen offset:1024 lds
    v_mfma_f32_16x16x32_bf16 v[108:111], a[60:63], a[108:111], v[108:111]
    s_add_u32 s40, s40, 128
    s_add_u32 s41, s41, 393216
    v_mfma_f32_16x16x32_bf16 v[132:135], a[64:67], a[108:111], v[132:135]
    buffer_load_dword a251, v22, s[20:23], s42 offen
    s_add_u32 s42, s42, s43
    v_mfma_f32_16x16x32_bf16 v[156:159], a[68:71], a[108:111], v[156:159]
    v_mfma_f32_16x16x32_bf16 v[180:183], a[72:75], a[108:111], v[180:183]
    v_mfma_f32_16x16x32_bf16 v[204:207], a[76:79], a[108:111], v[204:207]
    v_mfma_f32_16x16x32_bf16 v[228:231], a[80:83], a[108:111], v[228:231]
    v_mfma_f32_16x16x32_bf16 v[252:255], a[84:87], a[108:111], v[252:255]
    s_waitcnt lgkmcnt(0)
    v_mfma_f32_16x16x32_bf16 v[64:67], a[32:35], a[0:3], v[64:67]
    ds_read_b64_tr_b16 a[88:89], v19 offset:36864
    v_mfma_f32_16x16x32_bf16 v[88:91], a[32:35], a[4:7], v[88:91]
    ds_read_b64_tr_b16 a[90:91], v19 offset:38400
    v_mfma_f32_16x16x32_bf16 v[112:115], a[32:35], a[8:11], v[112:115]
    v_mfma_f32_16x16x32_bf16 v[136:139], a[32:35], a[12:15], v[136:139]
    ds_read_b128 a[56:59], v18 offset:32768
    v_mfma_f32_16x16x32_bf16 v[160:163], a[32:35], a[16:19], v[160:163]
    ds_read_b128 a[60:63], v18 offset:34816
    v_mfma_f32_16x16x32_bf16 v[184:187], a[32:35], a[20:23], v[184:187]
    v_mfma_f32_16x16x32_bf16 v[208:211], a[32:35], a[24:27], v[208:211]
    ds_read_b128 a[64:67], v18 offset:36864
    v_mfma_f32_16x16x32_bf16 v[232:235], a[32:35], a[28:31], v[232:235]
    ds_read_b128 a[68:71], v18 offset:38912
    v_mfma_f32_16x16x32_bf16 v[68:71], a[36:39], a[0:3], v[68:71]
    v_mfma_f32_16x16x32_bf16 v[92:95], a[36:39], a[4:7], v[92:95]
    ds_read_b128 a[72:75], v18 offset:40960
    v_mfma_f32_16x16x32_bf16 v[116:119], a[36:39], a[8:11], v[116:119]
    v_mfma_f32_16x16x32_bf16 v[140:143], a[36:39], a[12:15], v[140:143]
    ds_read_b128 a[76:79], v18 offset:43008
    v_mfma_f32_16x16x32_bf16 v[164:167], a[36:39], a[16:19], v[164:167]
    ds_read_b128 a[80:83], v18 offset:45056
    v_mfma_f32_16x16x32_bf16 v[188:191], a[36:39], a[20:23], v[188:191]
    v_mfma_f32_16x16x32_bf16 v[212:215], a[36:39], a[24:27], v[212:215]
    ds_read_b128 a[84:87], v18 offset:47104
    v_mfma_f32_16x16x32_bf16 v[236:239], a[36:39], a[28:31], v[236:239]
    ds_read_b64_tr_b16 a[92:93], v20 offset:36864
    v_mfma_f32_16x16x32_bf16 v[72:75], a[40:43], a[0:3], v[72:75]
    v_mfma_f32_16x16x32_bf16 v[96:99], a[40:43], a[4:7], v[96:99]
    ds_read_b64_tr_b16 a[94:95], v20 offset:38400
    v_mfma_f32_16x16x32_bf16 v[120:123], a[40:43], a[8:11], v[120:123]
    ds_read_b64_tr_b16 a[96:97], v19 offset:36992
    v_mfma_f32_16x16x32_bf16 v[144:147], a[40:43], a[12:15], v[144:147]
    v_mfma_f32_16x16x32_bf16 v[168:171], a[40:43], a[16:19], v[168:171]
    ds_read_b64_tr_b16 a[98:99], v19 offset:38528
    v_mfma_f32_16x16x32_bf16 v[192:195], a[40:43], a[20:23], v[192:195]
    v_mfma_f32_16x16x32_bf16 v[216:219], a[40:43], a[24:27], v[216:219]
    ds_read_b64_tr_b16 a[100:101], v20 offset:36992
    v_mfma_f32_16x16x32_bf16 v[240:243], a[40:43], a[28:31], v[240:243]
    ds_read_b64_tr_b16 a[102:103], v20 offset:38528
    v_mfma_f32_16x16x32_bf16 v[76:79], a[44:47], a[0:3], v[76:79]
    v_mfma_f32_16x16x32_bf16 v[100:103], a[44:47], a[4:7], v[100:103]
    ds_read_b64_tr_b16 a[104:105], v19 offset:37120
    v_mfma_f32_16x16x32_bf16 v[124:127], a[44:47], a[8:11], v[124:127]
    ds_read_b64_tr_b16 a[106:107], v19 offset:38656
    v_mfma_f32_16x16x32_bf16 v[148:151], a[44:47], a[12:15], v[148:151]
    v_mfma_f32_16x16x32_bf16 v[172:175], a[44:47], a[16:19], v[172:175]
    ds_read_b64_tr_b16 a[108:109], v20 offset:37120
    v_mfma_f32_16x16x32_bf16 v[196:199], a[44:47], a[20:23], v[196:199]
    v_mfma_f32_16x16x32_bf16 v[220:223], a[44:47], a[24:27], v[220:223]
    ds_read_b64_tr_b16 a[110:111], v20 offset:38656
    v_mfma_f32_16x16x32_bf16 v[244:247], a[44:47], a[28:31], v[244:247]
    v_mfma_f32_16x16x32_bf16 v[80:83], a[0:3], a[48:51], v[80:83]
    v_mfma_f32_16x16x32_bf16 v[104:107], a[4:7], a[48:51], v[104:107]
    v_mfma_f32_16x16x32_bf16 v[128:131], a[8:11], a[48:51], v[128:131]
    s_waitcnt vmcnt(1) lgkmcnt(0)
    s_barrier
    v_mfma_f32_16x16x32_bf16 v[152:155], a[12:15], a[48:51], v[152:155]
    s_mov_b32 m0, s28
    v_mfma_f32_16x16x32_bf16 v[176:179], a[16:19], a[48:51], v[176:179]
    v_mfma_f32_16x16x32_bf16 v[200:203], a[20:23], a[48:51], v[200:203]
    v_mfma_f32_16x16x32_bf16 v[224:227], a[24:27], a[48:51], v[224:227]
    buffer_load_dwordx4 v2, s[8:11], s40 offen lds
    v_mfma_f32_16x16x32_bf16 v[248:251], a[28:31], a[48:51], v[248:251]
    v_mfma_f32_16x16x32_bf16 v[84:87], a[0:3], a[52:55], v[84:87]
    v_mfma_f32_16x16x32_bf16 v[108:111], a[4:7], a[52:55], v[108:111]
    buffer_load_dwordx4 v3, s[8:11], s40 offen offset:1024 lds
    v_mfma_f32_16x16x32_bf16 v[132:135], a[8:11], a[52:55], v[132:135]
    v_mfma_f32_16x16x32_bf16 v[156:159], a[12:15], a[52:55], v[156:159]
    v_mfma_f32_16x16x32_bf16 v[180:183], a[16:19], a[52:55], v[180:183]
    buffer_load_dwordx4 v4, s[8:11], s40 offen offset:2048 lds
    v_mfma_f32_16x16x32_bf16 v[204:207], a[20:23], a[52:55], v[204:207]
    v_mfma_f32_16x16x32_bf16 v[228:231], a[24:27], a[52:55], v[228:231]
    v_mfma_f32_16x16x32_bf16 v[252:255], a[28:31], a[52:55], v[252:255]
    buffer_load_dwordx4 v5, s[8:11], s40 offen offset:3072 lds
    v_mfma_f32_16x16x32_bf16 v[64:67], a[88:91], a[56:59], v[64:67]
    ds_read_b64_tr_b16 a[32:33], v19 offset:0
    v_mfma_f32_16x16x32_bf16 v[88:91], a[88:91], a[60:63], v[88:91]
    ds_read_b64_tr_b16 a[34:35], v19 offset:1536
    v_mfma_f32_16x16x32_bf16 v[112:115], a[88:91], a[64:67], v[112:115]
    s_mov_b32 m0, s29
    v_mfma_f32_16x16x32_bf16 v[136:139], a[88:91], a[68:71], v[136:139]
    ds_read_b128 a[0:3], v17 offset:0
    v_mfma_f32_16x16x32_bf16 v[160:163], a[88:91], a[72:75], v[160:163]
    v_mfma_f32_16x16x32_bf16 v[184:187], a[88:91], a[76:79], v[184:187]
    buffer_load_dwordx4 v6, s[8:11], s40 offen lds
    ds_read_b128 a[4:7], v17 offset:2048
    v_mfma_f32_16x16x32_bf16 v[208:211], a[88:91], a[80:83], v[208:211]
    v_mfma_f32_16x16x32_bf16 v[232:235], a[88:91], a[84:87], v[232:235]
    ds_read_b128 a[8:11], v17 offset:4096
    v_mfma_f32_16x16x32_bf16 v[68:71], a[92:95], a[56:59], v[68:71]
    buffer_load_dwordx4 v7, s[8:11], s40 offen offset:1024 lds
    ds_read_b128 a[12:15], v17 offset:6144
    v_mfma_f32_16x16x32_bf16 v[92:95], a[92:95], a[60:63], v[92:95]
    v_mfma_f32_16x16x32_bf16 v[116:119], a[92:95], a[64:67], v[116:119]
    ds_read_b128 a[16:19], v17 offset:8192
    v_mfma_f32_16x16x32_bf16 v[140:143], a[92:95], a[68:71], v[140:143]
    buffer_load_dwordx4 v8, s[8:11], s40 offen offset:2048 lds
    v_mfma_f32_16x16x32_bf16 v[164:167], a[92:95], a[72:75], v[164:167]
    ds_read_b128 a[20:23], v17 offset:10240
    v_mfma_f32_16x16x32_bf16 v[188:191], a[92:95], a[76:79], v[188:191]
    v_mfma_f32_16x16x32_bf16 v[212:215], a[92:95], a[80:83], v[212:215]
    ds_read_b128 a[24:27], v17 offset:12288
    v_mfma_f32_16x16x32_bf16 v[236:239], a[92:95], a[84:87], v[236:239]
    buffer_load_dwordx4 v9, s[8:11], s40 offen offset:3072 lds
    v_mfma_f32_16x16x32_bf16 v[72:75], a[96:99], a[56:59], v[72:75]
    ds_read_b128 a[28:31], v17 offset:14336
    v_mfma_f32_16x16x32_bf16 v[96:99], a[96:99], a[60:63], v[96:99]
    ds_read_b64_tr_b16 a[36:37], v20 offset:0
    v_mfma_f32_16x16x32_bf16 v[120:123], a[96:99], a[64:67], v[120:123]
    s_mov_b32 m0, s30
    v_mfma_f32_16x16x32_bf16 v[144:147], a[96:99], a[68:71], v[144:147]
    ds_read_b64_tr_b16 a[38:39], v20 offset:1536
    v_mfma_f32_16x16x32_bf16 v[168:171], a[96:99], a[72:75], v[168:171]
    v_mfma_f32_16x16x32_bf16 v[192:195], a[96:99], a[76:79], v[192:195]
    buffer_load_dwordx4 v10, s[12:15], s41 offen lds
    ds_read_b64_tr_b16 a[40:41], v19 offset:128
    v_mfma_f32_16x16x32_bf16 v[216:219], a[96:99], a[80:83], v[216:219]
    v_mfma_f32_16x16x32_bf16 v[240:243], a[96:99], a[84:87], v[240:243]
    ds_read_b64_tr_b16 a[42:43], v19 offset:1664
    v_mfma_f32_16x16x32_bf16 v[76:79], a[100:103], a[56:59], v[76:79]
    buffer_load_dwordx4 v11, s[12:15], s41 offen offset:1024 lds
    v_mfma_f32_16x16x32_bf16 v[100:103], a[100:103], a[60:63], v[100:103]
    ds_read_b64_tr_b16 a[44:45], v20 offset:128
    v_mfma_f32_16x16x32_bf16 v[124:127], a[100:103], a[64:67], v[124:127]
    ds_read_b64_tr_b16 a[46:47], v20 offset:1664
    v_mfma_f32_16x16x32_bf16 v[148:151], a[100:103], a[68:71], v[148:151]
    buffer_load_dwordx4 v12, s[12:15], s41 offen offset:2048 lds
    v_mfma_f32_16x16x32_bf16 v[172:175], a[100:103], a[72:75], v[172:175]
    ds_read_b64_tr_b16 a[48:49], v19 offset:256
    v_mfma_f32_16x16x32_bf16 v[196:199], a[100:103], a[76:79], v[196:199]
    v_mfma_f32_16x16x32_bf16 v[220:223], a[100:103], a[80:83], v[220:223]
    buffer_load_dwordx4 v13, s[12:15], s41 offen offset:3072 lds
    ds_read_b64_tr_b16 a[50:51], v19 offset:1792
    v_mfma_f32_16x16x32_bf16 v[244:247], a[100:103], a[84:87], v[244:247]
    v_mfma_f32_16x16x32_bf16 v[80:83], a[56:59], a[104:107], v[80:83]
    ds_read_b64_tr_b16 a[52:53], v20 offset:256
    v_mfma_f32_16x16x32_bf16 v[104:107], a[60:63], a[104:107], v[104:107]
    s_mov_b32 m0, s31
    v_mfma_f32_16x16x32_bf16 v[128:131], a[64:67], a[104:107], v[128:131]
    ds_read_b64_tr_b16 a[54:55], v20 offset:1792
    v_mfma_f32_16x16x32_bf16 v[152:155], a[68:71], a[104:107], v[152:155]
    v_mfma_f32_16x16x32_bf16 v[176:179], a[72:75], a[104:107], v[176:179]
    buffer_load_dwordx4 v14, s[12:15], s41 offen lds
    v_mfma_f32_16x16x32_bf16 v[200:203], a[76:79], a[104:107], v[200:203]
    v_mfma_f32_16x16x32_bf16 v[224:227], a[80:83], a[104:107], v[224:227]
    v_mfma_f32_16x16x32_bf16 v[248:251], a[84:87], a[104:107], v[248:251]
    v_mfma_f32_16x16x32_bf16 v[84:87], a[56:59], a[108:111], v[84:87]
    buffer_load_dwordx4 v15, s[12:15], s41 offen offset:1024 lds
    v_mfma_f32_16x16x32_bf16 v[108:111], a[60:63], a[108:111], v[108:111]
    s_add_u32 s40, s40, 128
    s_add_u32 s41, s41, 393216
    v_mfma_f32_16x16x32_bf16 v[132:135], a[64:67], a[108:111], v[132:135]
    buffer_load_dword a251, v22, s[20:23], s42 offen
    s_add_u32 s42, s42, s43
    v_mfma_f32_16x16x32_bf16 v[156:159], a[68:71], a[108:111], v[156:159]
    v_mfma_f32_16x16x32_bf16 v[180:183], a[72:75], a[108:111], v[180:183]
    v_mfma_f32_16x16x32_bf16 v[204:207], a[76:79], a[108:111], v[204:207]
    v_mfma_f32_16x16x32_bf16 v[228:231], a[80:83], a[108:111], v[228:231]
    v_mfma_f32_16x16x32_bf16 v[252:255], a[84:87], a[108:111], v[252:255]
    s_sub_u32 s37, s37, 1
    s_cmp_lg_u32 s37, 5
    s_cbranch_scc1 hook_20
    v_mov_b32 v48, 0
    v_mov_b32 v49, 0
    v_mov_b32 v52, 0
    v_mov_b32 v53, 0
    v_mov_b32 v56, 0
    v_mov_b32 v57, 0
    v_mov_b32 v60, 0x3f803f80
    v_dot2c_f32_bf16 v48, v24, v60
    v_dot2c_f32_bf16 v52, v24, v24
    v_dot2c_f32_bf16 v56, v24, v40
    v_dot2c_f32_bf16 v49, v32, v60
    v_dot2c_f32_bf16 v53, v32, v32
    v_dot2c_f32_bf16 v57, v32, v40
    v_dot2c_f32_bf16 v48, v25, v60
    v_dot2c_f32_bf16 v52, v25, v25
    v_dot2c_f32_bf16 v56, v25, v41
    v_dot2c_f32_bf16 v49, v33, v60
    v_dot2c_f32_bf16 v53, v33, v33
    v_dot2c_f32_bf16 v57, v33, v41
    v_dot2c_f32_bf16 v48, v26, v60
    v_dot2c_f32_bf16 v52, v26, v26
    v_dot2c_f32_bf16 v56, v26, v42
    v_dot2c_f32_bf16 v49, v34, v60
    v_dot2c_f32_bf16 v53, v34, v34
    v_dot2c_f32_bf16 v57, v34, v42
    v_dot2c_f32_bf16 v48, v27, v60
    v_dot2c_f32_bf16 v52, v27, v27
    v_dot2c_f32_bf16 v56, v27, v43
    v_dot2c_f32_bf16 v49, v35, v60
    v_dot2c_f32_bf16 v53, v35, v35
    v_dot2c_f32_bf16 v57, v35, v43
    v_dot2c_f32_bf16 v48, v28, v60
    v_dot2c_f32_bf16 v52, v28, v28
    v_dot2c_f32_bf16 v56, v28, v44
    v_dot2c_f32_bf16 v49, v36, v60
    v_dot2c_f32_bf16 v53, v36, v36
    v_dot2c_f32_bf16 v57, v36, v44
    v_dot2c_f32_bf16 v48, v29, v60
    v_dot2c_f32_bf16 v52, v29, v29
    v_dot2c_f32_bf16 v56, v29, v45
    v_dot2c_f32_bf16 v49, v37, v60
    v_dot2c_f32_bf16 v53, v37, v37
    v_dot2c_f32_bf16 v57, v37, v45
    v_dot2c_f32_bf16 v48, v30, v60
    v_dot2c_f32_bf16 v52, v30, v30
    v_dot2c_f32_bf16 v56, v30, v46
    v_dot2c_f32_bf16 v49, v38, v60
    v_dot2c_f32_bf16 v53, v38, v38
    v_dot2c_f32_bf16 v57, v38, v46
    v_dot2c_f32_bf16 v48, v31, v60
    v_dot2c_f32_bf16 v52, v31, v31
    v_dot2c_f32_bf16 v56, v31, v47
    v_dot2c_f32_bf16 v49, v39, v60
    v_dot2c_f32_bf16 v53, v39, v39
    v_dot2c_f32_bf16 v57, v39, v47
    s_branch hkend_19
hook_20:
    s_cmp_lg_u32 s37, 4
    s_cbranch_scc1 hook_21
    v_mov_b32 v50, 0
    v_mov_b32 v51, 0
    v_mov_b32 v54, 0
    v_mov_b32 v55, 0
    v_mov_b32 v58, 0
    v_mov_b32 v59, 0
    v_mov_b32 v60, 0x3f803f80
    v_dot2c_f32_bf16 v50, v24, v60
    v_dot2c_f32_bf16 v54, v24, v24
    v_dot2c_f32_bf16 v58, v24, v40
    v_dot2c_f32_bf16 v51, v32, v60
    v_dot2c_f32_bf16 v55, v32, v32
    v_dot2c_f32_bf16 v59, v32, v40
    v_dot2c_f32_bf16 v50, v25, v60
    v_dot2c_f32_bf16 v54, v25, v25
    v_dot2c_f32_bf16 v58, v25, v41
    v_dot2c_f32_bf16 v51, v33, v60
    v_dot2c_f32_bf16 v55, v33, v33
    v_dot2c_f32_bf16 v59, v33, v41
    v_dot2c_f32_bf16 v50, v26, v60
    v_dot2c_f32_bf16 v54, v26, v26
    v_dot2c_f32_bf16 v58, v26, v42
    v_dot2c_f32_bf16 v51, v34, v60
    v_dot2c_f32_bf16 v55, v34, v34
    v_dot2c_f32_bf16 v59, v34, v42
    v_dot2c_f32_bf16 v50, v27, v60
    v_dot2c_f32_bf16 v54, v27, v27
    v_dot2c_f32_bf16 v58, v27, v43
    v_dot2c_f32_bf16 v51, v35, v60
    v_dot2c_f32_bf16 v55, v35, v35
    v_dot2c_f32_bf16 v59, v35, v43
    v_dot2c_f32_bf16 v50, v28, v60
    v_dot2c_f32_bf16 v54, v28, v28
    v_dot2c_f32_bf16 v58, v28, v44
    v_dot2c_f32_bf16 v51, v36, v60
    v_dot2c_f32_bf16 v55, v36, v36
    v_dot2c_f32_bf16 v59, v36, v44
    v_dot2c_f32_bf16 v50, v29, v60
    v_dot2c_f32_bf16 v54, v29, v29
    v_dot2c_f32_bf16 v58, v29, v45
    v_dot2c_f32_bf16 v51, v37, v60
    v_dot2c_f32_bf16 v55, v37, v37
    v_dot2c_f32_bf16 v59, v37, v45
    v_dot2c_f32_bf16 v50, v30, v60
    v_dot2c_f32_bf16 v54, v30, v30
    v_dot2c_f32_bf16 v58, v30, v46
    v_dot2c_f32_bf16 v51, v38, v60
    v_dot2c_f32_bf16 v55, v38, v38
    v_dot2c_f32_bf16 v59, v38, v46
    v_dot2c_f32_bf16 v50, v31, v60
    v_dot2c_f32_bf16 v54, v31, v31
    v_dot2c_f32_bf16 v58, v31, v47
    v_dot2c_f32_bf16 v51, v39, v60
    v_dot2c_f32_bf16 v55, v39, v39
    v_dot2c_f32_bf16 v59, v39, v47
    v_add_f32_dpp v48, v48, v48 row_ror:8 row_mask:0xf bank_mask:0xf
    v_add_f32_dpp v49, v49, v49 row_ror:8 row_mask:0xf bank_mask:0xf
    v_add_f32_dpp v50, v50, v50 row_ror:8 row_mask:0xf bank_mask:0xf
    v_add_f32_dpp v51, v51, v51 row_ror:8 row_mask:0xf bank_mask:0xf
    v_add_f32_dpp v52, v52, v52 row_ror:8 row_mask:0xf bank_mask:0xf
    v_add_f32_dpp v53, v53, v53 row_ror:8 row_mask:0xf bank_mask:0xf
    v_add_f32_dpp v54, v54, v54 row_ror:8 row_mask:0xf bank_mask:0xf
    v_add_f32_dpp v55, v55, v55 row_ror:8 row_mask:0xf bank_mask:0xf
    v_add_f32_dpp v56, v56, v56 row_ror:8 row_mask:0xf bank_mask:0xf
    v_add_f32_dpp v57, v57, v57 row_ror:8 row_mask:0xf bank_mask:0xf
    v_add_f32_dpp v58, v58, v58 row_ror:8 row_mask:0xf bank_mask:0xf
    v_add_f32_dpp v59, v59, v59 row_ror:8 row_mask:0xf bank_mask:0xf
    v_add_f32_dpp v48, v48, v48 row_ror:4 row_mask:0xf bank_mask:0xf
    v_add_f32_dpp v49, v49, v49 row_ror:4 row_mask:0xf bank_mask:0xf
    v_add_f32_dpp v50, v50, v50 row_ror:4 row_mask:0xf bank_mask:0xf
    v_add_f32_dpp v51, v51, v51 row_ror:4 row_mask:0xf bank_mask:0xf
    v_add_f32_dpp v52, v52, v52 row_ror:4 row_mask:0xf bank_mask:0xf
    v_add_f32_dpp v53, v53, v53 row_ror:4 row_mask:0xf bank_mask:0xf
    v_add_f32_dpp v54, v54, v54 row_ror:4 row_mask:0xf bank_mask:0xf
    v_add_f32_dpp v55, v55, v55 row_ror:4 row_mask:0xf bank_mask:0xf
    v_add_f32_dpp v56, v56, v56 row_ror:4 row_mask:0xf bank_mask:0xf
    v_add_f32_dpp v57, v57, v57 row_ror:4 row_mask:0xf bank_mask:0xf
    v_add_f32_dpp v58, v58, v58 row_ror:4 row_mask:0xf bank_mask:0xf
    v_add_f32_dpp v59, v59, v59 row_ror:4 row_mask:0xf bank_mask:0xf
    v_add_f32_dpp v48, v48, v48 row_ror:2 row_mask:0xf bank_mask:0xf
    v_add_f32_dpp v49, v49, v49 row_ror:2 row_mask:0xf bank_mask:0xf
    v_add_f32_dpp v50, v50, v50 row_ror:2 row_mask:0xf bank_mask:0xf
    v_add_f32_dpp v51, v51, v51 row_ror:2 row_mask:0xf bank_mask:0xf
    v_add_f32_dpp v52, v52, v52 row_ror:2 row_mask:0xf bank_mask:0xf
    v_add_f32_dpp v53, v53, v53 row_ror:2 row_mask:0xf bank_mask:0xf
    v_add_f32_dpp v54, v54, v54 row_ror:2 row_mask:0xf bank_mask:0xf
    v_add_f32_dpp v55, v55, v55 row_ror:2 row_mask:0xf bank_mask:0xf
    v_add_f32_dpp v56, v56, v56 row_ror:2 row_mask:0xf bank_mask:0xf
    v_add_f32_dpp v57, v57, v57 row_ror:2 row_mask:0xf bank_mask:0xf
    v_add_f32_dpp v58, v58, v58 row_ror:2 row_mask:0xf bank_mask:0xf
    v_add_f32_dpp v59, v59, v59 row_ror:2 row_mask:0xf bank_mask:0xf
    v_add_f32_dpp v48, v48, v48 row_ror:1 row_mask:0xf bank_mask:0xf
    v_add_f32_dpp v49, v49, v49 row_ror:1 row_mask:0xf bank_mask:0xf
    v_add_f32_dpp v50, v50, v50 row_ror:1 row_mask:0xf bank_mask:0xf
    v_add_f32_dpp v51, v51, v51 row_ror:1 row_mask:0xf bank_mask:0xf
    v_add_f32_dpp v52, v52, v52 row_ror:1 row_mask:0xf bank_mask:0xf
    v_add_f32_dpp v53, v53, v53 row_ror:1 row_mask:0xf bank_mask:0xf
    v_add_f32_dpp v54, v54, v54 row_ror:1 row_mask:0xf bank_mask:0xf
    v_add_f32_dpp v55, v55, v55 row_ror:1 row_mask:0xf bank_mask:0xf
    v_add_f32_dpp v56, v56, v56 row_ror:1 row_mask:0xf bank_mask:0xf
    v_add_f32_dpp v57, v57, v57 row_ror:1 row_mask:0xf bank_mask:0xf
    v_add_f32_dpp v58, v58, v58 row_ror:1 row_mask:0xf bank_mask:0xf
    v_add_f32_dpp v59, v59, v59 row_ror:1 row_mask:0xf bank_mask:0xf
    v_mov_b32 v24, v48
    v_mov_b32 v25, v49
    v_mov_b32 v26, v50
    v_mov_b32 v27, v51
    v_mov_b32 v28, v52
    v_mov_b32 v29, v53
    v_mov_b32 v30, v54
    v_mov_b32 v31, v55
    v_mov_b32 v32, v56
    v_mov_b32 v33, v57
    v_mov_b32 v34, v58
    v_mov_b32 v35, v59
    v_permlane16_swap_b32 v48, v24
    v_permlane16_swap_b32 v49, v25
    v_permlane16_swap_b32 v50, v26
    v_permlane16_swap_b32 v51, v27
    v_permlane16_swap_b32 v52, v28
    v_permlane16_swap_b32 v53, v29
    v_permlane16_swap_b32 v54, v30
    v_permlane16_swap_b32 v55, v31
    v_permlane16_swap_b32 v56, v32
    v_permlane16_swap_b32 v57, v33
    v_permlane16_swap_b32 v58, v34
    v_permlane16_swap_b32 v59, v35
    v_add_f32 v48, v48, v24
    v_add_f32 v49, v49, v25
    v_add_f32 v50, v50, v26
    v_add_f32 v51, v51, v27
    v_add_f32 v52, v52, v28
    v_add_f32 v53, v53, v29
    v_add_f32 v54, v54, v30
    v_add_f32 v55, v55, v31
    v_add_f32 v56, v56, v32
    v_add_f32 v57, v57, v33
    v_add_f32 v58, v58, v34
    v_add_f32 v59, v59, v35
    v_mov_b32 v24, v48
    v_mov_b32 v25, v49
    v_mov_b32 v26, v50
    v_mov_b32 v27, v51
    v_mov_b32 v28, v52
    v_mov_b32 v29, v53
    v_mov_b32 v30, v54
    v_mov_b32 v31, v55
    v_mov_b32 v32, v56
    v_mov_b32 v33, v57
    v_mov_b32 v34, v58
    v_mov_b32 v35, v59
    v_permlane32_swap_b32 v48, v24
    v_permlane32_swap_b32 v49, v25
    v_permlane32_swap_b32 v50, v26
    v_permlane32_swap_b32 v51, v27
    v_permlane32_swap_b32 v52, v28
    v_permlane32_swap_b32 v53, v29
    v_permlane32_swap_b32 v54, v30
    v_permlane32_swap_b32 v55, v31
    v_permlane32_swap_b32 v56, v32
    v_permlane32_swap_b32 v57, v33
    v_permlane32_swap_b32 v58, v34
    v_permlane32_swap_b32 v59, v35
    v_add_f32 v48, v48, v24
    v_add_f32 v49, v49, v25
    v_add_f32 v50, v50, v26
    v_add_f32 v51, v51, v27
    v_add_f32 v52, v52, v28
    v_add_f32 v53, v53, v29
    v_add_f32 v54, v54, v30
    v_add_f32 v55, v55, v31
    v_add_f32 v56, v56, v32
    v_add_f32 v57, v57, v33
    v_add_f32 v58, v58, v34
    v_add_f32 v59, v59, v35
    v_cmp_eq_u32 vcc, 1, v1
    s_nop 1
    v_cndmask_b32 v48, v48, v49, vcc
    v_cndmask_b32 v52, v52, v53, vcc
    v_cndmask_b32 v56, v56, v57, vcc
    v_cmp_eq_u32 vcc, 2, v1
    s_nop 1
    v_cndmask_b32 v48, v48, v50, vcc
    v_cndmask_b32 v52, v52, v54, vcc
    v_cndmask_b32 v56, v56, v58, vcc
    v_cmp_eq_u32 vcc, 3, v1
    s_nop 1
    v_cndmask_b32 v48, v48, v51, vcc
    v_cndmask_b32 v52, v52, v55, vcc
    v_cndmask_b32 v56, v56, v59, vcc
    s_mov_b32 s44, 0x3a800000
    s_mov_b32 s45, 0x3727c5ac
    v_mul_f32 v48, s44, v48
    v_mul_f32 v52, s44, v52
    v_mul_f32 v56, 0xbfb8aa3b, v56
    v_exp_f32 v56, v56
    v_fma_f32 v52, -v48, v48, v52
    v_max_f32 v52, 0, v52
    v_add_f32 v52, s45, v52
    v_rsq_f32 v54, v52
    v_add_f32 v56, 1.0, v56
    v_rcp_f32 v56, v56
    v_mul_f32 v55, -v48, v54
    s_lshl_b32 s44, s35, 4
    s_add_u32 s44, s44, s36
    s_lshl_b32 s44, s44, 2
    s_add_u32 s44, s44, s32
    s_lshl_b32 s45, s44, 5
    s_add_u32 s45, s45, 23068672
    s_add_u32 s16, s52, s45
    s_addc_u32 s17, s53, 0
    s_mov_b32 s18, 32
    s_mov_b32 s19, 0x20000
    v_lshlrev_b32 v49, 3, v1
    v_lshlrev_b32 v50, 2, v1
    buffer_store_dwordx2 v[54:55], v49, s[16:19], 0 offen sc1
    s_lshl_b32 s45, s44, 4
    s_add_u32 s45, s45, 23265280
    s_add_u32 s16, s52, s45
    s_addc_u32 s17, s53, 0
    s_mov_b32 s18, 16
    s_mov_b32 s19, 0x20000
    buffer_store_dword v56, v50, s[16:19], 0 offen sc1
    v_mov_b32 v61, 0
    s_cmp_lg_u32 s32, 0
    s_cbranch_scc1 inl_22
    global_load_dword v63, v61, s[68:69] sc1
    s_branch inl_22_e
inl_22:
    buffer_load_dword a250, v1, s[72:75], 0 offen
inl_22_e:
    s_branch hkend_19
hook_21:
    s_cmp_lg_u32 s37, 3
    s_cbranch_scc1 hook_23
    s_cmp_lg_u32 s32, 0
    s_cbranch_scc1 inc_24_ok
    s_mov_b32 s45, 32768
inc_24:
    v_readfirstlane_b32 s44, v63
    s_nop 1
    s_cmp_ge_u32 s44, 256
    s_cbranch_scc1 inc_24_ok
    s_sub_u32 s45, s45, 1
    s_cbranch_scc1 inc_24_ok
    s_sleep 8
    global_load_dword v63, v61, s[68:69] sc1
    s_waitcnt vmcnt(0)
    s_branch inc_24
inc_24_ok:
    s_add_u32 s78, s36, 32
    s_cmp_lg_u32 s32, 0
    s_cbranch_scc1 post_25
    s_add_u32 s16, s52, 23592960
    s_addc_u32 s17, s53, 0
    s_mov_b32 s18, 65536
    s_mov_b32 s19, 0x20000
    v_mov_b32 v56, 1
    v_mov_b32 v57, s35
    v_and_b32 v58, 3, v57
    v_lshl_add_u32 v56, v58, 1, v56
    v_lshrrev_b32 v57, 2, v57
    v_mov_b32 v58, v1
    v_and_b32 v59, 3, v58
    v_lshl_add_u32 v56, v59, 3, v56
    v_lshrrev_b32 v58, 2, v58
    v_lshl_add_u32 v57, v58, 1, v57
    v_lshl_add_u32 v56, v56, 3, v57
    v_lshlrev_b32 v56, 6, v56
    v_add_u32 v56, s78, v56
    v_lshlrev_b32 v56, 2, v56
    v_mov_b32 v57, 0x7ffffff0
    v_cmp_gt_u32 vcc, 16, v1
    s_nop 1
    v_cndmask_b32 v56, v57, v56, vcc
    v_mov_b32 v57, 1
    buffer_store_dword v57, v56, s[16:19], 0 offen sc1
    s_branch post_25_e
post_25:
    buffer_load_dword a250, v1, s[72:75], 0 offen
post_25_e:
    s_branch hkend_19
hook_23:
hkend_19:
    s_cmp_lg_u32 s37, 0
    s_cbranch_scc1 gated_mix__linear_kernel_hedgehog__mixer_channel_mlp__prompt_kernel_q_loop
    s_getpc_b64 s[50:51]
pc_18:
    s_sub_u32 s50, s50, pc_18-gated_mix__linear_kernel_hedgehog__mixer_channel_mlp__prompt_kernel
    s_subb_u32 s51, s51, 0
    s_lshr_b32 s48, s2, 3
    s_lshl_b32 s48, s48, 2
    v_lshrrev_b32 v48, 6, v0
    v_add_u32 v48, s48, v48
    v_mul_u32_u24 v48, 4, v48
    v_and_b32 v49, 63, v0
    v_min_u32 v49, 3, v49
    v_add_u32 v48, v48, v49
    v_lshlrev_b32 v48, 7, v48
    v_min_u32 v48, gated_mix__linear_kernel_hedgehog__mixer_channel_mlp__prompt_kernel_end-gated_mix__linear_kernel_hedgehog__mixer_channel_mlp__prompt_kernel, v48
    global_load_dword a253, v48, s[50:51]
    s_lshr_b32 s44, s2, 4
    s_lshl_b32 s44, s44, 3
    s_and_b32 s45, s2, 7
    s_add_u32 s44, s44, s45
    s_lshl_b32 s44, s44, 2
    s_add_u32 s44, s44, s32
    s_mul_i32 s45, s44, 14336
    s_add_u32 s56, s96, s45
    s_addc_u32 s57, s97, 0
    s_mov_b32 s58, 14336
    s_mov_b32 s59, 0x20000
    v_lshlrev_b32 v48, 7, v1
    buffer_load_dword a254, v48, s[56:59], 0 offen
    s_movk_i32 s45, 0x2000
    buffer_load_dword a254, v48, s[56:59], s45 offen
    s_lshl_b32 s45, s44, 12
    s_add_u32 s56, s98, s45
    s_addc_u32 s57, s99, 0
    s_mov_b32 s58, 4096
    s_mov_b32 s59, 0x20000
    buffer_load_dword a255, v48, s[56:59], 0 offen
    s_waitcnt lgkmcnt(0)
    v_mfma_f32_16x16x32_bf16 v[64:67], a[32:35], a[0:3], v[64:67]
    ds_read_b64_tr_b16 a[88:89], v19 offset:12288
    v_mfma_f32_16x16x32_bf16 v[88:91], a[32:35], a[4:7], v[88:91]
    ds_read_b64_tr_b16 a[90:91], v19 offset:13824
    v_mfma_f32_16x16x32_bf16 v[112:115], a[32:35], a[8:11], v[112:115]
    v_mfma_f32_16x16x32_bf16 v[136:139], a[32:35], a[12:15], v[136:139]
    ds_read_b128 a[56:59], v18 offset:0
    v_mfma_f32_16x16x32_bf16 v[160:163], a[32:35], a[16:19], v[160:163]
    ds_read_b128 a[60:63], v18 offset:2048
    v_mfma_f32_16x16x32_bf16 v[184:187], a[32:35], a[20:23], v[184:187]
    v_mfma_f32_16x16x32_bf16 v[208:211], a[32:35], a[24:27], v[208:211]
    ds_read_b128 a[64:67], v18 offset:4096
    v_mfma_f32_16x16x32_bf16 v[232:235], a[32:35], a[28:31], v[232:235]
    ds_read_b128 a[68:71], v18 offset:6144
    v_mfma_f32_16x16x32_bf16 v[68:71], a[36:39], a[0:3], v[68:71]
    v_mfma_f32_16x16x32_bf16 v[92:95], a[36:39], a[4:7], v[92:95]
    ds_read_b128 a[72:75], v18 offset:8192
    v_mfma_f32_16x16x32_bf16 v[116:119], a[36:39], a[8:11], v[116:119]
    v_mfma_f32_16x16x32_bf16 v[140:143], a[36:39], a[12:15], v[140:143]
    ds_read_b128 a[76:79], v18 offset:10240
    v_mfma_f32_16x16x32_bf16 v[164:167], a[36:39], a[16:19], v[164:167]
    ds_read_b128 a[80:83], v18 offset:12288
    v_mfma_f32_16x16x32_bf16 v[188:191], a[36:39], a[20:23], v[188:191]
    v_mfma_f32_16x16x32_bf16 v[212:215], a[36:39], a[24:27], v[212:215]
    ds_read_b128 a[84:87], v18 offset:14336
    v_mfma_f32_16x16x32_bf16 v[236:239], a[36:39], a[28:31], v[236:239]
    ds_read_b64_tr_b16 a[92:93], v20 offset:12288
    v_mfma_f32_16x16x32_bf16 v[72:75], a[40:43], a[0:3], v[72:75]
    v_mfma_f32_16x16x32_bf16 v[96:99], a[40:43], a[4:7], v[96:99]
    ds_read_b64_tr_b16 a[94:95], v20 offset:13824
    v_mfma_f32_16x16x32_bf16 v[120:123], a[40:43], a[8:11], v[120:123]
    ds_read_b64_tr_b16 a[96:97], v19 offset:12416
    v_mfma_f32_16x16x32_bf16 v[144:147], a[40:43], a[12:15], v[144:147]
    v_mfma_f32_16x16x32_bf16 v[168:171], a[40:43], a[16:19], v[168:171]
    ds_read_b64_tr_b16 a[98:99], v19 offset:13952
    v_mfma_f32_16x16x32_bf16 v[192:195], a[40:43], a[20:23], v[192:195]
    v_mfma_f32_16x16x32_bf16 v[216:219], a[40:43], a[24:27], v[216:219]
    ds_read_b64_tr_b16 a[100:101], v20 offset:12416
    v_mfma_f32_16x16x32_bf16 v[240:243], a[40:43], a[28:31], v[240:243]
    ds_read_b64_tr_b16 a[102:103], v20 offset:13952
    v_mfma_f32_16x16x32_bf16 v[76:79], a[44:47], a[0:3], v[76:79]
    v_mfma_f32_16x16x32_bf16 v[100:103], a[44:47], a[4:7], v[100:103]
    ds_read_b64_tr_b16 a[104:105], v19 offset:12544
    v_mfma_f32_16x16x32_bf16 v[124:127], a[44:47], a[8:11], v[124:127]
    ds_read_b64_tr_b16 a[106:107], v19 offset:14080
    v_mfma_f32_16x16x32_bf16 v[148:151], a[44:47], a[12:15], v[148:151]
    v_mfma_f32_16x16x32_bf16 v[172:175], a[44:47], a[16:19], v[172:175]
    ds_read_b64_tr_b16 a[108:109], v20 offset:12544
    v_mfma_f32_16x16x32_bf16 v[196:199], a[44:47], a[20:23], v[196:199]
    v_mfma_f32_16x16x32_bf16 v[220:223], a[44:47], a[24:27], v[220:223]
    ds_read_b64_tr_b16 a[110:111], v20 offset:14080
    v_mfma_f32_16x16x32_bf16 v[244:247], a[44:47], a[28:31], v[244:247]
    v_mfma_f32_16x16x32_bf16 v[80:83], a[0:3], a[48:51], v[80:83]
    v_mfma_f32_16x16x32_bf16 v[104:107], a[4:7], a[48:51], v[104:107]
    v_mfma_f32_16x16x32_bf16 v[128:131], a[8:11], a[48:51], v[128:131]
    s_waitcnt vmcnt(5) lgkmcnt(0)
    s_barrier
    v_mfma_f32_16x16x32_bf16 v[152:155], a[12:15], a[48:51], v[152:155]
    v_mfma_f32_16x16x32_bf16 v[176:179], a[16:19], a[48:51], v[176:179]
    v_mfma_f32_16x16x32_bf16 v[200:203], a[20:23], a[48:51], v[200:203]
    v_mfma_f32_16x16x32_bf16 v[224:227], a[24:27], a[48:51], v[224:227]
    v_mfma_f32_16x16x32_bf16 v[248:251], a[28:31], a[48:51], v[248:251]
    v_mfma_f32_16x16x32_bf16 v[84:87], a[0:3], a[52:55], v[84:87]
    v_mfma_f32_16x16x32_bf16 v[108:111], a[4:7], a[52:55], v[108:111]
    v_mfma_f32_16x16x32_bf16 v[132:135], a[8:11], a[52:55], v[132:135]
    v_mfma_f32_16x16x32_bf16 v[156:159], a[12:15], a[52:55], v[156:159]
    v_mfma_f32_16x16x32_bf16 v[180:183], a[16:19], a[52:55], v[180:183]
    v_mfma_f32_16x16x32_bf16 v[204:207], a[20:23], a[52:55], v[204:207]
    v_mfma_f32_16x16x32_bf16 v[228:231], a[24:27], a[52:55], v[228:231]
    v_mfma_f32_16x16x32_bf16 v[252:255], a[28:31], a[52:55], v[252:255]
    v_mfma_f32_16x16x32_bf16 v[64:67], a[88:91], a[56:59], v[64:67]
    ds_read_b64_tr_b16 a[32:33], v19 offset:24576
    v_mfma_f32_16x16x32_bf16 v[88:91], a[88:91], a[60:63], v[88:91]
    ds_read_b64_tr_b16 a[34:35], v19 offset:26112
    v_mfma_f32_16x16x32_bf16 v[112:115], a[88:91], a[64:67], v[112:115]
    v_mfma_f32_16x16x32_bf16 v[136:139], a[88:91], a[68:71], v[136:139]
    ds_read_b128 a[0:3], v17 offset:32768
    v_mfma_f32_16x16x32_bf16 v[160:163], a[88:91], a[72:75], v[160:163]
    v_mfma_f32_16x16x32_bf16 v[184:187], a[88:91], a[76:79], v[184:187]
    ds_read_b128 a[4:7], v17 offset:34816
    v_mfma_f32_16x16x32_bf16 v[208:211], a[88:91], a[80:83], v[208:211]
    v_mfma_f32_16x16x32_bf16 v[232:235], a[88:91], a[84:87], v[232:235]
    ds_read_b128 a[8:11], v17 offset:36864
    v_mfma_f32_16x16x32_bf16 v[68:71], a[92:95], a[56:59], v[68:71]
    ds_read_b128 a[12:15], v17 offset:38912
    v_mfma_f32_16x16x32_bf16 v[92:95], a[92:95], a[60:63], v[92:95]
    v_mfma_f32_16x16x32_bf16 v[116:119], a[92:95], a[64:67], v[116:119]
    ds_read_b128 a[16:19], v17 offset:40960
    v_mfma_f32_16x16x32_bf16 v[140:143], a[92:95], a[68:71], v[140:143]
    v_mfma_f32_16x16x32_bf16 v[164:167], a[92:95], a[72:75], v[164:167]
    ds_read_b128 a[20:23], v17 offset:43008
    v_mfma_f32_16x16x32_bf16 v[188:191], a[92:95], a[76:79], v[188:191]
    v_mfma_f32_16x16x32_bf16 v[212:215], a[92:95], a[80:83], v[212:215]
    ds_read_b128 a[24:27], v17 offset:45056
    v_mfma_f32_16x16x32_bf16 v[236:239], a[92:95], a[84:87], v[236:239]
    v_mfma_f32_16x16x32_bf16 v[72:75], a[96:99], a[56:59], v[72:75]
    ds_read_b128 a[28:31], v17 offset:47104
    v_mfma_f32_16x16x32_bf16 v[96:99], a[96:99], a[60:63], v[96:99]
    ds_read_b64_tr_b16 a[36:37], v20 offset:24576
    v_mfma_f32_16x16x32_bf16 v[120:123], a[96:99], a[64:67], v[120:123]
    v_mfma_f32_16x16x32_bf16 v[144:147], a[96:99], a[68:71], v[144:147]
    ds_read_b64_tr_b16 a[38:39], v20 offset:26112
    v_mfma_f32_16x16x32_bf16 v[168:171], a[96:99], a[72:75], v[168:171]
    v_mfma_f32_16x16x32_bf16 v[192:195], a[96:99], a[76:79], v[192:195]
    ds_read_b64_tr_b16 a[40:41], v19 offset:24704
    v_mfma_f32_16x16x32_bf16 v[216:219], a[96:99], a[80:83], v[216:219]
    v_mfma_f32_16x16x32_bf16 v[240:243], a[96:99], a[84:87], v[240:243]
    ds_read_b64_tr_b16 a[42:43], v19 offset:26240
    v_mfma_f32_16x16x32_bf16 v[76:79], a[100:103], a[56:59], v[76:79]
    v_mfma_f32_16x16x32_bf16 v[100:103], a[100:103], a[60:63], v[100:103]
    ds_read_b64_tr_b16 a[44:45], v20 offset:24704
    v_mfma_f32_16x16x32_bf16 v[124:127], a[100:103], a[64:67], v[124:127]
    ds_read_b64_tr_b16 a[46:47], v20 offset:26240
    v_mfma_f32_16x16x32_bf16 v[148:151], a[100:103], a[68:71], v[148:151]
    v_mfma_f32_16x16x32_bf16 v[172:175], a[100:103], a[72:75], v[172:175]
    ds_read_b64_tr_b16 a[48:49], v19 offset:24832
    v_mfma_f32_16x16x32_bf16 v[196:199], a[100:103], a[76:79], v[196:199]
    v_mfma_f32_16x16x32_bf16 v[220:223], a[100:103], a[80:83], v[220:223]
    ds_read_b64_tr_b16 a[50:51], v19 offset:26368
    v_mfma_f32_16x16x32_bf16 v[244:247], a[100:103], a[84:87], v[244:247]
    v_mfma_f32_16x16x32_bf16 v[80:83], a[56:59], a[104:107], v[80:83]
    ds_read_b64_tr_b16 a[52:53], v20 offset:24832
    v_mfma_f32_16x16x32_bf16 v[104:107], a[60:63], a[104:107], v[104:107]
    v_mfma_f32_16x16x32_bf16 v[128:131], a[64:67], a[104:107], v[128:131]
    ds_read_b64_tr_b16 a[54:55], v20 offset:26368
    v_mfma_f32_16x16x32_bf16 v[152:155], a[68:71], a[104:107], v[152:155]
    v_mfma_f32_16x16x32_bf16 v[176:179], a[72:75], a[104:107], v[176:179]
    v_mfma_f32_16x16x32_bf16 v[200:203], a[76:79], a[104:107], v[200:203]
    v_mfma_f32_16x16x32_bf16 v[224:227], a[80:83], a[104:107], v[224:227]
    v_mfma_f32_16x16x32_bf16 v[248:251], a[84:87], a[104:107], v[248:251]
    v_mfma_f32_16x16x32_bf16 v[84:87], a[56:59], a[108:111], v[84:87]
    v_mfma_f32_16x16x32_bf16 v[108:111], a[60:63], a[108:111], v[108:111]
    v_mfma_f32_16x16x32_bf16 v[132:135], a[64:67], a[108:111], v[132:135]
    v_mfma_f32_16x16x32_bf16 v[156:159], a[68:71], a[108:111], v[156:159]
    v_mfma_f32_16x16x32_bf16 v[180:183], a[72:75], a[108:111], v[180:183]
    v_mfma_f32_16x16x32_bf16 v[204:207], a[76:79], a[108:111], v[204:207]
    v_mfma_f32_16x16x32_bf16 v[228:231], a[80:83], a[108:111], v[228:231]
    v_mfma_f32_16x16x32_bf16 v[252:255], a[84:87], a[108:111], v[252:255]
    s_waitcnt lgkmcnt(0)
    v_mfma_f32_16x16x32_bf16 v[64:67], a[32:35], a[0:3], v[64:67]
    ds_read_b64_tr_b16 a[88:89], v19 offset:36864
    v_mfma_f32_16x16x32_bf16 v[88:91], a[32:35], a[4:7], v[88:91]
    ds_read_b64_tr_b16 a[90:91], v19 offset:38400
    v_mfma_f32_16x16x32_bf16 v[112:115], a[32:35], a[8:11], v[112:115]
    v_mfma_f32_16x16x32_bf16 v[136:139], a[32:35], a[12:15], v[136:139]
    ds_read_b128 a[56:59], v18 offset:32768
    v_mfma_f32_16x16x32_bf16 v[160:163], a[32:35], a[16:19], v[160:163]
    ds_read_b128 a[60:63], v18 offset:34816
    v_mfma_f32_16x16x32_bf16 v[184:187], a[32:35], a[20:23], v[184:187]
    v_mfma_f32_16x16x32_bf16 v[208:211], a[32:35], a[24:27], v[208:211]
    ds_read_b128 a[64:67], v18 offset:36864
    v_mfma_f32_16x16x32_bf16 v[232:235], a[32:35], a[28:31], v[232:235]
    ds_read_b128 a[68:71], v18 offset:38912
    v_mfma_f32_16x16x32_bf16 v[68:71], a[36:39], a[0:3], v[68:71]
    v_mfma_f32_16x16x32_bf16 v[92:95], a[36:39], a[4:7], v[92:95]
    ds_read_b128 a[72:75], v18 offset:40960
    v_mfma_f32_16x16x32_bf16 v[116:119], a[36:39], a[8:11], v[116:119]
    v_mfma_f32_16x16x32_bf16 v[140:143], a[36:39], a[12:15], v[140:143]
    ds_read_b128 a[76:79], v18 offset:43008
    v_mfma_f32_16x16x32_bf16 v[164:167], a[36:39], a[16:19], v[164:167]
    ds_read_b128 a[80:83], v18 offset:45056
    v_mfma_f32_16x16x32_bf16 v[188:191], a[36:39], a[20:23], v[188:191]
    v_mfma_f32_16x16x32_bf16 v[212:215], a[36:39], a[24:27], v[212:215]
    ds_read_b128 a[84:87], v18 offset:47104
    v_mfma_f32_16x16x32_bf16 v[236:239], a[36:39], a[28:31], v[236:239]
    ds_read_b64_tr_b16 a[92:93], v20 offset:36864
    v_mfma_f32_16x16x32_bf16 v[72:75], a[40:43], a[0:3], v[72:75]
    v_mfma_f32_16x16x32_bf16 v[96:99], a[40:43], a[4:7], v[96:99]
    ds_read_b64_tr_b16 a[94:95], v20 offset:38400
    v_mfma_f32_16x16x32_bf16 v[120:123], a[40:43], a[8:11], v[120:123]
    ds_read_b64_tr_b16 a[96:97], v19 offset:36992
    v_mfma_f32_16x16x32_bf16 v[144:147], a[40:43], a[12:15], v[144:147]
    v_mfma_f32_16x16x32_bf16 v[168:171], a[40:43], a[16:19], v[168:171]
    ds_read_b64_tr_b16 a[98:99], v19 offset:38528
    v_mfma_f32_16x16x32_bf16 v[192:195], a[40:43], a[20:23], v[192:195]
    v_mfma_f32_16x16x32_bf16 v[216:219], a[40:43], a[24:27], v[216:219]
    ds_read_b64_tr_b16 a[100:101], v20 offset:36992
    v_mfma_f32_16x16x32_bf16 v[240:243], a[40:43], a[28:31], v[240:243]
    ds_read_b64_tr_b16 a[102:103], v20 offset:38528
    v_mfma_f32_16x16x32_bf16 v[76:79], a[44:47], a[0:3], v[76:79]
    v_mfma_f32_16x16x32_bf16 v[100:103], a[44:47], a[4:7], v[100:103]
    ds_read_b64_tr_b16 a[104:105], v19 offset:37120
    v_mfma_f32_16x16x32_bf16 v[124:127], a[44:47], a[8:11], v[124:127]
    ds_read_b64_tr_b16 a[106:107], v19 offset:38656
    v_mfma_f32_16x16x32_bf16 v[148:151], a[44:47], a[12:15], v[148:151]
    v_mfma_f32_16x16x32_bf16 v[172:175], a[44:47], a[16:19], v[172:175]
    ds_read_b64_tr_b16 a[108:109], v20 offset:37120
    v_mfma_f32_16x16x32_bf16 v[196:199], a[44:47], a[20:23], v[196:199]
    v_mfma_f32_16x16x32_bf16 v[220:223], a[44:47], a[24:27], v[220:223]
    ds_read_b64_tr_b16 a[110:111], v20 offset:38656
    v_mfma_f32_16x16x32_bf16 v[244:247], a[44:47], a[28:31], v[244:247]
    v_mfma_f32_16x16x32_bf16 v[80:83], a[0:3], a[48:51], v[80:83]
    v_mfma_f32_16x16x32_bf16 v[104:107], a[4:7], a[48:51], v[104:107]
    v_mfma_f32_16x16x32_bf16 v[128:131], a[8:11], a[48:51], v[128:131]
    s_waitcnt lgkmcnt(0)
    v_mfma_f32_16x16x32_bf16 v[152:155], a[12:15], a[48:51], v[152:155]
    v_mfma_f32_16x16x32_bf16 v[176:179], a[16:19], a[48:51], v[176:179]
    v_mfma_f32_16x16x32_bf16 v[200:203], a[20:23], a[48:51], v[200:203]
    v_mfma_f32_16x16x32_bf16 v[224:227], a[24:27], a[48:51], v[224:227]
    v_mfma_f32_16x16x32_bf16 v[248:251], a[28:31], a[48:51], v[248:251]
    v_mfma_f32_16x16x32_bf16 v[84:87], a[0:3], a[52:55], v[84:87]
    v_mfma_f32_16x16x32_bf16 v[108:111], a[4:7], a[52:55], v[108:111]
    v_mfma_f32_16x16x32_bf16 v[132:135], a[8:11], a[52:55], v[132:135]
    v_mfma_f32_16x16x32_bf16 v[156:159], a[12:15], a[52:55], v[156:159]
    v_mfma_f32_16x16x32_bf16 v[180:183], a[16:19], a[52:55], v[180:183]
    v_mfma_f32_16x16x32_bf16 v[204:207], a[20:23], a[52:55], v[204:207]
    v_mfma_f32_16x16x32_bf16 v[228:231], a[24:27], a[52:55], v[228:231]
    v_mfma_f32_16x16x32_bf16 v[252:255], a[28:31], a[52:55], v[252:255]
    v_mfma_f32_16x16x32_bf16 v[64:67], a[88:91], a[56:59], v[64:67]
    v_mfma_f32_16x16x32_bf16 v[88:91], a[88:91], a[60:63], v[88:91]
    v_mfma_f32_16x16x32_bf16 v[112:115], a[88:91], a[64:67], v[112:115]
    v_mfma_f32_16x16x32_bf16 v[136:139], a[88:91], a[68:71], v[136:139]
    v_mfma_f32_16x16x32_bf16 v[160:163], a[88:91], a[72:75], v[160:163]
    v_mfma_f32_16x16x32_bf16 v[184:187], a[88:91], a[76:79], v[184:187]
    v_mfma_f32_16x16x32_bf16 v[208:211], a[88:91], a[80:83], v[208:211]
    v_mfma_f32_16x16x32_bf16 v[232:235], a[88:91], a[84:87], v[232:235]
    v_mfma_f32_16x16x32_bf16 v[68:71], a[92:95], a[56:59], v[68:71]
    v_mfma_f32_16x16x32_bf16 v[92:95], a[92:95], a[60:63], v[92:95]
    v_mfma_f32_16x16x32_bf16 v[116:119], a[92:95], a[64:67], v[116:119]
    v_mfma_f32_16x16x32_bf16 v[140:143], a[92:95], a[68:71], v[140:143]
    v_mfma_f32_16x16x32_bf16 v[164:167], a[92:95], a[72:75], v[164:167]
    v_mfma_f32_16x16x32_bf16 v[188:191], a[92:95], a[76:79], v[188:191]
    v_mfma_f32_16x16x32_bf16 v[212:215], a[92:95], a[80:83], v[212:215]
    v_mfma_f32_16x16x32_bf16 v[236:239], a[92:95], a[84:87], v[236:239]
    v_mfma_f32_16x16x32_bf16 v[72:75], a[96:99], a[56:59], v[72:75]
    v_mfma_f32_16x16x32_bf16 v[96:99], a[96:99], a[60:63], v[96:99]
    v_mfma_f32_16x16x32_bf16 v[120:123], a[96:99], a[64:67], v[120:123]
    v_mfma_f32_16x16x32_bf16 v[144:147], a[96:99], a[68:71], v[144:147]
    v_mfma_f32_16x16x32_bf16 v[168:171], a[96:99], a[72:75], v[168:171]
    v_mfma_f32_16x16x32_bf16 v[192:195], a[96:99], a[76:79], v[192:195]
    v_mfma_f32_16x16x32_bf16 v[216:219], a[96:99], a[80:83], v[216:219]
    v_mfma_f32_16x16x32_bf16 v[240:243], a[96:99], a[84:87], v[240:243]
    v_mfma_f32_16x16x32_bf16 v[76:79], a[100:103], a[56:59], v[76:79]
    v_mfma_f32_16x16x32_bf16 v[100:103], a[100:103], a[60:63], v[100:103]
    v_mfma_f32_16x16x32_bf16 v[124:127], a[100:103], a[64:67], v[124:127]
    v_mfma_f32_16x16x32_bf16 v[148:151], a[100:103], a[68:71], v[148:151]
    v_mfma_f32_16x16x32_bf16 v[172:175], a[100:103], a[72:75], v[172:175]
    v_mfma_f32_16x16x32_bf16 v[196:199], a[100:103], a[76:79], v[196:199]
    v_mfma_f32_16x16x32_bf16 v[220:223], a[100:103], a[80:83], v[220:223]
    v_mfma_f32_16x16x32_bf16 v[244:247], a[100:103], a[84:87], v[244:247]
    v_mfma_f32_16x16x32_bf16 v[80:83], a[56:59], a[104:107], v[80:83]
    v_mfma_f32_16x16x32_bf16 v[104:107], a[60:63], a[104:107], v[104:107]
    v_mfma_f32_16x16x32_bf16 v[128:131], a[64:67], a[104:107], v[128:131]
    v_mfma_f32_16x16x32_bf16 v[152:155], a[68:71], a[104:107], v[152:155]
    v_mfma_f32_16x16x32_bf16 v[176:179], a[72:75], a[104:107], v[176:179]
    v_mfma_f32_16x16x32_bf16 v[200:203], a[76:79], a[104:107], v[200:203]
    v_mfma_f32_16x16x32_bf16 v[224:227], a[80:83], a[104:107], v[224:227]
    v_mfma_f32_16x16x32_bf16 v[248:251], a[84:87], a[104:107], v[248:251]
    v_mfma_f32_16x16x32_bf16 v[84:87], a[56:59], a[108:111], v[84:87]
    v_mfma_f32_16x16x32_bf16 v[108:111], a[60:63], a[108:111], v[108:111]
    v_mfma_f32_16x16x32_bf16 v[132:135], a[64:67], a[108:111], v[132:135]
    v_mfma_f32_16x16x32_bf16 v[156:159], a[68:71], a[108:111], v[156:159]
    v_mfma_f32_16x16x32_bf16 v[180:183], a[72:75], a[108:111], v[180:183]
    v_mfma_f32_16x16x32_bf16 v[204:207], a[76:79], a[108:111], v[204:207]
    v_mfma_f32_16x16x32_bf16 v[228:231], a[80:83], a[108:111], v[228:231]
    v_mfma_f32_16x16x32_bf16 v[252:255], a[84:87], a[108:111], v[252:255]
gated_mix__linear_kernel_hedgehog__mixer_channel_mlp__prompt_kernel_qepi:
    s_barrier
    s_mov_b32 s60, 0x3fb8aa3b
    s_mov_b32 s61, 0x3fb8aa3b
    s_mov_b32 s62, 0xbfb8aa3b
    s_mov_b32 s63, 0xbfb8aa3b
    v_lshrrev_b32 v24, 4, v1
    v_bfe_u32 v25, v1, 2, 2
    v_lshlrev_b32 v24, 2, v24
    v_add_u32 v24, v24, v25
    v_lshlrev_b32 v24, 6, v24
    v_and_b32 v25, 3, v1
    v_lshlrev_b32 v25, 3, v25
    v_add_u32 v24, v24, v25
    s_lshl_b32 s44, s34, 11
    s_add_u32 s44, s44, 114688
    v_add_u32 v24, s44, v24
    ds_read_b64_tr_b16 a[200:201], v24 offset:0
    ds_read_b64_tr_b16 a[202:203], v24 offset:1024
    ds_read_b64_tr_b16 a[204:205], v24 offset:32
    ds_read_b64_tr_b16 a[206:207], v24 offset:1056
    s_waitcnt lgkmcnt(0)
    s_mov_b32 s72, s52
    s_mov_b32 s73, s53
    s_mov_b32 s74, 37748736
    s_mov_b32 s75, 0x20000
    v_lshlrev_b32 v60, 7, v1
    s_lshl_b32 s44, s36, 1
    s_add_u32 s44, s44, s34
    s_lshl_b32 s44, s44, 3
    s_add_u32 s44, s44, s35
    s_lshl_b32 s44, s44, 1
    s_add_u32 s44, s44, s33
    s_mul_i32 s44, s44, 2176
    s_add_u32 s44, s44, 24117248
    v_min_u32 v61, 2176, v60
    buffer_load_dword a252, v61, s[72:75], s44 offen
    s_lshl_b32 s44, s35, 1
    s_add_u32 s44, s44, s33
    s_mul_i32 s44, s44, 144
    s_lshl_b32 s45, s36, 1
    s_add_u32 s45, s45, s34
    s_add_u32 s44, s44, s45
    s_add_u32 s44, s44, 112
    s_lshl_b32 s44, s44, 13
    v_cvt_pk_bf16_f32 v2, v72, v73
    v_cvt_pk_bf16_f32 v28, v96, v97
    v_cvt_pk_bf16_f32 v3, v74, v75
    v_cvt_pk_bf16_f32 v29, v98, v99
    v_cvt_pk_bf16_f32 v4, v76, v77
    v_cvt_pk_bf16_f32 v30, v100, v101
    v_cvt_pk_bf16_f32 v5, v78, v79
    v_cvt_pk_bf16_f32 v31, v102, v103
    s_nop 0
    v_mfma_f32_16x16x32_bf16 v[72:75], a[200:203], v[2:5], 0
    v_mfma_f32_16x16x32_bf16 v[96:99], a[200:203], v[28:31], 0
    v_mfma_f32_16x16x32_bf16 v[76:79], a[204:207], v[2:5], 0
    v_mfma_f32_16x16x32_bf16 v[100:103], a[204:207], v[28:31], 0
    s_nop 4
    v_max3_f32 v14, v72, v73, v74
    v_max3_f32 v40, v96, v97, v98
    v_min3_f32 v15, v72, v73, v74
    v_min3_f32 v41, v96, v97, v98
    v_max3_f32 v14, v14, v75, v76
    v_max3_f32 v40, v40, v99, v100
    v_min3_f32 v15, v15, v75, v76
    v_min3_f32 v41, v41, v99, v100
    v_max3_f32 v14, v14, v77, v78
    v_max3_f32 v40, v40, v101, v102
    v_min3_f32 v15, v15, v77, v78
    v_min3_f32 v41, v41, v101, v102
    v_max_f32 v14, v14, v79
    v_max_f32 v40, v40, v103
    v_max_f32 v15, -v15, -v79
    v_max_f32 v41, -v41, -v103
    s_nop 0
    v_permlane32_swap_b32 v14, v15
    v_permlane32_swap_b32 v40, v41
    v_max_f32 v14, v14, v15
    v_max_f32 v40, v40, v41
    v_mov_b32 v16, v14
    v_mov_b32 v42, v40
    s_nop 0
    v_permlane16_swap_b32 v14, v16
    v_permlane16_swap_b32 v40, v42
    v_max_f32 v14, v14, v16
    v_max_f32 v40, v40, v42
    v_mov_b32 v15, v14
    v_mov_b32 v41, v40
    s_nop 0
    v_permlane32_swap_b32 v14, v15
    v_permlane32_swap_b32 v40, v41
    v_pk_mul_f32 v[14:15], v[14:15], s[62:63]
    v_pk_mul_f32 v[40:41], v[40:41], s[62:63]
    v_pk_fma_f32 v[6:7], v[72:73], s[62:63], v[14:15] op_sel:[0,0,1] op_sel_hi:[1,1,1]
    v_pk_fma_f32 v[32:33], v[96:97], s[62:63], v[40:41] op_sel:[0,0,1] op_sel_hi:[1,1,1]
    v_pk_fma_f32 v[8:9], v[74:75], s[62:63], v[14:15] op_sel:[0,0,1] op_sel_hi:[1,1,1]
    v_pk_fma_f32 v[34:35], v[98:99], s[62:63], v[40:41] op_sel:[0,0,1] op_sel_hi:[1,1,1]
    v_pk_fma_f32 v[10:11], v[76:77], s[62:63], v[14:15] op_sel:[0,0,1] op_sel_hi:[1,1,1]
    v_pk_fma_f32 v[36:37], v[100:101], s[62:63], v[40:41] op_sel:[0,0,1] op_sel_hi:[1,1,1]
    v_pk_fma_f32 v[12:13], v[78:79], s[62:63], v[14:15] op_sel:[0,0,1] op_sel_hi:[1,1,1]
    v_pk_fma_f32 v[38:39], v[102:103], s[62:63], v[40:41] op_sel:[0,0,1] op_sel_hi:[1,1,1]
    v_pk_fma_f32 v[72:73], v[72:73], s[60:61], v[14:15] op_sel_hi:[1,1,0]
    v_pk_fma_f32 v[96:97], v[96:97], s[60:61], v[40:41] op_sel_hi:[1,1,0]
    v_pk_fma_f32 v[74:75], v[74:75], s[60:61], v[14:15] op_sel_hi:[1,1,0]
    v_pk_fma_f32 v[98:99], v[98:99], s[60:61], v[40:41] op_sel_hi:[1,1,0]
    v_pk_fma_f32 v[76:77], v[76:77], s[60:61], v[14:15] op_sel_hi:[1,1,0]
    v_pk_fma_f32 v[100:101], v[100:101], s[60:61], v[40:41] op_sel_hi:[1,1,0]
    v_pk_fma_f32 v[78:79], v[78:79], s[60:61], v[14:15] op_sel_hi:[1,1,0]
    v_pk_fma_f32 v[102:103], v[102:103], s[60:61], v[40:41] op_sel_hi:[1,1,0]
    v_exp_f32 v72, v72
    v_exp_f32 v96, v96
    v_exp_f32 v6, v6
    v_exp_f32 v32, v32
    v_exp_f32 v73, v73
    v_exp_f32 v97, v97
    v_exp_f32 v7, v7
    v_exp_f32 v33, v33
    v_exp_f32 v74, v74
    v_exp_f32 v98, v98
    v_exp_f32 v8, v8
    v_exp_f32 v34, v34
    v_exp_f32 v75, v75
    v_exp_f32 v99, v99
    v_exp_f32 v9, v9
    v_exp_f32 v35, v35
    v_exp_f32 v76, v76
    v_exp_f32 v100, v100
    v_exp_f32 v10, v10
    v_exp_f32 v36, v36
    v_exp_f32 v77, v77
    v_exp_f32 v101, v101
    v_exp_f32 v11, v11
    v_exp_f32 v37, v37
    v_exp_f32 v78, v78
    v_exp_f32 v102, v102
    v_exp_f32 v12, v12
    v_exp_f32 v38, v38
    v_exp_f32 v79, v79
    v_exp_f32 v103, v103
    v_exp_f32 v13, v13
    v_exp_f32 v39, v39
    v_pk_add_f32 v[16:17], v[72:73], v[74:75]
    v_pk_add_f32 v[42:43], v[96:97], v[98:99]
    v_pk_add_f32 v[18:19], v[6:7], v[8:9]
    v_pk_add_f32 v[44:45], v[32:33], v[34:35]
    v_pk_add_f32 v[16:17], v[16:17], v[76:77]
    v_pk_add_f32 v[42:43], v[42:43], v[100:101]
    v_pk_add_f32 v[18:19], v[18:19], v[10:11]
    v_pk_add_f32 v[44:45], v[44:45], v[36:37]
    v_pk_add_f32 v[16:17], v[16:17], v[78:79]
    v_pk_add_f32 v[42:43], v[42:43], v[102:103]
    v_pk_add_f32 v[18:19], v[18:19], v[12:13]
    v_pk_add_f32 v[44:45], v[44:45], v[38:39]
    v_add_f32 v14, v16, v17
    v_add_f32 v40, v42, v43
    v_add_f32 v15, v18, v19
    v_add_f32 v41, v44, v45
    s_nop 0
    v_permlane32_swap_b32 v14, v15
    v_permlane32_swap_b32 v40, v41
    v_add_f32 v14, v14, v15
    v_add_f32 v40, v40, v41
    v_mov_b32 v16, v14
    v_mov_b32 v42, v40
    s_nop 0
    v_permlane16_swap_b32 v14, v16
    v_permlane16_swap_b32 v40, v42
    v_add_f32 v14, v14, v16
    v_add_f32 v40, v40, v42
    v_mov_b32 v15, v14
    v_mov_b32 v41, v40
    s_nop 0
    v_permlane32_swap_b32 v14, v15
    v_permlane32_swap_b32 v40, v41
    v_rcp_f32 v14, v14
    v_rcp_f32 v40, v40
    v_rcp_f32 v15, v15
    v_rcp_f32 v41, v41
    v_pk_mul_f32 v[72:73], v[72:73], v[14:15] op_sel_hi:[1,0]
    v_pk_mul_f32 v[96:97], v[96:97], v[40:41] op_sel_hi:[1,0]
    v_pk_mul_f32 v[74:75], v[74:75], v[14:15] op_sel_hi:[1,0]
    v_pk_mul_f32 v[98:99], v[98:99], v[40:41] op_sel_hi:[1,0]
    v_pk_mul_f32 v[76:77], v[76:77], v[14:15] op_sel_hi:[1,0]
    v_pk_mul_f32 v[100:101], v[100:101], v[40:41] op_sel_hi:[1,0]
    v_pk_mul_f32 v[78:79], v[78:79], v[14:15] op_sel_hi:[1,0]
    v_pk_mul_f32 v[102:103], v[102:103], v[40:41] op_sel_hi:[1,0]
    v_pk_mul_f32 v[6:7], v[6:7], v[14:15] op_sel:[0,1] op_sel_hi:[1,1]
    v_pk_mul_f32 v[32:33], v[32:33], v[40:41] op_sel:[0,1] op_sel_hi:[1,1]
    v_pk_mul_f32 v[8:9], v[8:9], v[14:15] op_sel:[0,1] op_sel_hi:[1,1]
    v_pk_mul_f32 v[34:35], v[34:35], v[40:41] op_sel:[0,1] op_sel_hi:[1,1]
    v_pk_mul_f32 v[10:11], v[10:11], v[14:15] op_sel:[0,1] op_sel_hi:[1,1]
    v_pk_mul_f32 v[36:37], v[36:37], v[40:41] op_sel:[0,1] op_sel_hi:[1,1]
    v_pk_mul_f32 v[12:13], v[12:13], v[14:15] op_sel:[0,1] op_sel_hi:[1,1]
    v_pk_mul_f32 v[38:39], v[38:39], v[40:41] op_sel:[0,1] op_sel_hi:[1,1]
    v_cvt_pk_bf16_f32 v20, v72, v73
    v_cvt_pk_bf16_f32 v46, v96, v97
    v_cvt_pk_bf16_f32 v21, v74, v75
    v_cvt_pk_bf16_f32 v47, v98, v99
    v_cvt_pk_bf16_f32 v22, v76, v77
    v_cvt_pk_bf16_f32 v48, v100, v101
    v_cvt_pk_bf16_f32 v23, v78, v79
    v_cvt_pk_bf16_f32 v49, v102, v103
    v_cvt_pk_bf16_f32 v24, v6, v7
    v_cvt_pk_bf16_f32 v50, v32, v33
    v_cvt_pk_bf16_f32 v25, v8, v9
    v_cvt_pk_bf16_f32 v51, v34, v35
    v_cvt_pk_bf16_f32 v26, v10, v11
    v_cvt_pk_bf16_f32 v52, v36, v37
    v_cvt_pk_bf16_f32 v27, v12, v13
    v_cvt_pk_bf16_f32 v53, v38, v39
    s_nop 0
    v_mfma_f32_16x16x32_bf16 v[72:75], v[20:23], a[210:213], 0
    v_mfma_f32_16x16x32_bf16 v[76:79], v[20:23], a[208:211], 0
    v_mfma_f32_16x16x32_bf16 v[6:9], v[24:27], a[210:213], 0
    v_mfma_f32_16x16x32_bf16 v[10:13], v[24:27], a[208:211], 0
    v_mfma_f32_16x16x32_bf16 v[96:99], v[46:49], a[210:213], 0
    v_mfma_f32_16x16x32_bf16 v[100:103], v[46:49], a[208:211], 0
    v_mfma_f32_16x16x32_bf16 v[32:35], v[50:53], a[210:213], 0
    v_mfma_f32_16x16x32_bf16 v[36:39], v[50:53], a[208:211], 0
    v_cvt_pk_bf16_f32 v80, v80, v81
    v_cvt_pk_bf16_f32 v81, v82, v83
    v_cvt_pk_bf16_f32 v82, v104, v105
    v_cvt_pk_bf16_f32 v83, v106, v107
    v_cvt_pk_bf16_f32 v84, v84, v85
    v_cvt_pk_bf16_f32 v85, v86, v87
    v_cvt_pk_bf16_f32 v86, v108, v109
    v_cvt_pk_bf16_f32 v87, v110, v111
    v_cvt_pk_bf16_f32 v54, v72, v73
    v_cvt_pk_bf16_f32 v55, v74, v75
    v_cvt_pk_bf16_f32 v56, v96, v97
    v_cvt_pk_bf16_f32 v57, v98, v99
    v_cvt_pk_bf16_f32 v58, v76, v77
    v_cvt_pk_bf16_f32 v59, v78, v79
    v_cvt_pk_bf16_f32 v60, v100, v101
    v_cvt_pk_bf16_f32 v61, v102, v103
    v_cvt_pk_bf16_f32 v104, v6, v7
    v_cvt_pk_bf16_f32 v105, v8, v9
    v_cvt_pk_bf16_f32 v106, v32, v33
    v_cvt_pk_bf16_f32 v107, v34, v35
    v_cvt_pk_bf16_f32 v108, v10, v11
    v_cvt_pk_bf16_f32 v109, v12, v13
    v_cvt_pk_bf16_f32 v110, v36, v37
    v_cvt_pk_bf16_f32 v111, v38, v39
    s_nop 0
    v_mfma_f32_16x16x32_bf16 a[32:35], v[54:57], v[80:83], 0
    v_mfma_f32_16x16x32_bf16 a[36:39], v[54:57], v[84:87], 0
    v_mfma_f32_16x16x32_bf16 a[40:43], v[54:57], a[216:219], 0
    v_mfma_f32_16x16x32_bf16 a[44:47], v[58:61], v[80:83], 0
    v_mfma_f32_16x16x32_bf16 a[48:51], v[58:61], v[84:87], 0
    v_mfma_f32_16x16x32_bf16 a[52:55], v[58:61], a[216:219], 0
    v_mfma_f32_16x16x32_bf16 a[56:59], v[104:107], v[80:83], 0
    v_mfma_f32_16x16x32_bf16 a[60:63], v[104:107], v[84:87], 0
    v_mfma_f32_16x16x32_bf16 a[64:67], v[104:107], a[216:219], 0
    v_mfma_f32_16x16x32_bf16 a[68:71], v[108:111], v[80:83], 0
    v_mfma_f32_16x16x32_bf16 a[72:75], v[108:111], v[84:87], 0
    v_mfma_f32_16x16x32_bf16 a[76:79], v[108:111], a[216:219], 0
    v_cvt_pk_bf16_f32 v2, v120, v121
    v_cvt_pk_bf16_f32 v28, v144, v145
    v_cvt_pk_bf16_f32 v3, v122, v123
    v_cvt_pk_bf16_f32 v29, v146, v147
    v_cvt_pk_bf16_f32 v4, v124, v125
    v_cvt_pk_bf16_f32 v30, v148, v149
    v_cvt_pk_bf16_f32 v5, v126, v127
    v_cvt_pk_bf16_f32 v31, v150, v151
    s_nop 0
    v_mfma_f32_16x16x32_bf16 v[120:123], a[200:203], v[2:5], 0
    v_mfma_f32_16x16x32_bf16 v[144:147], a[200:203], v[28:31], 0
    v_mfma_f32_16x16x32_bf16 v[124:127], a[204:207], v[2:5], 0
    v_mfma_f32_16x16x32_bf16 v[148:151], a[204:207], v[28:31], 0
    s_nop 4
    v_max3_f32 v14, v120, v121, v122
    v_max3_f32 v40, v144, v145, v146
    v_min3_f32 v15, v120, v121, v122
    v_min3_f32 v41, v144, v145, v146
    v_max3_f32 v14, v14, v123, v124
    v_max3_f32 v40, v40, v147, v148
    v_min3_f32 v15, v15, v123, v124
    v_min3_f32 v41, v41, v147, v148
    v_max3_f32 v14, v14, v125, v126
    v_max3_f32 v40, v40, v149, v150
    v_min3_f32 v15, v15, v125, v126
    v_min3_f32 v41, v41, v149, v150
    v_max_f32 v14, v14, v127
    v_max_f32 v40, v40, v151
    v_max_f32 v15, -v15, -v127
    v_max_f32 v41, -v41, -v151
    s_nop 0
    v_permlane32_swap_b32 v14, v15
    v_permlane32_swap_b32 v40, v41
    v_max_f32 v14, v14, v15
    v_max_f32 v40, v40, v41
    v_mov_b32 v16, v14
    v_mov_b32 v42, v40
    s_nop 0
    v_permlane16_swap_b32 v14, v16
    v_permlane16_swap_b32 v40, v42
    v_max_f32 v14, v14, v16
    v_max_f32 v40, v40, v42
    v_mov_b32 v15, v14
    v_mov_b32 v41, v40
    s_nop 0
    v_permlane32_swap_b32 v14, v15
    v_permlane32_swap_b32 v40, v41
    v_pk_mul_f32 v[14:15], v[14:15], s[62:63]
    v_pk_mul_f32 v[40:41], v[40:41], s[62:63]
    v_pk_fma_f32 v[6:7], v[120:121], s[62:63], v[14:15] op_sel:[0,0,1] op_sel_hi:[1,1,1]
    v_pk_fma_f32 v[32:33], v[144:145], s[62:63], v[40:41] op_sel:[0,0,1] op_sel_hi:[1,1,1]
    v_pk_fma_f32 v[8:9], v[122:123], s[62:63], v[14:15] op_sel:[0,0,1] op_sel_hi:[1,1,1]
    v_pk_fma_f32 v[34:35], v[146:147], s[62:63], v[40:41] op_sel:[0,0,1] op_sel_hi:[1,1,1]
    v_pk_fma_f32 v[10:11], v[124:125], s[62:63], v[14:15] op_sel:[0,0,1] op_sel_hi:[1,1,1]
    v_pk_fma_f32 v[36:37], v[148:149], s[62:63], v[40:41] op_sel:[0,0,1] op_sel_hi:[1,1,1]
    v_pk_fma_f32 v[12:13], v[126:127], s[62:63], v[14:15] op_sel:[0,0,1] op_sel_hi:[1,1,1]
    v_pk_fma_f32 v[38:39], v[150:151], s[62:63], v[40:41] op_sel:[0,0,1] op_sel_hi:[1,1,1]
    v_pk_fma_f32 v[120:121], v[120:121], s[60:61], v[14:15] op_sel_hi:[1,1,0]
    v_pk_fma_f32 v[144:145], v[144:145], s[60:61], v[40:41] op_sel_hi:[1,1,0]
    v_pk_fma_f32 v[122:123], v[122:123], s[60:61], v[14:15] op_sel_hi:[1,1,0]
    v_pk_fma_f32 v[146:147], v[146:147], s[60:61], v[40:41] op_sel_hi:[1,1,0]
    v_pk_fma_f32 v[124:125], v[124:125], s[60:61], v[14:15] op_sel_hi:[1,1,0]
    v_pk_fma_f32 v[148:149], v[148:149], s[60:61], v[40:41] op_sel_hi:[1,1,0]
    v_pk_fma_f32 v[126:127], v[126:127], s[60:61], v[14:15] op_sel_hi:[1,1,0]
    v_pk_fma_f32 v[150:151], v[150:151], s[60:61], v[40:41] op_sel_hi:[1,1,0]
    v_exp_f32 v120, v120
    v_exp_f32 v144, v144
    v_exp_f32 v6, v6
    v_exp_f32 v32, v32
    v_exp_f32 v121, v121
    v_exp_f32 v145, v145
    v_exp_f32 v7, v7
    v_exp_f32 v33, v33
    v_exp_f32 v122, v122
    v_exp_f32 v146, v146
    v_exp_f32 v8, v8
    v_exp_f32 v34, v34
    v_exp_f32 v123, v123
    v_exp_f32 v147, v147
    v_exp_f32 v9, v9
    v_exp_f32 v35, v35
    v_exp_f32 v124, v124
    v_exp_f32 v148, v148
    v_exp_f32 v10, v10
    v_exp_f32 v36, v36
    v_exp_f32 v125, v125
    v_exp_f32 v149, v149
    v_exp_f32 v11, v11
    v_exp_f32 v37, v37
    v_exp_f32 v126, v126
    v_exp_f32 v150, v150
    v_exp_f32 v12, v12
    v_exp_f32 v38, v38
    v_exp_f32 v127, v127
    v_exp_f32 v151, v151
    v_exp_f32 v13, v13
    v_exp_f32 v39, v39
    v_pk_add_f32 v[16:17], v[120:121], v[122:123]
    v_pk_add_f32 v[42:43], v[144:145], v[146:147]
    v_pk_add_f32 v[18:19], v[6:7], v[8:9]
    v_pk_add_f32 v[44:45], v[32:33], v[34:35]
    v_pk_add_f32 v[16:17], v[16:17], v[124:125]
    v_pk_add_f32 v[42:43], v[42:43], v[148:149]
    v_pk_add_f32 v[18:19], v[18:19], v[10:11]
    v_pk_add_f32 v[44:45], v[44:45], v[36:37]
    v_pk_add_f32 v[16:17], v[16:17], v[126:127]
    v_pk_add_f32 v[42:43], v[42:43], v[150:151]
    v_pk_add_f32 v[18:19], v[18:19], v[12:13]
    v_pk_add_f32 v[44:45], v[44:45], v[38:39]
    v_add_f32 v14, v16, v17
    v_add_f32 v40, v42, v43
    v_add_f32 v15, v18, v19
    v_add_f32 v41, v44, v45
    s_nop 0
    v_permlane32_swap_b32 v14, v15
    v_permlane32_swap_b32 v40, v41
    v_add_f32 v14, v14, v15
    v_add_f32 v40, v40, v41
    v_mov_b32 v16, v14
    v_mov_b32 v42, v40
    s_nop 0
    v_permlane16_swap_b32 v14, v16
    v_permlane16_swap_b32 v40, v42
    v_add_f32 v14, v14, v16
    v_add_f32 v40, v40, v42
    v_mov_b32 v15, v14
    v_mov_b32 v41, v40
    s_nop 0
    v_permlane32_swap_b32 v14, v15
    v_permlane32_swap_b32 v40, v41
    v_rcp_f32 v14, v14
    v_rcp_f32 v40, v40
    v_rcp_f32 v15, v15
    v_rcp_f32 v41, v41
    v_pk_mul_f32 v[120:121], v[120:121], v[14:15] op_sel_hi:[1,0]
    v_pk_mul_f32 v[144:145], v[144:145], v[40:41] op_sel_hi:[1,0]
    v_pk_mul_f32 v[122:123], v[122:123], v[14:15] op_sel_hi:[1,0]
    v_pk_mul_f32 v[146:147], v[146:147], v[40:41] op_sel_hi:[1,0]
    v_pk_mul_f32 v[124:125], v[124:125], v[14:15] op_sel_hi:[1,0]
    v_pk_mul_f32 v[148:149], v[148:149], v[40:41] op_sel_hi:[1,0]
    v_pk_mul_f32 v[126:127], v[126:127], v[14:15] op_sel_hi:[1,0]
    v_pk_mul_f32 v[150:151], v[150:151], v[40:41] op_sel_hi:[1,0]
    v_pk_mul_f32 v[6:7], v[6:7], v[14:15] op_sel:[0,1] op_sel_hi:[1,1]
    v_pk_mul_f32 v[32:33], v[32:33], v[40:41] op_sel:[0,1] op_sel_hi:[1,1]
    v_pk_mul_f32 v[8:9], v[8:9], v[14:15] op_sel:[0,1] op_sel_hi:[1,1]
    v_pk_mul_f32 v[34:35], v[34:35], v[40:41] op_sel:[0,1] op_sel_hi:[1,1]
    v_pk_mul_f32 v[10:11], v[10:11], v[14:15] op_sel:[0,1] op_sel_hi:[1,1]
    v_pk_mul_f32 v[36:37], v[36:37], v[40:41] op_sel:[0,1] op_sel_hi:[1,1]
    v_pk_mul_f32 v[12:13], v[12:13], v[14:15] op_sel:[0,1] op_sel_hi:[1,1]
    v_pk_mul_f32 v[38:39], v[38:39], v[40:41] op_sel:[0,1] op_sel_hi:[1,1]
    v_cvt_pk_bf16_f32 v20, v120, v121
    v_cvt_pk_bf16_f32 v46, v144, v145
    v_cvt_pk_bf16_f32 v21, v122, v123
    v_cvt_pk_bf16_f32 v47, v146, v147
    v_cvt_pk_bf16_f32 v22, v124, v125
    v_cvt_pk_bf16_f32 v48, v148, v149
    v_cvt_pk_bf16_f32 v23, v126, v127
    v_cvt_pk_bf16_f32 v49, v150, v151
    v_cvt_pk_bf16_f32 v24, v6, v7
    v_cvt_pk_bf16_f32 v50, v32, v33
    v_cvt_pk_bf16_f32 v25, v8, v9
    v_cvt_pk_bf16_f32 v51, v34, v35
    v_cvt_pk_bf16_f32 v26, v10, v11
    v_cvt_pk_bf16_f32 v52, v36, v37
    v_cvt_pk_bf16_f32 v27, v12, v13
    v_cvt_pk_bf16_f32 v53, v38, v39
    s_nop 0
    v_mfma_f32_16x16x32_bf16 v[120:123], v[20:23], a[210:213], 0
    v_mfma_f32_16x16x32_bf16 v[124:127], v[20:23], a[208:211], 0
    v_mfma_f32_16x16x32_bf16 v[6:9], v[24:27], a[210:213], 0
    v_mfma_f32_16x16x32_bf16 v[10:13], v[24:27], a[208:211], 0
    v_mfma_f32_16x16x32_bf16 v[144:147], v[46:49], a[210:213], 0
    v_mfma_f32_16x16x32_bf16 v[148:151], v[46:49], a[208:211], 0
    v_mfma_f32_16x16x32_bf16 v[32:35], v[50:53], a[210:213], 0
    v_mfma_f32_16x16x32_bf16 v[36:39], v[50:53], a[208:211], 0
    v_cvt_pk_bf16_f32 v128, v128, v129
    v_cvt_pk_bf16_f32 v129, v130, v131
    v_cvt_pk_bf16_f32 v130, v152, v153
    v_cvt_pk_bf16_f32 v131, v154, v155
    v_cvt_pk_bf16_f32 v132, v132, v133
    v_cvt_pk_bf16_f32 v133, v134, v135
    v_cvt_pk_bf16_f32 v134, v156, v157
    v_cvt_pk_bf16_f32 v135, v158, v159
    v_cvt_pk_bf16_f32 v54, v120, v121
    v_cvt_pk_bf16_f32 v55, v122, v123
    v_cvt_pk_bf16_f32 v56, v144, v145
    v_cvt_pk_bf16_f32 v57, v146, v147
    v_cvt_pk_bf16_f32 v58, v124, v125
    v_cvt_pk_bf16_f32 v59, v126, v127
    v_cvt_pk_bf16_f32 v60, v148, v149
    v_cvt_pk_bf16_f32 v61, v150, v151
    v_cvt_pk_bf16_f32 v152, v6, v7
    v_cvt_pk_bf16_f32 v153, v8, v9
    v_cvt_pk_bf16_f32 v154, v32, v33
    v_cvt_pk_bf16_f32 v155, v34, v35
    v_cvt_pk_bf16_f32 v156, v10, v11
    v_cvt_pk_bf16_f32 v157, v12, v13
    v_cvt_pk_bf16_f32 v158, v36, v37
    v_cvt_pk_bf16_f32 v159, v38, v39
    s_nop 0
    v_mfma_f32_16x16x32_bf16 a[32:35], v[54:57], v[128:131], a[32:35]
    v_mfma_f32_16x16x32_bf16 a[36:39], v[54:57], v[132:135], a[36:39]
    v_mfma_f32_16x16x32_bf16 a[40:43], v[54:57], a[216:219], a[40:43]
    v_mfma_f32_16x16x32_bf16 a[44:47], v[58:61], v[128:131], a[44:47]
    v_mfma_f32_16x16x32_bf16 a[48:51], v[58:61], v[132:135], a[48:51]
    v_mfma_f32_16x16x32_bf16 a[52:55], v[58:61], a[216:219], a[52:55]
    v_mfma_f32_16x16x32_bf16 a[56:59], v[152:155], v[128:131], a[56:59]
    v_mfma_f32_16x16x32_bf16 a[60:63], v[152:155], v[132:135], a[60:63]
    v_mfma_f32_16x16x32_bf16 a[64:67], v[152:155], a[216:219], a[64:67]
    v_mfma_f32_16x16x32_bf16 a[68:71], v[156:159], v[128:131], a[68:71]
    v_mfma_f32_16x16x32_bf16 a[72:75], v[156:159], v[132:135], a[72:75]
    v_mfma_f32_16x16x32_bf16 a[76:79], v[156:159], a[216:219], a[76:79]
    v_cvt_pk_bf16_f32 v2, v168, v169
    v_cvt_pk_bf16_f32 v28, v192, v193
    v_cvt_pk_bf16_f32 v3, v170, v171
    v_cvt_pk_bf16_f32 v29, v194, v195
    v_cvt_pk_bf16_f32 v4, v172, v173
    v_cvt_pk_bf16_f32 v30, v196, v197
    v_cvt_pk_bf16_f32 v5, v174, v175
    v_cvt_pk_bf16_f32 v31, v198, v199
    s_nop 0
    v_mfma_f32_16x16x32_bf16 v[168:171], a[200:203], v[2:5], 0
    v_mfma_f32_16x16x32_bf16 v[192:195], a[200:203], v[28:31], 0
    v_mfma_f32_16x16x32_bf16 v[172:175], a[204:207], v[2:5], 0
    v_mfma_f32_16x16x32_bf16 v[196:199], a[204:207], v[28:31], 0
    s_nop 4
    v_max3_f32 v14, v168, v169, v170
    v_max3_f32 v40, v192, v193, v194
    v_min3_f32 v15, v168, v169, v170
    v_min3_f32 v41, v192, v193, v194
    v_max3_f32 v14, v14, v171, v172
    v_max3_f32 v40, v40, v195, v196
    v_min3_f32 v15, v15, v171, v172
    v_min3_f32 v41, v41, v195, v196
    v_max3_f32 v14, v14, v173, v174
    v_max3_f32 v40, v40, v197, v198
    v_min3_f32 v15, v15, v173, v174
    v_min3_f32 v41, v41, v197, v198
    v_max_f32 v14, v14, v175
    v_max_f32 v40, v40, v199
    v_max_f32 v15, -v15, -v175
    v_max_f32 v41, -v41, -v199
    s_nop 0
    v_permlane32_swap_b32 v14, v15
    v_permlane32_swap_b32 v40, v41
    v_max_f32 v14, v14, v15
    v_max_f32 v40, v40, v41
    v_mov_b32 v16, v14
    v_mov_b32 v42, v40
    s_nop 0
    v_permlane16_swap_b32 v14, v16
    v_permlane16_swap_b32 v40, v42
    v_max_f32 v14, v14, v16
    v_max_f32 v40, v40, v42
    v_mov_b32 v15, v14
    v_mov_b32 v41, v40
    s_nop 0
    v_permlane32_swap_b32 v14, v15
    v_permlane32_swap_b32 v40, v41
    v_pk_mul_f32 v[14:15], v[14:15], s[62:63]
    v_pk_mul_f32 v[40:41], v[40:41], s[62:63]
    v_pk_fma_f32 v[6:7], v[168:169], s[62:63], v[14:15] op_sel:[0,0,1] op_sel_hi:[1,1,1]
    v_pk_fma_f32 v[32:33], v[192:193], s[62:63], v[40:41] op_sel:[0,0,1] op_sel_hi:[1,1,1]
    v_pk_fma_f32 v[8:9], v[170:171], s[62:63], v[14:15] op_sel:[0,0,1] op_sel_hi:[1,1,1]
    v_pk_fma_f32 v[34:35], v[194:195], s[62:63], v[40:41] op_sel:[0,0,1] op_sel_hi:[1,1,1]
    v_pk_fma_f32 v[10:11], v[172:173], s[62:63], v[14:15] op_sel:[0,0,1] op_sel_hi:[1,1,1]
    v_pk_fma_f32 v[36:37], v[196:197], s[62:63], v[40:41] op_sel:[0,0,1] op_sel_hi:[1,1,1]
    v_pk_fma_f32 v[12:13], v[174:175], s[62:63], v[14:15] op_sel:[0,0,1] op_sel_hi:[1,1,1]
    v_pk_fma_f32 v[38:39], v[198:199], s[62:63], v[40:41] op_sel:[0,0,1] op_sel_hi:[1,1,1]
    v_pk_fma_f32 v[168:169], v[168:169], s[60:61], v[14:15] op_sel_hi:[1,1,0]
    v_pk_fma_f32 v[192:193], v[192:193], s[60:61], v[40:41] op_sel_hi:[1,1,0]
    v_pk_fma_f32 v[170:171], v[170:171], s[60:61], v[14:15] op_sel_hi:[1,1,0]
    v_pk_fma_f32 v[194:195], v[194:195], s[60:61], v[40:41] op_sel_hi:[1,1,0]
    v_pk_fma_f32 v[172:173], v[172:173], s[60:61], v[14:15] op_sel_hi:[1,1,0]
    v_pk_fma_f32 v[196:197], v[196:197], s[60:61], v[40:41] op_sel_hi:[1,1,0]
    v_pk_fma_f32 v[174:175], v[174:175], s[60:61], v[14:15] op_sel_hi:[1,1,0]
    v_pk_fma_f32 v[198:199], v[198:199], s[60:61], v[40:41] op_sel_hi:[1,1,0]
    v_exp_f32 v168, v168
    v_exp_f32 v192, v192
    v_exp_f32 v6, v6
    v_exp_f32 v32, v32
    v_exp_f32 v169, v169
    v_exp_f32 v193, v193
    v_exp_f32 v7, v7
    v_exp_f32 v33, v33
    v_exp_f32 v170, v170
    v_exp_f32 v194, v194
    v_exp_f32 v8, v8
    v_exp_f32 v34, v34
    v_exp_f32 v171, v171
    v_exp_f32 v195, v195
    v_exp_f32 v9, v9
    v_exp_f32 v35, v35
    v_exp_f32 v172, v172
    v_exp_f32 v196, v196
    v_exp_f32 v10, v10
    v_exp_f32 v36, v36
    v_exp_f32 v173, v173
    v_exp_f32 v197, v197
    v_exp_f32 v11, v11
    v_exp_f32 v37, v37
    v_exp_f32 v174, v174
    v_exp_f32 v198, v198
    v_exp_f32 v12, v12
    v_exp_f32 v38, v38
    v_exp_f32 v175, v175
    v_exp_f32 v199, v199
    v_exp_f32 v13, v13
    v_exp_f32 v39, v39
    v_pk_add_f32 v[16:17], v[168:169], v[170:171]
    v_pk_add_f32 v[42:43], v[192:193], v[194:195]
    v_pk_add_f32 v[18:19], v[6:7], v[8:9]
    v_pk_add_f32 v[44:45], v[32:33], v[34:35]
    v_pk_add_f32 v[16:17], v[16:17], v[172:173]
    v_pk_add_f32 v[42:43], v[42:43], v[196:197]
    v_pk_add_f32 v[18:19], v[18:19], v[10:11]
    v_pk_add_f32 v[44:45], v[44:45], v[36:37]
    v_pk_add_f32 v[16:17], v[16:17], v[174:175]
    v_pk_add_f32 v[42:43], v[42:43], v[198:199]
    v_pk_add_f32 v[18:19], v[18:19], v[12:13]
    v_pk_add_f32 v[44:45], v[44:45], v[38:39]
    v_add_f32 v14, v16, v17
    v_add_f32 v40, v42, v43
    v_add_f32 v15, v18, v19
    v_add_f32 v41, v44, v45
    s_nop 0
    v_permlane32_swap_b32 v14, v15
    v_permlane32_swap_b32 v40, v41
    v_add_f32 v14, v14, v15
    v_add_f32 v40, v40, v41
    v_mov_b32 v16, v14
    v_mov_b32 v42, v40
    s_nop 0
    v_permlane16_swap_b32 v14, v16
    v_permlane16_swap_b32 v40, v42
    v_add_f32 v14, v14, v16
    v_add_f32 v40, v40, v42
    v_mov_b32 v15, v14
    v_mov_b32 v41, v40
    s_nop 0
    v_permlane32_swap_b32 v14, v15
    v_permlane32_swap_b32 v40, v41
    v_rcp_f32 v14, v14
    v_rcp_f32 v40, v40
    v_rcp_f32 v15, v15
    v_rcp_f32 v41, v41
    v_pk_mul_f32 v[168:169], v[168:169], v[14:15] op_sel_hi:[1,0]
    v_pk_mul_f32 v[192:193], v[192:193], v[40:41] op_sel_hi:[1,0]
    v_pk_mul_f32 v[170:171], v[170:171], v[14:15] op_sel_hi:[1,0]
    v_pk_mul_f32 v[194:195], v[194:195], v[40:41] op_sel_hi:[1,0]
    v_pk_mul_f32 v[172:173], v[172:173], v[14:15] op_sel_hi:[1,0]
    v_pk_mul_f32 v[196:197], v[196:197], v[40:41] op_sel_hi:[1,0]
    v_pk_mul_f32 v[174:175], v[174:175], v[14:15] op_sel_hi:[1,0]
    v_pk_mul_f32 v[198:199], v[198:199], v[40:41] op_sel_hi:[1,0]
    v_pk_mul_f32 v[6:7], v[6:7], v[14:15] op_sel:[0,1] op_sel_hi:[1,1]
    v_pk_mul_f32 v[32:33], v[32:33], v[40:41] op_sel:[0,1] op_sel_hi:[1,1]
    v_pk_mul_f32 v[8:9], v[8:9], v[14:15] op_sel:[0,1] op_sel_hi:[1,1]
    v_pk_mul_f32 v[34:35], v[34:35], v[40:41] op_sel:[0,1] op_sel_hi:[1,1]
    v_pk_mul_f32 v[10:11], v[10:11], v[14:15] op_sel:[0,1] op_sel_hi:[1,1]
    v_pk_mul_f32 v[36:37], v[36:37], v[40:41] op_sel:[0,1] op_sel_hi:[1,1]
    v_pk_mul_f32 v[12:13], v[12:13], v[14:15] op_sel:[0,1] op_sel_hi:[1,1]
    v_pk_mul_f32 v[38:39], v[38:39], v[40:41] op_sel:[0,1] op_sel_hi:[1,1]
    v_cvt_pk_bf16_f32 v20, v168, v169
    v_cvt_pk_bf16_f32 v46, v192, v193
    v_cvt_pk_bf16_f32 v21, v170, v171
    v_cvt_pk_bf16_f32 v47, v194, v195
    v_cvt_pk_bf16_f32 v22, v172, v173
    v_cvt_pk_bf16_f32 v48, v196, v197
    v_cvt_pk_bf16_f32 v23, v174, v175
    v_cvt_pk_bf16_f32 v49, v198, v199
    v_cvt_pk_bf16_f32 v24, v6, v7
    v_cvt_pk_bf16_f32 v50, v32, v33
    v_cvt_pk_bf16_f32 v25, v8, v9
    v_cvt_pk_bf16_f32 v51, v34, v35
    v_cvt_pk_bf16_f32 v26, v10, v11
    v_cvt_pk_bf16_f32 v52, v36, v37
    v_cvt_pk_bf16_f32 v27, v12, v13
    v_cvt_pk_bf16_f32 v53, v38, v39
    s_nop 0
    v_mfma_f32_16x16x32_bf16 v[168:171], v[20:23], a[210:213], 0
    v_mfma_f32_16x16x32_bf16 v[172:175], v[20:23], a[208:211], 0
    v_mfma_f32_16x16x32_bf16 v[6:9], v[24:27], a[210:213], 0
    v_mfma_f32_16x16x32_bf16 v[10:13], v[24:27], a[208:211], 0
    v_mfma_f32_16x16x32_bf16 v[192:195], v[46:49], a[210:213], 0
    v_mfma_f32_16x16x32_bf16 v[196:199], v[46:49], a[208:211], 0
    v_mfma_f32_16x16x32_bf16 v[32:35], v[50:53], a[210:213], 0
    v_mfma_f32_16x16x32_bf16 v[36:39], v[50:53], a[208:211], 0
    v_cvt_pk_bf16_f32 v176, v176, v177
    v_cvt_pk_bf16_f32 v177, v178, v179
    v_cvt_pk_bf16_f32 v178, v200, v201
    v_cvt_pk_bf16_f32 v179, v202, v203
    v_cvt_pk_bf16_f32 v180, v180, v181
    v_cvt_pk_bf16_f32 v181, v182, v183
    v_cvt_pk_bf16_f32 v182, v204, v205
    v_cvt_pk_bf16_f32 v183, v206, v207
    v_cvt_pk_bf16_f32 v54, v168, v169
    v_cvt_pk_bf16_f32 v55, v170, v171
    v_cvt_pk_bf16_f32 v56, v192, v193
    v_cvt_pk_bf16_f32 v57, v194, v195
    v_cvt_pk_bf16_f32 v58, v172, v173
    v_cvt_pk_bf16_f32 v59, v174, v175
    v_cvt_pk_bf16_f32 v60, v196, v197
    v_cvt_pk_bf16_f32 v61, v198, v199
    v_cvt_pk_bf16_f32 v200, v6, v7
    v_cvt_pk_bf16_f32 v201, v8, v9
    v_cvt_pk_bf16_f32 v202, v32, v33
    v_cvt_pk_bf16_f32 v203, v34, v35
    v_cvt_pk_bf16_f32 v204, v10, v11
    v_cvt_pk_bf16_f32 v205, v12, v13
    v_cvt_pk_bf16_f32 v206, v36, v37
    v_cvt_pk_bf16_f32 v207, v38, v39
    s_nop 0
    v_mfma_f32_16x16x32_bf16 a[32:35], v[54:57], v[176:179], a[32:35]
    v_mfma_f32_16x16x32_bf16 a[36:39], v[54:57], v[180:183], a[36:39]
    v_mfma_f32_16x16x32_bf16 a[40:43], v[54:57], a[216:219], a[40:43]
    v_mfma_f32_16x16x32_bf16 a[44:47], v[58:61], v[176:179], a[44:47]
    v_mfma_f32_16x16x32_bf16 a[48:51], v[58:61], v[180:183], a[48:51]
    v_mfma_f32_16x16x32_bf16 a[52:55], v[58:61], a[216:219], a[52:55]
    v_mfma_f32_16x16x32_bf16 a[56:59], v[200:203], v[176:179], a[56:59]
    v_mfma_f32_16x16x32_bf16 a[60:63], v[200:203], v[180:183], a[60:63]
    v_mfma_f32_16x16x32_bf16 a[64:67], v[200:203], a[216:219], a[64:67]
    v_mfma_f32_16x16x32_bf16 a[68:71], v[204:207], v[176:179], a[68:71]
    v_mfma_f32_16x16x32_bf16 a[72:75], v[204:207], v[180:183], a[72:75]
    v_mfma_f32_16x16x32_bf16 a[76:79], v[204:207], a[216:219], a[76:79]
    v_cvt_pk_bf16_f32 v2, v216, v217
    v_cvt_pk_bf16_f32 v28, v240, v241
    v_cvt_pk_bf16_f32 v3, v218, v219
    v_cvt_pk_bf16_f32 v29, v242, v243
    v_cvt_pk_bf16_f32 v4, v220, v221
    v_cvt_pk_bf16_f32 v30, v244, v245
    v_cvt_pk_bf16_f32 v5, v222, v223
    v_cvt_pk_bf16_f32 v31, v246, v247
    s_nop 0
    v_mfma_f32_16x16x32_bf16 v[216:219], a[200:203], v[2:5], 0
    v_mfma_f32_16x16x32_bf16 v[240:243], a[200:203], v[28:31], 0
    v_mfma_f32_16x16x32_bf16 v[220:223], a[204:207], v[2:5], 0
    v_mfma_f32_16x16x32_bf16 v[244:247], a[204:207], v[28:31], 0
    s_nop 4
    v_max3_f32 v14, v216, v217, v218
    v_max3_f32 v40, v240, v241, v242
    v_min3_f32 v15, v216, v217, v218
    v_min3_f32 v41, v240, v241, v242
    v_max3_f32 v14, v14, v219, v220
    v_max3_f32 v40, v40, v243, v244
    v_min3_f32 v15, v15, v219, v220
    v_min3_f32 v41, v41, v243, v244
    v_max3_f32 v14, v14, v221, v222
    v_max3_f32 v40, v40, v245, v246
    v_min3_f32 v15, v15, v221, v222
    v_min3_f32 v41, v41, v245, v246
    v_max_f32 v14, v14, v223
    v_max_f32 v40, v40, v247
    v_max_f32 v15, -v15, -v223
    v_max_f32 v41, -v41, -v247
    s_nop 0
    v_permlane32_swap_b32 v14, v15
    v_permlane32_swap_b32 v40, v41
    v_max_f32 v14, v14, v15
    v_max_f32 v40, v40, v41
    v_mov_b32 v16, v14
    v_mov_b32 v42, v40
    s_nop 0
    v_permlane16_swap_b32 v14, v16
    v_permlane16_swap_b32 v40, v42
    v_max_f32 v14, v14, v16
    v_max_f32 v40, v40, v42
    v_mov_b32 v15, v14
    v_mov_b32 v41, v40
    s_nop 0
    v_permlane32_swap_b32 v14, v15
    v_permlane32_swap_b32 v40, v41
    v_pk_mul_f32 v[14:15], v[14:15], s[62:63]
    v_pk_mul_f32 v[40:41], v[40:41], s[62:63]
    v_pk_fma_f32 v[6:7], v[216:217], s[62:63], v[14:15] op_sel:[0,0,1] op_sel_hi:[1,1,1]
    v_pk_fma_f32 v[32:33], v[240:241], s[62:63], v[40:41] op_sel:[0,0,1] op_sel_hi:[1,1,1]
    v_pk_fma_f32 v[8:9], v[218:219], s[62:63], v[14:15] op_sel:[0,0,1] op_sel_hi:[1,1,1]
    v_pk_fma_f32 v[34:35], v[242:243], s[62:63], v[40:41] op_sel:[0,0,1] op_sel_hi:[1,1,1]
    v_pk_fma_f32 v[10:11], v[220:221], s[62:63], v[14:15] op_sel:[0,0,1] op_sel_hi:[1,1,1]
    v_pk_fma_f32 v[36:37], v[244:245], s[62:63], v[40:41] op_sel:[0,0,1] op_sel_hi:[1,1,1]
    v_pk_fma_f32 v[12:13], v[222:223], s[62:63], v[14:15] op_sel:[0,0,1] op_sel_hi:[1,1,1]
    v_pk_fma_f32 v[38:39], v[246:247], s[62:63], v[40:41] op_sel:[0,0,1] op_sel_hi:[1,1,1]
    v_pk_fma_f32 v[216:217], v[216:217], s[60:61], v[14:15] op_sel_hi:[1,1,0]
    v_pk_fma_f32 v[240:241], v[240:241], s[60:61], v[40:41] op_sel_hi:[1,1,0]
    v_pk_fma_f32 v[218:219], v[218:219], s[60:61], v[14:15] op_sel_hi:[1,1,0]
    v_pk_fma_f32 v[242:243], v[242:243], s[60:61], v[40:41] op_sel_hi:[1,1,0]
    v_pk_fma_f32 v[220:221], v[220:221], s[60:61], v[14:15] op_sel_hi:[1,1,0]
    v_pk_fma_f32 v[244:245], v[244:245], s[60:61], v[40:41] op_sel_hi:[1,1,0]
    v_pk_fma_f32 v[222:223], v[222:223], s[60:61], v[14:15] op_sel_hi:[1,1,0]
    v_pk_fma_f32 v[246:247], v[246:247], s[60:61], v[40:41] op_sel_hi:[1,1,0]
    v_exp_f32 v216, v216
    v_exp_f32 v240, v240
    v_exp_f32 v6, v6
    v_exp_f32 v32, v32
    v_exp_f32 v217, v217
    v_exp_f32 v241, v241
    v_exp_f32 v7, v7
    v_exp_f32 v33, v33
    v_exp_f32 v218, v218
    v_exp_f32 v242, v242
    v_exp_f32 v8, v8
    v_exp_f32 v34, v34
    v_exp_f32 v219, v219
    v_exp_f32 v243, v243
    v_exp_f32 v9, v9
    v_exp_f32 v35, v35
    v_exp_f32 v220, v220
    v_exp_f32 v244, v244
    v_exp_f32 v10, v10
    v_exp_f32 v36, v36
    v_exp_f32 v221, v221
    v_exp_f32 v245, v245
    v_exp_f32 v11, v11
    v_exp_f32 v37, v37
    v_exp_f32 v222, v222
    v_exp_f32 v246, v246
    v_exp_f32 v12, v12
    v_exp_f32 v38, v38
    v_exp_f32 v223, v223
    v_exp_f32 v247, v247
    v_exp_f32 v13, v13
    v_exp_f32 v39, v39
    v_pk_add_f32 v[16:17], v[216:217], v[218:219]
    v_pk_add_f32 v[42:43], v[240:241], v[242:243]
    v_pk_add_f32 v[18:19], v[6:7], v[8:9]
    v_pk_add_f32 v[44:45], v[32:33], v[34:35]
    v_pk_add_f32 v[16:17], v[16:17], v[220:221]
    v_pk_add_f32 v[42:43], v[42:43], v[244:245]
    v_pk_add_f32 v[18:19], v[18:19], v[10:11]
    v_pk_add_f32 v[44:45], v[44:45], v[36:37]
    v_pk_add_f32 v[16:17], v[16:17], v[222:223]
    v_pk_add_f32 v[42:43], v[42:43], v[246:247]
    v_pk_add_f32 v[18:19], v[18:19], v[12:13]
    v_pk_add_f32 v[44:45], v[44:45], v[38:39]
    v_add_f32 v14, v16, v17
    v_add_f32 v40, v42, v43
    v_add_f32 v15, v18, v19
    v_add_f32 v41, v44, v45
    s_nop 0
    v_permlane32_swap_b32 v14, v15
    v_permlane32_swap_b32 v40, v41
    v_add_f32 v14, v14, v15
    v_add_f32 v40, v40, v41
    v_mov_b32 v16, v14
    v_mov_b32 v42, v40
    s_nop 0
    v_permlane16_swap_b32 v14, v16
    v_permlane16_swap_b32 v40, v42
    v_add_f32 v14, v14, v16
    v_add_f32 v40, v40, v42
    v_mov_b32 v15, v14
    v_mov_b32 v41, v40
    s_nop 0
    v_permlane32_swap_b32 v14, v15
    v_permlane32_swap_b32 v40, v41
    v_rcp_f32 v14, v14
    v_rcp_f32 v40, v40
    v_rcp_f32 v15, v15
    v_rcp_f32 v41, v41
    v_pk_mul_f32 v[216:217], v[216:217], v[14:15] op_sel_hi:[1,0]
    v_pk_mul_f32 v[240:241], v[240:241], v[40:41] op_sel_hi:[1,0]
    v_pk_mul_f32 v[218:219], v[218:219], v[14:15] op_sel_hi:[1,0]
    v_pk_mul_f32 v[242:243], v[242:243], v[40:41] op_sel_hi:[1,0]
    v_pk_mul_f32 v[220:221], v[220:221], v[14:15] op_sel_hi:[1,0]
    v_pk_mul_f32 v[244:245], v[244:245], v[40:41] op_sel_hi:[1,0]
    v_pk_mul_f32 v[222:223], v[222:223], v[14:15] op_sel_hi:[1,0]
    v_pk_mul_f32 v[246:247], v[246:247], v[40:41] op_sel_hi:[1,0]
    v_pk_mul_f32 v[6:7], v[6:7], v[14:15] op_sel:[0,1] op_sel_hi:[1,1]
    v_pk_mul_f32 v[32:33], v[32:33], v[40:41] op_sel:[0,1] op_sel_hi:[1,1]
    v_pk_mul_f32 v[8:9], v[8:9], v[14:15] op_sel:[0,1] op_sel_hi:[1,1]
    v_pk_mul_f32 v[34:35], v[34:35], v[40:41] op_sel:[0,1] op_sel_hi:[1,1]
    v_pk_mul_f32 v[10:11], v[10:11], v[14:15] op_sel:[0,1] op_sel_hi:[1,1]
    v_pk_mul_f32 v[36:37], v[36:37], v[40:41] op_sel:[0,1] op_sel_hi:[1,1]
    v_pk_mul_f32 v[12:13], v[12:13], v[14:15] op_sel:[0,1] op_sel_hi:[1,1]
    v_pk_mul_f32 v[38:39], v[38:39], v[40:41] op_sel:[0,1] op_sel_hi:[1,1]
    v_cvt_pk_bf16_f32 v20, v216, v217
    v_cvt_pk_bf16_f32 v46, v240, v241
    v_cvt_pk_bf16_f32 v21, v218, v219
    v_cvt_pk_bf16_f32 v47, v242, v243
    v_cvt_pk_bf16_f32 v22, v220, v221
    v_cvt_pk_bf16_f32 v48, v244, v245
    v_cvt_pk_bf16_f32 v23, v222, v223
    v_cvt_pk_bf16_f32 v49, v246, v247
    v_cvt_pk_bf16_f32 v24, v6, v7
    v_cvt_pk_bf16_f32 v50, v32, v33
    v_cvt_pk_bf16_f32 v25, v8, v9
    v_cvt_pk_bf16_f32 v51, v34, v35
    v_cvt_pk_bf16_f32 v26, v10, v11
    v_cvt_pk_bf16_f32 v52, v36, v37
    v_cvt_pk_bf16_f32 v27, v12, v13
    v_cvt_pk_bf16_f32 v53, v38, v39
    s_nop 0
    v_mfma_f32_16x16x32_bf16 v[216:219], v[20:23], a[210:213], 0
    v_mfma_f32_16x16x32_bf16 v[220:223], v[20:23], a[208:211], 0
    v_mfma_f32_16x16x32_bf16 v[6:9], v[24:27], a[210:213], 0
    v_mfma_f32_16x16x32_bf16 v[10:13], v[24:27], a[208:211], 0
    v_mfma_f32_16x16x32_bf16 v[240:243], v[46:49], a[210:213], 0
    v_mfma_f32_16x16x32_bf16 v[244:247], v[46:49], a[208:211], 0
    v_mfma_f32_16x16x32_bf16 v[32:35], v[50:53], a[210:213], 0
    v_mfma_f32_16x16x32_bf16 v[36:39], v[50:53], a[208:211], 0
    v_cvt_pk_bf16_f32 v224, v224, v225
    v_cvt_pk_bf16_f32 v225, v226, v227
    v_cvt_pk_bf16_f32 v226, v248, v249
    v_cvt_pk_bf16_f32 v227, v250, v251
    v_cvt_pk_bf16_f32 v228, v228, v229
    v_cvt_pk_bf16_f32 v229, v230, v231
    v_cvt_pk_bf16_f32 v230, v252, v253
    v_cvt_pk_bf16_f32 v231, v254, v255
    v_cvt_pk_bf16_f32 v54, v216, v217
    v_cvt_pk_bf16_f32 v55, v218, v219
    v_cvt_pk_bf16_f32 v56, v240, v241
    v_cvt_pk_bf16_f32 v57, v242, v243
    v_cvt_pk_bf16_f32 v58, v220, v221
    v_cvt_pk_bf16_f32 v59, v222, v223
    v_cvt_pk_bf16_f32 v60, v244, v245
    v_cvt_pk_bf16_f32 v61, v246, v247
    v_cvt_pk_bf16_f32 v248, v6, v7
    v_cvt_pk_bf16_f32 v249, v8, v9
    v_cvt_pk_bf16_f32 v250, v32, v33
    v_cvt_pk_bf16_f32 v251, v34, v35
    v_cvt_pk_bf16_f32 v252, v10, v11
    v_cvt_pk_bf16_f32 v253, v12, v13
    v_cvt_pk_bf16_f32 v254, v36, v37
    v_cvt_pk_bf16_f32 v255, v38, v39
    s_nop 0
    v_mfma_f32_16x16x32_bf16 a[32:35], v[54:57], v[224:227], a[32:35]
    v_mfma_f32_16x16x32_bf16 a[36:39], v[54:57], v[228:231], a[36:39]
    v_mfma_f32_16x16x32_bf16 a[40:43], v[54:57], a[216:219], a[40:43]
    v_mfma_f32_16x16x32_bf16 a[44:47], v[58:61], v[224:227], a[44:47]
    v_mfma_f32_16x16x32_bf16 a[48:51], v[58:61], v[228:231], a[48:51]
    v_mfma_f32_16x16x32_bf16 a[52:55], v[58:61], a[216:219], a[52:55]
    v_mfma_f32_16x16x32_bf16 a[56:59], v[248:251], v[224:227], a[56:59]
    v_mfma_f32_16x16x32_bf16 a[60:63], v[248:251], v[228:231], a[60:63]
    v_mfma_f32_16x16x32_bf16 a[64:67], v[248:251], a[216:219], a[64:67]
    v_mfma_f32_16x16x32_bf16 a[68:71], v[252:255], v[224:227], a[68:71]
    v_mfma_f32_16x16x32_bf16 a[72:75], v[252:255], v[228:231], a[72:75]
    v_mfma_f32_16x16x32_bf16 a[76:79], v[252:255], a[216:219], a[76:79]
    v_lshlrev_b32 v2, 4, v1
    s_lshl_b32 s44, s34, 1
    s_add_u32 s45, s44, s33
    s_xor_b32 s44, s45, 1
    s_mul_i32 s44, s44, 6144
    s_mul_i32 s45, s45, 6144
    v_add_u32 v3, s44, v2
    v_add_u32 v4, s45, v2
    s_nop 7
    s_cmp_eq_u32 s33, 0
    s_cbranch_scc1 kvp_26_0
    ds_write_b128 v3, a[32:35] offset:0
    ds_write_b128 v3, a[36:39] offset:1024
    ds_write_b128 v3, a[40:43] offset:2048
    ds_write_b128 v3, a[44:47] offset:3072
    ds_write_b128 v3, a[48:51] offset:4096
    ds_write_b128 v3, a[52:55] offset:5120
    v_accvgpr_read_b32 v8, a56
    v_accvgpr_read_b32 v9, a57
    v_accvgpr_read_b32 v10, a58
    v_accvgpr_read_b32 v11, a59
    v_accvgpr_read_b32 v12, a60
    v_accvgpr_read_b32 v13, a61
    v_accvgpr_read_b32 v14, a62
    v_accvgpr_read_b32 v15, a63
    v_accvgpr_read_b32 v16, a64
    v_accvgpr_read_b32 v17, a65
    v_accvgpr_read_b32 v18, a66
    v_accvgpr_read_b32 v19, a67
    v_accvgpr_read_b32 v20, a68
    v_accvgpr_read_b32 v21, a69
    v_accvgpr_read_b32 v22, a70
    v_accvgpr_read_b32 v23, a71
    v_accvgpr_read_b32 v24, a72
    v_accvgpr_read_b32 v25, a73
    v_accvgpr_read_b32 v26, a74
    v_accvgpr_read_b32 v27, a75
    v_accvgpr_read_b32 v28, a76
    v_accvgpr_read_b32 v29, a77
    v_accvgpr_read_b32 v30, a78
    v_accvgpr_read_b32 v31, a79
    s_branch kvp_26_1
kvp_26_0:
    ds_write_b128 v3, a[56:59] offset:0
    ds_write_b128 v3, a[60:63] offset:1024
    ds_write_b128 v3, a[64:67] offset:2048
    ds_write_b128 v3, a[68:71] offset:3072
    ds_write_b128 v3, a[72:75] offset:4096
    ds_write_b128 v3, a[76:79] offset:5120
    v_accvgpr_read_b32 v8, a32
    v_accvgpr_read_b32 v9, a33
    v_accvgpr_read_b32 v10, a34
    v_accvgpr_read_b32 v11, a35
    v_accvgpr_read_b32 v12, a36
    v_accvgpr_read_b32 v13, a37
    v_accvgpr_read_b32 v14, a38
    v_accvgpr_read_b32 v15, a39
    v_accvgpr_read_b32 v16, a40
    v_accvgpr_read_b32 v17, a41
    v_accvgpr_read_b32 v18, a42
    v_accvgpr_read_b32 v19, a43
    v_accvgpr_read_b32 v20, a44
    v_accvgpr_read_b32 v21, a45
    v_accvgpr_read_b32 v22, a46
    v_accvgpr_read_b32 v23, a47
    v_accvgpr_read_b32 v24, a48
    v_accvgpr_read_b32 v25, a49
    v_accvgpr_read_b32 v26, a50
    v_accvgpr_read_b32 v27, a51
    v_accvgpr_read_b32 v28, a52
    v_accvgpr_read_b32 v29, a53
    v_accvgpr_read_b32 v30, a54
    v_accvgpr_read_b32 v31, a55
kvp_26_1:
    s_waitcnt lgkmcnt(0)
    s_barrier
    ds_read_b128 v[32:35], v4 offset:0
    ds_read_b128 v[36:39], v4 offset:1024
    ds_read_b128 v[40:43], v4 offset:2048
    ds_read_b128 v[44:47], v4 offset:3072
    ds_read_b128 v[48:51], v4 offset:4096
    ds_read_b128 v[52:55], v4 offset:5120
    s_lshl_b32 s44, s36, 1
    s_add_u32 s44, s44, s34
    s_lshl_b32 s44, s44, 3
    s_add_u32 s44, s44, s35
    s_lshl_b32 s44, s44, 1
    s_add_u32 s44, s44, s33
    s_mul_i32 s44, s44, 2176
    s_add_u32 s44, s44, 24117248
    s_add_u32 s56, s52, s44
    s_addc_u32 s57, s53, 0
    s_mov_b32 s58, 2176
    s_mov_b32 s59, 0x20000
    v_lshrrev_b32 v5, 4, v1
    v_lshlrev_b32 v5, 4, v5
    v_add_u32 v5, 2048, v5
    v_and_b32 v6, 15, v1
    v_cmp_eq_u32 vcc, 0, v6
    v_mov_b32 v6, 0x7ffffff0
    s_nop 0
    v_cndmask_b32 v5, v6, v5, vcc
    s_waitcnt lgkmcnt(0)
    v_pk_add_f32 v[8:9], v[8:9], v[32:33]
    v_pk_add_f32 v[10:11], v[10:11], v[34:35]
    v_pk_add_f32 v[12:13], v[12:13], v[36:37]
    v_pk_add_f32 v[14:15], v[14:15], v[38:39]
    v_pk_add_f32 v[16:17], v[16:17], v[40:41]
    v_pk_add_f32 v[18:19], v[18:19], v[42:43]
    v_pk_add_f32 v[20:21], v[20:21], v[44:45]
    v_pk_add_f32 v[22:23], v[22:23], v[46:47]
    v_pk_add_f32 v[24:25], v[24:25], v[48:49]
    v_pk_add_f32 v[26:27], v[26:27], v[50:51]
    v_pk_add_f32 v[28:29], v[28:29], v[52:53]
    v_pk_add_f32 v[30:31], v[30:31], v[54:55]
    v_cvt_pk_bf16_f32 v32, v8, v9
    v_cvt_pk_bf16_f32 v33, v10, v11
    v_cvt_pk_bf16_f32 v34, v20, v21
    v_cvt_pk_bf16_f32 v35, v22, v23
    v_cvt_pk_bf16_f32 v36, v12, v13
    v_cvt_pk_bf16_f32 v37, v14, v15
    v_cvt_pk_bf16_f32 v38, v24, v25
    v_cvt_pk_bf16_f32 v39, v26, v27
    v_cvt_pk_bf16_f32 v40, v16, v17
    v_cvt_pk_bf16_f32 v41, v18, v19
    v_cvt_pk_bf16_f32 v42, v28, v29
    v_cvt_pk_bf16_f32 v43, v30, v31
    buffer_store_dwordx4 v[32:35], v2, s[56:59], 0 offen sc1
    buffer_store_dwordx4 v[36:39], v2, s[56:59], 0 offen offset:1024 sc1
    buffer_store_dwordx4 v[40:43], v5, s[56:59], 0 offen sc1
    v_cvt_pk_bf16_f32 v2, v64, v65
    v_cvt_pk_bf16_f32 v28, v88, v89
    v_cvt_pk_bf16_f32 v3, v66, v67
    v_cvt_pk_bf16_f32 v29, v90, v91
    v_cvt_pk_bf16_f32 v4, v68, v69
    v_cvt_pk_bf16_f32 v30, v92, v93
    v_cvt_pk_bf16_f32 v5, v70, v71
    v_cvt_pk_bf16_f32 v31, v94, v95
    s_nop 0
    v_mfma_f32_16x16x32_bf16 v[64:67], a[200:203], v[2:5], 0
    v_mfma_f32_16x16x32_bf16 v[88:91], a[200:203], v[28:31], 0
    v_mfma_f32_16x16x32_bf16 v[68:71], a[204:207], v[2:5], 0
    v_mfma_f32_16x16x32_bf16 v[92:95], a[204:207], v[28:31], 0
    s_nop 4
    v_max3_f32 v14, v64, v65, v66
    v_max3_f32 v40, v88, v89, v90
    v_min3_f32 v15, v64, v65, v66
    v_min3_f32 v41, v88, v89, v90
    v_max3_f32 v14, v14, v67, v68
    v_max3_f32 v40, v40, v91, v92
    v_min3_f32 v15, v15, v67, v68
    v_min3_f32 v41, v41, v91, v92
    v_max3_f32 v14, v14, v69, v70
    v_max3_f32 v40, v40, v93, v94
    v_min3_f32 v15, v15, v69, v70
    v_min3_f32 v41, v41, v93, v94
    v_max_f32 v14, v14, v71
    v_max_f32 v40, v40, v95
    v_max_f32 v15, -v15, -v71
    v_max_f32 v41, -v41, -v95
    s_nop 0
    v_permlane32_swap_b32 v14, v15
    v_permlane32_swap_b32 v40, v41
    v_max_f32 v14, v14, v15
    v_max_f32 v40, v40, v41
    v_mov_b32 v16, v14
    v_mov_b32 v42, v40
    s_nop 0
    v_permlane16_swap_b32 v14, v16
    v_permlane16_swap_b32 v40, v42
    v_max_f32 v14, v14, v16
    v_max_f32 v40, v40, v42
    v_mov_b32 v15, v14
    v_mov_b32 v41, v40
    s_nop 0
    v_permlane32_swap_b32 v14, v15
    v_permlane32_swap_b32 v40, v41
    v_pk_mul_f32 v[14:15], v[14:15], s[62:63]
    v_pk_mul_f32 v[40:41], v[40:41], s[62:63]
    v_pk_fma_f32 v[6:7], v[64:65], s[62:63], v[14:15] op_sel:[0,0,1] op_sel_hi:[1,1,1]
    v_pk_fma_f32 v[32:33], v[88:89], s[62:63], v[40:41] op_sel:[0,0,1] op_sel_hi:[1,1,1]
    v_pk_fma_f32 v[8:9], v[66:67], s[62:63], v[14:15] op_sel:[0,0,1] op_sel_hi:[1,1,1]
    v_pk_fma_f32 v[34:35], v[90:91], s[62:63], v[40:41] op_sel:[0,0,1] op_sel_hi:[1,1,1]
    v_pk_fma_f32 v[10:11], v[68:69], s[62:63], v[14:15] op_sel:[0,0,1] op_sel_hi:[1,1,1]
    v_pk_fma_f32 v[36:37], v[92:93], s[62:63], v[40:41] op_sel:[0,0,1] op_sel_hi:[1,1,1]
    v_pk_fma_f32 v[12:13], v[70:71], s[62:63], v[14:15] op_sel:[0,0,1] op_sel_hi:[1,1,1]
    v_pk_fma_f32 v[38:39], v[94:95], s[62:63], v[40:41] op_sel:[0,0,1] op_sel_hi:[1,1,1]
    v_pk_fma_f32 v[64:65], v[64:65], s[60:61], v[14:15] op_sel_hi:[1,1,0]
    v_pk_fma_f32 v[88:89], v[88:89], s[60:61], v[40:41] op_sel_hi:[1,1,0]
    v_pk_fma_f32 v[66:67], v[66:67], s[60:61], v[14:15] op_sel_hi:[1,1,0]
    v_pk_fma_f32 v[90:91], v[90:91], s[60:61], v[40:41] op_sel_hi:[1,1,0]
    v_pk_fma_f32 v[68:69], v[68:69], s[60:61], v[14:15] op_sel_hi:[1,1,0]
    v_pk_fma_f32 v[92:93], v[92:93], s[60:61], v[40:41] op_sel_hi:[1,1,0]
    v_pk_fma_f32 v[70:71], v[70:71], s[60:61], v[14:15] op_sel_hi:[1,1,0]
    v_pk_fma_f32 v[94:95], v[94:95], s[60:61], v[40:41] op_sel_hi:[1,1,0]
    v_exp_f32 v64, v64
    v_exp_f32 v88, v88
    v_exp_f32 v6, v6
    v_exp_f32 v32, v32
    v_exp_f32 v65, v65
    v_exp_f32 v89, v89
    v_exp_f32 v7, v7
    v_exp_f32 v33, v33
    v_exp_f32 v66, v66
    v_exp_f32 v90, v90
    v_exp_f32 v8, v8
    v_exp_f32 v34, v34
    v_exp_f32 v67, v67
    v_exp_f32 v91, v91
    v_exp_f32 v9, v9
    v_exp_f32 v35, v35
    v_exp_f32 v68, v68
    v_exp_f32 v92, v92
    v_exp_f32 v10, v10
    v_exp_f32 v36, v36
    v_exp_f32 v69, v69
    v_exp_f32 v93, v93
    v_exp_f32 v11, v11
    v_exp_f32 v37, v37
    v_exp_f32 v70, v70
    v_exp_f32 v94, v94
    v_exp_f32 v12, v12
    v_exp_f32 v38, v38
    v_exp_f32 v71, v71
    v_exp_f32 v95, v95
    v_exp_f32 v13, v13
    v_exp_f32 v39, v39
    v_cvt_pk_bf16_f32 v64, v64, v65
    v_cvt_pk_bf16_f32 v88, v88, v89
    v_cvt_pk_bf16_f32 v65, v66, v67
    v_cvt_pk_bf16_f32 v89, v90, v91
    v_cvt_pk_bf16_f32 v66, v68, v69
    v_cvt_pk_bf16_f32 v90, v92, v93
    v_cvt_pk_bf16_f32 v67, v70, v71
    v_cvt_pk_bf16_f32 v91, v94, v95
    v_cvt_pk_bf16_f32 v68, v6, v7
    v_cvt_pk_bf16_f32 v92, v32, v33
    v_cvt_pk_bf16_f32 v69, v8, v9
    v_cvt_pk_bf16_f32 v93, v34, v35
    v_cvt_pk_bf16_f32 v70, v10, v11
    v_cvt_pk_bf16_f32 v94, v36, v37
    v_cvt_pk_bf16_f32 v71, v12, v13
    v_cvt_pk_bf16_f32 v95, v38, v39
    s_waitcnt vmcnt(0)
    s_barrier
    s_add_u32 s78, s35, 48
    s_cmp_lg_u32 s32, 0
    s_cbranch_scc1 post_27
    s_add_u32 s16, s52, 23592960
    s_addc_u32 s17, s53, 0
    s_mov_b32 s18, 65536
    s_mov_b32 s19, 0x20000
    v_mov_b32 v54, 0
    v_mov_b32 v55, v1
    v_and_b32 v56, 3, v55
    v_lshl_add_u32 v54, v56, 1, v54
    v_lshrrev_b32 v55, 2, v55
    v_mov_b32 v56, s36
    v_and_b32 v57, 3, v56
    v_lshl_add_u32 v54, v57, 3, v54
    v_lshrrev_b32 v56, 2, v56
    v_lshl_add_u32 v55, v56, 1, v55
    v_lshl_add_u32 v54, v54, 3, v55
    v_lshlrev_b32 v54, 6, v54
    v_add_u32 v54, s78, v54
    v_lshlrev_b32 v54, 2, v54
    v_mov_b32 v55, 0x7ffffff0
    v_cmp_gt_u32 vcc, 8, v1
    s_nop 1
    v_cndmask_b32 v54, v55, v54, vcc
    v_mov_b32 v55, 1
    buffer_store_dword v55, v54, s[16:19], 0 offen sc1
post_27:
    v_cvt_pk_bf16_f32 v2, v112, v113
    v_cvt_pk_bf16_f32 v28, v136, v137
    v_cvt_pk_bf16_f32 v3, v114, v115
    v_cvt_pk_bf16_f32 v29, v138, v139
    v_cvt_pk_bf16_f32 v4, v116, v117
    v_cvt_pk_bf16_f32 v30, v140, v141
    v_cvt_pk_bf16_f32 v5, v118, v119
    v_cvt_pk_bf16_f32 v31, v142, v143
    s_nop 0
    v_mfma_f32_16x16x32_bf16 v[112:115], a[200:203], v[2:5], 0
    v_mfma_f32_16x16x32_bf16 v[136:139], a[200:203], v[28:31], 0
    v_mfma_f32_16x16x32_bf16 v[116:119], a[204:207], v[2:5], 0
    v_mfma_f32_16x16x32_bf16 v[140:143], a[204:207], v[28:31], 0
    s_nop 4
    v_max3_f32 v14, v112, v113, v114
    v_max3_f32 v40, v136, v137, v138
    v_min3_f32 v15, v112, v113, v114
    v_min3_f32 v41, v136, v137, v138
    v_max3_f32 v14, v14, v115, v116
    v_max3_f32 v40, v40, v139, v140
    v_min3_f32 v15, v15, v115, v116
    v_min3_f32 v41, v41, v139, v140
    v_max3_f32 v14, v14, v117, v118
    v_max3_f32 v40, v40, v141, v142
    v_min3_f32 v15, v15, v117, v118
    v_min3_f32 v41, v41, v141, v142
    v_max_f32 v14, v14, v119
    v_max_f32 v40, v40, v143
    v_max_f32 v15, -v15, -v119
    v_max_f32 v41, -v41, -v143
    s_nop 0
    v_permlane32_swap_b32 v14, v15
    v_permlane32_swap_b32 v40, v41
    v_max_f32 v14, v14, v15
    v_max_f32 v40, v40, v41
    v_mov_b32 v16, v14
    v_mov_b32 v42, v40
    s_nop 0
    v_permlane16_swap_b32 v14, v16
    v_permlane16_swap_b32 v40, v42
    v_max_f32 v14, v14, v16
    v_max_f32 v40, v40, v42
    v_mov_b32 v15, v14
    v_mov_b32 v41, v40
    s_nop 0
    v_permlane32_swap_b32 v14, v15
    v_permlane32_swap_b32 v40, v41
    v_pk_mul_f32 v[14:15], v[14:15], s[62:63]
    v_pk_mul_f32 v[40:41], v[40:41], s[62:63]
    v_pk_fma_f32 v[6:7], v[112:113], s[62:63], v[14:15] op_sel:[0,0,1] op_sel_hi:[1,1,1]
    v_pk_fma_f32 v[32:33], v[136:137], s[62:63], v[40:41] op_sel:[0,0,1] op_sel_hi:[1,1,1]
    v_pk_fma_f32 v[8:9], v[114:115], s[62:63], v[14:15] op_sel:[0,0,1] op_sel_hi:[1,1,1]
    v_pk_fma_f32 v[34:35], v[138:139], s[62:63], v[40:41] op_sel:[0,0,1] op_sel_hi:[1,1,1]
    v_pk_fma_f32 v[10:11], v[116:117], s[62:63], v[14:15] op_sel:[0,0,1] op_sel_hi:[1,1,1]
    v_pk_fma_f32 v[36:37], v[140:141], s[62:63], v[40:41] op_sel:[0,0,1] op_sel_hi:[1,1,1]
    v_pk_fma_f32 v[12:13], v[118:119], s[62:63], v[14:15] op_sel:[0,0,1] op_sel_hi:[1,1,1]
    v_pk_fma_f32 v[38:39], v[142:143], s[62:63], v[40:41] op_sel:[0,0,1] op_sel_hi:[1,1,1]
    v_pk_fma_f32 v[112:113], v[112:113], s[60:61], v[14:15] op_sel_hi:[1,1,0]
    v_pk_fma_f32 v[136:137], v[136:137], s[60:61], v[40:41] op_sel_hi:[1,1,0]
    v_pk_fma_f32 v[114:115], v[114:115], s[60:61], v[14:15] op_sel_hi:[1,1,0]
    v_pk_fma_f32 v[138:139], v[138:139], s[60:61], v[40:41] op_sel_hi:[1,1,0]
    v_pk_fma_f32 v[116:117], v[116:117], s[60:61], v[14:15] op_sel_hi:[1,1,0]
    v_pk_fma_f32 v[140:141], v[140:141], s[60:61], v[40:41] op_sel_hi:[1,1,0]
    v_pk_fma_f32 v[118:119], v[118:119], s[60:61], v[14:15] op_sel_hi:[1,1,0]
    v_pk_fma_f32 v[142:143], v[142:143], s[60:61], v[40:41] op_sel_hi:[1,1,0]
    v_exp_f32 v112, v112
    v_exp_f32 v136, v136
    v_exp_f32 v6, v6
    v_exp_f32 v32, v32
    v_exp_f32 v113, v113
    v_exp_f32 v137, v137
    v_exp_f32 v7, v7
    v_exp_f32 v33, v33
    v_exp_f32 v114, v114
    v_exp_f32 v138, v138
    v_exp_f32 v8, v8
    v_exp_f32 v34, v34
    v_exp_f32 v115, v115
    v_exp_f32 v139, v139
    v_exp_f32 v9, v9
    v_exp_f32 v35, v35
    v_exp_f32 v116, v116
    v_exp_f32 v140, v140
    v_exp_f32 v10, v10
    v_exp_f32 v36, v36
    v_exp_f32 v117, v117
    v_exp_f32 v141, v141
    v_exp_f32 v11, v11
    v_exp_f32 v37, v37
    v_exp_f32 v118, v118
    v_exp_f32 v142, v142
    v_exp_f32 v12, v12
    v_exp_f32 v38, v38
    v_exp_f32 v119, v119
    v_exp_f32 v143, v143
    v_exp_f32 v13, v13
    v_exp_f32 v39, v39
    v_cvt_pk_bf16_f32 v112, v112, v113
    v_cvt_pk_bf16_f32 v136, v136, v137
    v_cvt_pk_bf16_f32 v113, v114, v115
    v_cvt_pk_bf16_f32 v137, v138, v139
    v_cvt_pk_bf16_f32 v114, v116, v117
    v_cvt_pk_bf16_f32 v138, v140, v141
    v_cvt_pk_bf16_f32 v115, v118, v119
    v_cvt_pk_bf16_f32 v139, v142, v143
    v_cvt_pk_bf16_f32 v116, v6, v7
    v_cvt_pk_bf16_f32 v140, v32, v33
    v_cvt_pk_bf16_f32 v117, v8, v9
    v_cvt_pk_bf16_f32 v141, v34, v35
    v_cvt_pk_bf16_f32 v118, v10, v11
    v_cvt_pk_bf16_f32 v142, v36, v37
    v_cvt_pk_bf16_f32 v119, v12, v13
    v_cvt_pk_bf16_f32 v143, v38, v39
    v_min_u32 v60, 7, v1
    v_add_u32 v60, 48, v60
    v_lshlrev_b32 v60, 2, v60
    global_load_dword v61, v60, s[100:101] sc1
    v_cvt_pk_bf16_f32 v2, v160, v161
    v_cvt_pk_bf16_f32 v28, v184, v185
    v_cvt_pk_bf16_f32 v3, v162, v163
    v_cvt_pk_bf16_f32 v29, v186, v187
    v_cvt_pk_bf16_f32 v4, v164, v165
    v_cvt_pk_bf16_f32 v30, v188, v189
    v_cvt_pk_bf16_f32 v5, v166, v167
    v_cvt_pk_bf16_f32 v31, v190, v191
    s_nop 0
    v_mfma_f32_16x16x32_bf16 v[160:163], a[200:203], v[2:5], 0
    v_mfma_f32_16x16x32_bf16 v[184:187], a[200:203], v[28:31], 0
    v_mfma_f32_16x16x32_bf16 v[164:167], a[204:207], v[2:5], 0
    v_mfma_f32_16x16x32_bf16 v[188:191], a[204:207], v[28:31], 0
    s_nop 4
    v_max3_f32 v14, v160, v161, v162
    v_max3_f32 v40, v184, v185, v186
    v_min3_f32 v15, v160, v161, v162
    v_min3_f32 v41, v184, v185, v186
    v_max3_f32 v14, v14, v163, v164
    v_max3_f32 v40, v40, v187, v188
    v_min3_f32 v15, v15, v163, v164
    v_min3_f32 v41, v41, v187, v188
    v_max3_f32 v14, v14, v165, v166
    v_max3_f32 v40, v40, v189, v190
    v_min3_f32 v15, v15, v165, v166
    v_min3_f32 v41, v41, v189, v190
    v_max_f32 v14, v14, v167
    v_max_f32 v40, v40, v191
    v_max_f32 v15, -v15, -v167
    v_max_f32 v41, -v41, -v191
    s_nop 0
    v_permlane32_swap_b32 v14, v15
    v_permlane32_swap_b32 v40, v41
    v_max_f32 v14, v14, v15
    v_max_f32 v40, v40, v41
    v_mov_b32 v16, v14
    v_mov_b32 v42, v40
    s_nop 0
    v_permlane16_swap_b32 v14, v16
    v_permlane16_swap_b32 v40, v42
    v_max_f32 v14, v14, v16
    v_max_f32 v40, v40, v42
    v_mov_b32 v15, v14
    v_mov_b32 v41, v40
    s_nop 0
    v_permlane32_swap_b32 v14, v15
    v_permlane32_swap_b32 v40, v41
    v_pk_mul_f32 v[14:15], v[14:15], s[62:63]
    v_pk_mul_f32 v[40:41], v[40:41], s[62:63]
    v_pk_fma_f32 v[6:7], v[160:161], s[62:63], v[14:15] op_sel:[0,0,1] op_sel_hi:[1,1,1]
    v_pk_fma_f32 v[32:33], v[184:185], s[62:63], v[40:41] op_sel:[0,0,1] op_sel_hi:[1,1,1]
    v_pk_fma_f32 v[8:9], v[162:163], s[62:63], v[14:15] op_sel:[0,0,1] op_sel_hi:[1,1,1]
    v_pk_fma_f32 v[34:35], v[186:187], s[62:63], v[40:41] op_sel:[0,0,1] op_sel_hi:[1,1,1]
    v_pk_fma_f32 v[10:11], v[164:165], s[62:63], v[14:15] op_sel:[0,0,1] op_sel_hi:[1,1,1]
    v_pk_fma_f32 v[36:37], v[188:189], s[62:63], v[40:41] op_sel:[0,0,1] op_sel_hi:[1,1,1]
    v_pk_fma_f32 v[12:13], v[166:167], s[62:63], v[14:15] op_sel:[0,0,1] op_sel_hi:[1,1,1]
    v_pk_fma_f32 v[38:39], v[190:191], s[62:63], v[40:41] op_sel:[0,0,1] op_sel_hi:[1,1,1]
    v_pk_fma_f32 v[160:161], v[160:161], s[60:61], v[14:15] op_sel_hi:[1,1,0]
    v_pk_fma_f32 v[184:185], v[184:185], s[60:61], v[40:41] op_sel_hi:[1,1,0]
    v_pk_fma_f32 v[162:163], v[162:163], s[60:61], v[14:15] op_sel_hi:[1,1,0]
    v_pk_fma_f32 v[186:187], v[186:187], s[60:61], v[40:41] op_sel_hi:[1,1,0]
    v_pk_fma_f32 v[164:165], v[164:165], s[60:61], v[14:15] op_sel_hi:[1,1,0]
    v_pk_fma_f32 v[188:189], v[188:189], s[60:61], v[40:41] op_sel_hi:[1,1,0]
    v_pk_fma_f32 v[166:167], v[166:167], s[60:61], v[14:15] op_sel_hi:[1,1,0]
    v_pk_fma_f32 v[190:191], v[190:191], s[60:61], v[40:41] op_sel_hi:[1,1,0]
    v_exp_f32 v160, v160
    v_exp_f32 v184, v184
    v_exp_f32 v6, v6
    v_exp_f32 v32, v32
    v_exp_f32 v161, v161
    v_exp_f32 v185, v185
    v_exp_f32 v7, v7
    v_exp_f32 v33, v33
    v_exp_f32 v162, v162
    v_exp_f32 v186, v186
    v_exp_f32 v8, v8
    v_exp_f32 v34, v34
    v_exp_f32 v163, v163
    v_exp_f32 v187, v187
    v_exp_f32 v9, v9
    v_exp_f32 v35, v35
    v_exp_f32 v164, v164
    v_exp_f32 v188, v188
    v_exp_f32 v10, v10
    v_exp_f32 v36, v36
    v_exp_f32 v165, v165
    v_exp_f32 v189, v189
    v_exp_f32 v11, v11
    v_exp_f32 v37, v37
    v_exp_f32 v166, v166
    v_exp_f32 v190, v190
    v_exp_f32 v12, v12
    v_exp_f32 v38, v38
    v_exp_f32 v167, v167
    v_exp_f32 v191, v191
    v_exp_f32 v13, v13
    v_exp_f32 v39, v39
    v_cvt_pk_bf16_f32 v160, v160, v161
    v_cvt_pk_bf16_f32 v184, v184, v185
    v_cvt_pk_bf16_f32 v161, v162, v163
    v_cvt_pk_bf16_f32 v185, v186, v187
    v_cvt_pk_bf16_f32 v162, v164, v165
    v_cvt_pk_bf16_f32 v186, v188, v189
    v_cvt_pk_bf16_f32 v163, v166, v167
    v_cvt_pk_bf16_f32 v187, v190, v191
    v_cvt_pk_bf16_f32 v164, v6, v7
    v_cvt_pk_bf16_f32 v188, v32, v33
    v_cvt_pk_bf16_f32 v165, v8, v9
    v_cvt_pk_bf16_f32 v189, v34, v35
    v_cvt_pk_bf16_f32 v166, v10, v11
    v_cvt_pk_bf16_f32 v190, v36, v37
    v_cvt_pk_bf16_f32 v167, v12, v13
    v_cvt_pk_bf16_f32 v191, v38, v39
    s_waitcnt vmcnt(0)
    s_mov_b32 s44, 32768
wait_28:
    v_cmp_ne_u32 vcc, 1, v61
    s_nop 4
    s_cbranch_vccz wait_28_ok
    s_sub_u32 s44, s44, 1
    s_cbranch_scc1 wait_28_ok
    s_sleep 1
    global_load_dword v61, v60, s[100:101] sc1
    s_waitcnt vmcnt(0)
    s_branch wait_28
wait_28_ok:
    s_lshl_b32 s44, s36, 1
    s_add_u32 s44, s44, s34
    s_lshl_b32 s44, s44, 4
    s_add_u32 s44, s44, s33
    s_mul_i32 s44, s44, 2176
    s_add_u32 s44, s44, 24117248
    s_add_u32 s56, s52, s44
    s_addc_u32 s57, s53, 0
    s_mov_b32 s58, 32640
    s_mov_b32 s59, 0x20000
    v_lshlrev_b32 v62, 4, v1
    v_lshrrev_b32 v63, 4, v1
    v_lshlrev_b32 v63, 4, v63
    v_add_u32 v63, 2048, v63
    s_mov_b32 s45, 0
    buffer_load_dwordx4 a[0:3], v62, s[56:59], s45 offen sc1
    buffer_load_dwordx4 a[4:7], v62, s[56:59], s45 offen offset:1024 sc1
    buffer_load_dwordx4 a[8:11], v63, s[56:59], s45 offen sc1
    s_mov_b32 s45, 4352
    buffer_load_dwordx4 a[12:15], v62, s[56:59], s45 offen sc1
    buffer_load_dwordx4 a[16:19], v62, s[56:59], s45 offen offset:1024 sc1
    buffer_load_dwordx4 a[20:23], v63, s[56:59], s45 offen sc1
    s_mov_b32 s45, 8704
    buffer_load_dwordx4 a[24:27], v62, s[56:59], s45 offen sc1
    buffer_load_dwordx4 a[28:31], v62, s[56:59], s45 offen offset:1024 sc1
    buffer_load_dwordx4 a[32:35], v63, s[56:59], s45 offen sc1
    s_mov_b32 s45, 13056
    buffer_load_dwordx4 a[36:39], v62, s[56:59], s45 offen sc1
    buffer_load_dwordx4 a[40:43], v62, s[56:59], s45 offen offset:1024 sc1
    buffer_load_dwordx4 a[44:47], v63, s[56:59], s45 offen sc1
    s_mov_b32 s45, 17408
    buffer_load_dwordx4 a[48:51], v62, s[56:59], s45 offen sc1
    buffer_load_dwordx4 a[52:55], v62, s[56:59], s45 offen offset:1024 sc1
    buffer_load_dwordx4 a[56:59], v63, s[56:59], s45 offen sc1
    s_mov_b32 s45, 21760
    buffer_load_dwordx4 a[60:63], v62, s[56:59], s45 offen sc1
    buffer_load_dwordx4 a[64:67], v62, s[56:59], s45 offen offset:1024 sc1
    buffer_load_dwordx4 a[68:71], v63, s[56:59], s45 offen sc1
    s_mov_b32 s45, 26112
    buffer_load_dwordx4 a[72:75], v62, s[56:59], s45 offen sc1
    buffer_load_dwordx4 a[76:79], v62, s[56:59], s45 offen offset:1024 sc1
    buffer_load_dwordx4 a[80:83], v63, s[56:59], s45 offen sc1
    s_mov_b32 s45, 30464
    buffer_load_dwordx4 a[84:87], v62, s[56:59], s45 offen sc1
    buffer_load_dwordx4 a[88:91], v62, s[56:59], s45 offen offset:1024 sc1
    buffer_load_dwordx4 a[92:95], v63, s[56:59], s45 offen sc1
    v_cvt_pk_bf16_f32 v2, v208, v209
    v_cvt_pk_bf16_f32 v28, v232, v233
    v_cvt_pk_bf16_f32 v3, v210, v211
    v_cvt_pk_bf16_f32 v29, v234, v235
    v_cvt_pk_bf16_f32 v4, v212, v213
    v_cvt_pk_bf16_f32 v30, v236, v237
    v_cvt_pk_bf16_f32 v5, v214, v215
    v_cvt_pk_bf16_f32 v31, v238, v239
    s_nop 0
    v_mfma_f32_16x16x32_bf16 v[208:211], a[200:203], v[2:5], 0
    v_mfma_f32_16x16x32_bf16 v[232:235], a[200:203], v[28:31], 0
    v_mfma_f32_16x16x32_bf16 v[212:215], a[204:207], v[2:5], 0
    v_mfma_f32_16x16x32_bf16 v[236:239], a[204:207], v[28:31], 0
    s_nop 4
    v_max3_f32 v14, v208, v209, v210
    v_max3_f32 v40, v232, v233, v234
    v_min3_f32 v15, v208, v209, v210
    v_min3_f32 v41, v232, v233, v234
    v_max3_f32 v14, v14, v211, v212
    v_max3_f32 v40, v40, v235, v236
    v_min3_f32 v15, v15, v211, v212
    v_min3_f32 v41, v41, v235, v236
    v_max3_f32 v14, v14, v213, v214
    v_max3_f32 v40, v40, v237, v238
    v_min3_f32 v15, v15, v213, v214
    v_min3_f32 v41, v41, v237, v238
    v_max_f32 v14, v14, v215
    v_max_f32 v40, v40, v239
    v_max_f32 v15, -v15, -v215
    v_max_f32 v41, -v41, -v239
    s_nop 0
    v_permlane32_swap_b32 v14, v15
    v_permlane32_swap_b32 v40, v41
    v_max_f32 v14, v14, v15
    v_max_f32 v40, v40, v41
    v_mov_b32 v16, v14
    v_mov_b32 v42, v40
    s_nop 0
    v_permlane16_swap_b32 v14, v16
    v_permlane16_swap_b32 v40, v42
    v_max_f32 v14, v14, v16
    v_max_f32 v40, v40, v42
    v_mov_b32 v15, v14
    v_mov_b32 v41, v40
    s_nop 0
    v_permlane32_swap_b32 v14, v15
    v_permlane32_swap_b32 v40, v41
    v_pk_mul_f32 v[14:15], v[14:15], s[62:63]
    v_pk_mul_f32 v[40:41], v[40:41], s[62:63]
    v_pk_fma_f32 v[6:7], v[208:209], s[62:63], v[14:15] op_sel:[0,0,1] op_sel_hi:[1,1,1]
    v_pk_fma_f32 v[32:33], v[232:233], s[62:63], v[40:41] op_sel:[0,0,1] op_sel_hi:[1,1,1]
    v_pk_fma_f32 v[8:9], v[210:211], s[62:63], v[14:15] op_sel:[0,0,1] op_sel_hi:[1,1,1]
    v_pk_fma_f32 v[34:35], v[234:235], s[62:63], v[40:41] op_sel:[0,0,1] op_sel_hi:[1,1,1]
    v_pk_fma_f32 v[10:11], v[212:213], s[62:63], v[14:15] op_sel:[0,0,1] op_sel_hi:[1,1,1]
    v_pk_fma_f32 v[36:37], v[236:237], s[62:63], v[40:41] op_sel:[0,0,1] op_sel_hi:[1,1,1]
    v_pk_fma_f32 v[12:13], v[214:215], s[62:63], v[14:15] op_sel:[0,0,1] op_sel_hi:[1,1,1]
    v_pk_fma_f32 v[38:39], v[238:239], s[62:63], v[40:41] op_sel:[0,0,1] op_sel_hi:[1,1,1]
    v_pk_fma_f32 v[208:209], v[208:209], s[60:61], v[14:15] op_sel_hi:[1,1,0]
    v_pk_fma_f32 v[232:233], v[232:233], s[60:61], v[40:41] op_sel_hi:[1,1,0]
    v_pk_fma_f32 v[210:211], v[210:211], s[60:61], v[14:15] op_sel_hi:[1,1,0]
    v_pk_fma_f32 v[234:235], v[234:235], s[60:61], v[40:41] op_sel_hi:[1,1,0]
    v_pk_fma_f32 v[212:213], v[212:213], s[60:61], v[14:15] op_sel_hi:[1,1,0]
    v_pk_fma_f32 v[236:237], v[236:237], s[60:61], v[40:41] op_sel_hi:[1,1,0]
    v_pk_fma_f32 v[214:215], v[214:215], s[60:61], v[14:15] op_sel_hi:[1,1,0]
    v_pk_fma_f32 v[238:239], v[238:239], s[60:61], v[40:41] op_sel_hi:[1,1,0]
    v_exp_f32 v208, v208
    v_exp_f32 v232, v232
    v_exp_f32 v6, v6
    v_exp_f32 v32, v32
    v_exp_f32 v209, v209
    v_exp_f32 v233, v233
    v_exp_f32 v7, v7
    v_exp_f32 v33, v33
    v_exp_f32 v210, v210
    v_exp_f32 v234, v234
    v_exp_f32 v8, v8
    v_exp_f32 v34, v34
    v_exp_f32 v211, v211
    v_exp_f32 v235, v235
    v_exp_f32 v9, v9
    v_exp_f32 v35, v35
    v_exp_f32 v212, v212
    v_exp_f32 v236, v236
    v_exp_f32 v10, v10
    v_exp_f32 v36, v36
    v_exp_f32 v213, v213
    v_exp_f32 v237, v237
    v_exp_f32 v11, v11
    v_exp_f32 v37, v37
    v_exp_f32 v214, v214
    v_exp_f32 v238, v238
    v_exp_f32 v12, v12
    v_exp_f32 v38, v38
    v_exp_f32 v215, v215
    v_exp_f32 v239, v239
    v_exp_f32 v13, v13
    v_exp_f32 v39, v39
    v_cvt_pk_bf16_f32 v208, v208, v209
    v_cvt_pk_bf16_f32 v232, v232, v233
    v_cvt_pk_bf16_f32 v209, v210, v211
    v_cvt_pk_bf16_f32 v233, v234, v235
    v_cvt_pk_bf16_f32 v210, v212, v213
    v_cvt_pk_bf16_f32 v234, v236, v237
    v_cvt_pk_bf16_f32 v211, v214, v215
    v_cvt_pk_bf16_f32 v235, v238, v239
    v_cvt_pk_bf16_f32 v212, v6, v7
    v_cvt_pk_bf16_f32 v236, v32, v33
    v_cvt_pk_bf16_f32 v213, v8, v9
    v_cvt_pk_bf16_f32 v237, v34, v35
    v_cvt_pk_bf16_f32 v214, v10, v11
    v_cvt_pk_bf16_f32 v238, v36, v37
    v_cvt_pk_bf16_f32 v215, v12, v13
    v_cvt_pk_bf16_f32 v239, v38, v39
    s_waitcnt vmcnt(21)
    v_mfma_f32_16x16x32_bf16 v[2:5], a[210:213], a[0:3], 0
    v_mfma_f32_16x16x32_bf16 v[14:17], a[208:211], a[0:3], 0
    v_mfma_f32_16x16x32_bf16 v[6:9], a[210:213], a[4:7], 0
    v_mfma_f32_16x16x32_bf16 v[18:21], a[208:211], a[4:7], 0
    v_mfma_f32_16x16x32_bf16 v[10:13], a[210:213], a[8:11], 0
    v_mfma_f32_16x16x32_bf16 v[22:25], a[208:211], a[8:11], 0
    s_waitcnt vmcnt(18)
    v_mfma_f32_16x16x32_bf16 v[2:5], a[210:213], a[12:15], v[2:5]
    v_mfma_f32_16x16x32_bf16 v[14:17], a[208:211], a[12:15], v[14:17]
    v_mfma_f32_16x16x32_bf16 v[6:9], a[210:213], a[16:19], v[6:9]
    v_mfma_f32_16x16x32_bf16 v[18:21], a[208:211], a[16:19], v[18:21]
    v_mfma_f32_16x16x32_bf16 v[10:13], a[210:213], a[20:23], v[10:13]
    v_mfma_f32_16x16x32_bf16 v[22:25], a[208:211], a[20:23], v[22:25]
    s_waitcnt vmcnt(15)
    v_mfma_f32_16x16x32_bf16 v[2:5], a[210:213], a[24:27], v[2:5]
    v_mfma_f32_16x16x32_bf16 v[14:17], a[208:211], a[24:27], v[14:17]
    v_mfma_f32_16x16x32_bf16 v[6:9], a[210:213], a[28:31], v[6:9]
    v_mfma_f32_16x16x32_bf16 v[18:21], a[208:211], a[28:31], v[18:21]
    v_mfma_f32_16x16x32_bf16 v[10:13], a[210:213], a[32:35], v[10:13]
    v_mfma_f32_16x16x32_bf16 v[22:25], a[208:211], a[32:35], v[22:25]
    s_waitcnt vmcnt(12)
    v_mfma_f32_16x16x32_bf16 v[2:5], a[210:213], a[36:39], v[2:5]
    v_mfma_f32_16x16x32_bf16 v[14:17], a[208:211], a[36:39], v[14:17]
    v_mfma_f32_16x16x32_bf16 v[6:9], a[210:213], a[40:43], v[6:9]
    v_mfma_f32_16x16x32_bf16 v[18:21], a[208:211], a[40:43], v[18:21]
    v_mfma_f32_16x16x32_bf16 v[10:13], a[210:213], a[44:47], v[10:13]
    v_mfma_f32_16x16x32_bf16 v[22:25], a[208:211], a[44:47], v[22:25]
    s_waitcnt vmcnt(9)
    v_mfma_f32_16x16x32_bf16 v[2:5], a[210:213], a[48:51], v[2:5]
    v_mfma_f32_16x16x32_bf16 v[14:17], a[208:211], a[48:51], v[14:17]
    v_mfma_f32_16x16x32_bf16 v[6:9], a[210:213], a[52:55], v[6:9]
    v_mfma_f32_16x16x32_bf16 v[18:21], a[208:211], a[52:55], v[18:21]
    v_mfma_f32_16x16x32_bf16 v[10:13], a[210:213], a[56:59], v[10:13]
    v_mfma_f32_16x16x32_bf16 v[22:25], a[208:211], a[56:59], v[22:25]
    s_waitcnt vmcnt(6)
    v_mfma_f32_16x16x32_bf16 v[2:5], a[210:213], a[60:63], v[2:5]
    v_mfma_f32_16x16x32_bf16 v[14:17], a[208:211], a[60:63], v[14:17]
    v_mfma_f32_16x16x32_bf16 v[6:9], a[210:213], a[64:67], v[6:9]
    v_mfma_f32_16x16x32_bf16 v[18:21], a[208:211], a[64:67], v[18:21]
    v_mfma_f32_16x16x32_bf16 v[10:13], a[210:213], a[68:71], v[10:13]
    v_mfma_f32_16x16x32_bf16 v[22:25], a[208:211], a[68:71], v[22:25]
    s_waitcnt vmcnt(3)
    v_mfma_f32_16x16x32_bf16 v[2:5], a[210:213], a[72:75], v[2:5]
    v_mfma_f32_16x16x32_bf16 v[14:17], a[208:211], a[72:75], v[14:17]
    v_mfma_f32_16x16x32_bf16 v[6:9], a[210:213], a[76:79], v[6:9]
    v_mfma_f32_16x16x32_bf16 v[18:21], a[208:211], a[76:79], v[18:21]
    v_mfma_f32_16x16x32_bf16 v[10:13], a[210:213], a[80:83], v[10:13]
    v_mfma_f32_16x16x32_bf16 v[22:25], a[208:211], a[80:83], v[22:25]
    s_waitcnt vmcnt(0)
    v_mfma_f32_16x16x32_bf16 v[2:5], a[210:213], a[84:87], v[2:5]
    v_mfma_f32_16x16x32_bf16 v[14:17], a[208:211], a[84:87], v[14:17]
    v_mfma_f32_16x16x32_bf16 v[6:9], a[210:213], a[88:91], v[6:9]
    v_mfma_f32_16x16x32_bf16 v[18:21], a[208:211], a[88:91], v[18:21]
    v_mfma_f32_16x16x32_bf16 v[10:13], a[210:213], a[92:95], v[10:13]
    v_mfma_f32_16x16x32_bf16 v[22:25], a[208:211], a[92:95], v[22:25]
    s_nop 2
    v_cvt_pk_bf16_f32 v26, v2, v3
    v_cvt_pk_bf16_f32 v27, v4, v5
    v_cvt_pk_bf16_f32 v28, v14, v15
    v_cvt_pk_bf16_f32 v29, v16, v17
    v_cvt_pk_bf16_f32 v30, v6, v7
    v_cvt_pk_bf16_f32 v31, v8, v9
    v_cvt_pk_bf16_f32 v32, v18, v19
    v_cvt_pk_bf16_f32 v33, v20, v21
    v_cvt_pk_bf16_f32 v34, v10, v11
    v_cvt_pk_bf16_f32 v35, v12, v13
    v_cvt_pk_bf16_f32 v36, v22, v23
    v_cvt_pk_bf16_f32 v37, v24, v25
    s_lshl_b32 s44, s34, 1
    s_add_u32 s45, s44, s33
    s_xor_b32 s44, s45, 1
    s_mul_i32 s44, s44, 3072
    s_mul_i32 s45, s45, 3072
    v_add_u32 v60, s45, v62
    v_add_u32 v61, s44, v62
    s_barrier
    ds_write_b128 v60, v[26:29] offset:32768
    ds_write_b128 v60, v[30:33] offset:33792
    ds_write_b128 v60, v[34:37] offset:34816
    s_waitcnt lgkmcnt(0)
    s_barrier
    ds_read_b128 v[38:41], v61 offset:32768
    ds_read_b128 v[42:45], v61 offset:33792
    ds_read_b128 v[46:49], v61 offset:34816
    s_waitcnt lgkmcnt(0)
    s_cmp_eq_u32 s33, 0
    s_cbranch_scc1 kvg_29_0
    v_mov_b32 v2, v38
    v_mov_b32 v14, v26
    v_mov_b32 v3, v39
    v_mov_b32 v15, v27
    v_mov_b32 v4, v40
    v_mov_b32 v16, v28
    v_mov_b32 v5, v41
    v_mov_b32 v17, v29
    v_mov_b32 v6, v42
    v_mov_b32 v18, v30
    v_mov_b32 v7, v43
    v_mov_b32 v19, v31
    v_mov_b32 v8, v44
    v_mov_b32 v20, v32
    v_mov_b32 v9, v45
    v_mov_b32 v21, v33
    v_mov_b32 v10, v46
    v_mov_b32 v22, v34
    v_mov_b32 v11, v47
    v_mov_b32 v23, v35
    v_mov_b32 v12, v48
    v_mov_b32 v24, v36
    v_mov_b32 v13, v49
    v_mov_b32 v25, v37
    s_branch kvg_29_1
kvg_29_0:
    v_mov_b32 v2, v26
    v_mov_b32 v14, v38
    v_mov_b32 v3, v27
    v_mov_b32 v15, v39
    v_mov_b32 v4, v28
    v_mov_b32 v16, v40
    v_mov_b32 v5, v29
    v_mov_b32 v17, v41
    v_mov_b32 v6, v30
    v_mov_b32 v18, v42
    v_mov_b32 v7, v31
    v_mov_b32 v19, v43
    v_mov_b32 v8, v32
    v_mov_b32 v20, v44
    v_mov_b32 v9, v33
    v_mov_b32 v21, v45
    v_mov_b32 v10, v34
    v_mov_b32 v22, v46
    v_mov_b32 v11, v35
    v_mov_b32 v23, v47
    v_mov_b32 v12, v36
    v_mov_b32 v24, v48
    v_mov_b32 v13, v37
    v_mov_b32 v25, v49
kvg_29_1:
    s_mov_b32 s16, s52
    s_mov_b32 s17, s53
    s_mov_b32 s18, 18874368
    s_mov_b32 s19, 0x20000
    s_lshl_b32 s44, s35, 1
    s_add_u32 s44, s44, s33
    s_mul_i32 s44, s44, 144
    s_lshl_b32 s45, s36, 1
    s_add_u32 s45, s45, s34
    s_add_u32 s44, s44, s45
    s_add_u32 s44, s44, 112
    s_mul_i32 s44, s44, 8192
    s_mov_b32 s64, 0x358637bd
    v_mfma_f32_16x16x32_bf16 v[26:29], v[10:13], v[64:67], 0
    v_mfma_f32_16x16x32_bf16 v[34:37], a[216:219], v[64:67], 0
    v_mfma_f32_16x16x32_bf16 v[30:33], v[22:25], v[68:71], 0
    v_mfma_f32_16x16x32_bf16 v[38:41], a[216:219], v[68:71], 0
    v_mfma_f32_16x16x32_bf16 v[72:75], v[2:5], v[64:67], 0
    v_mfma_f32_16x16x32_bf16 v[76:79], v[6:9], v[64:67], 0
    v_mfma_f32_16x16x32_bf16 v[80:83], v[14:17], v[68:71], 0
    v_mfma_f32_16x16x32_bf16 v[84:87], v[18:21], v[68:71], 0
    v_mfma_f32_16x16x32_bf16 v[42:45], v[10:13], v[88:91], 0
    v_mfma_f32_16x16x32_bf16 v[50:53], a[216:219], v[88:91], 0
    v_mfma_f32_16x16x32_bf16 v[46:49], v[22:25], v[92:95], 0
    v_mfma_f32_16x16x32_bf16 v[54:57], a[216:219], v[92:95], 0
    v_mfma_f32_16x16x32_bf16 v[96:99], v[2:5], v[88:91], 0
    v_mfma_f32_16x16x32_bf16 v[100:103], v[6:9], v[88:91], 0
    v_mfma_f32_16x16x32_bf16 v[104:107], v[14:17], v[92:95], 0
    v_mfma_f32_16x16x32_bf16 v[108:111], v[18:21], v[92:95], 0
    v_rcp_f32 v34, v34
    s_nop 0
    v_rcp_f32 v50, v50
    v_rcp_f32 v35, v38
    v_rcp_f32 v51, v54
    v_fma_f32 v26, v26, v34, s64
    v_fma_f32 v42, v42, v50, s64
    v_fma_f32 v26, v30, v35, v26
    v_fma_f32 v42, v46, v51, v42
    v_rcp_f32 v26, v26
    v_rcp_f32 v42, v42
    v_pk_mul_f32 v[34:35], v[34:35], v[26:27] op_sel_hi:[1,0]
    v_pk_mul_f32 v[50:51], v[50:51], v[42:43] op_sel_hi:[1,0]
    v_pk_mul_f32 v[72:73], v[72:73], v[34:35] op_sel_hi:[1,0]
    v_pk_mul_f32 v[96:97], v[96:97], v[50:51] op_sel_hi:[1,0]
    v_pk_mul_f32 v[74:75], v[74:75], v[34:35] op_sel_hi:[1,0]
    v_pk_mul_f32 v[98:99], v[98:99], v[50:51] op_sel_hi:[1,0]
    v_pk_mul_f32 v[76:77], v[76:77], v[34:35] op_sel_hi:[1,0]
    v_pk_mul_f32 v[100:101], v[100:101], v[50:51] op_sel_hi:[1,0]
    v_pk_mul_f32 v[78:79], v[78:79], v[34:35] op_sel_hi:[1,0]
    v_pk_mul_f32 v[102:103], v[102:103], v[50:51] op_sel_hi:[1,0]
    v_pk_fma_f32 v[72:73], v[80:81], v[34:35], v[72:73] op_sel:[0,1,0] op_sel_hi:[1,1,1]
    v_pk_fma_f32 v[96:97], v[104:105], v[50:51], v[96:97] op_sel:[0,1,0] op_sel_hi:[1,1,1]
    v_pk_fma_f32 v[74:75], v[82:83], v[34:35], v[74:75] op_sel:[0,1,0] op_sel_hi:[1,1,1]
    v_pk_fma_f32 v[98:99], v[106:107], v[50:51], v[98:99] op_sel:[0,1,0] op_sel_hi:[1,1,1]
    v_pk_fma_f32 v[76:77], v[84:85], v[34:35], v[76:77] op_sel:[0,1,0] op_sel_hi:[1,1,1]
    v_pk_fma_f32 v[100:101], v[108:109], v[50:51], v[100:101] op_sel:[0,1,0] op_sel_hi:[1,1,1]
    v_pk_fma_f32 v[78:79], v[86:87], v[34:35], v[78:79] op_sel:[0,1,0] op_sel_hi:[1,1,1]
    v_pk_fma_f32 v[102:103], v[110:111], v[50:51], v[102:103] op_sel:[0,1,0] op_sel_hi:[1,1,1]
    v_cvt_pk_bf16_f32 v80, v72, v73
    v_cvt_pk_bf16_f32 v104, v96, v97
    v_cvt_pk_bf16_f32 v81, v74, v75
    v_cvt_pk_bf16_f32 v105, v98, v99
    v_cvt_pk_bf16_f32 v82, v76, v77
    v_cvt_pk_bf16_f32 v106, v100, v101
    v_cvt_pk_bf16_f32 v83, v78, v79
    v_cvt_pk_bf16_f32 v107, v102, v103
    s_add_u32 s45, s44, 0
    s_add_u32 s46, s44, 1024
    buffer_store_dwordx4 v[80:83], v62, s[16:19], s45 offen sc1
    buffer_store_dwordx4 v[104:107], v62, s[16:19], s46 offen sc1
    v_mfma_f32_16x16x32_bf16 v[26:29], v[10:13], v[112:115], 0
    v_mfma_f32_16x16x32_bf16 v[34:37], a[216:219], v[112:115], 0
    v_mfma_f32_16x16x32_bf16 v[30:33], v[22:25], v[116:119], 0
    v_mfma_f32_16x16x32_bf16 v[38:41], a[216:219], v[116:119], 0
    v_mfma_f32_16x16x32_bf16 v[120:123], v[2:5], v[112:115], 0
    v_mfma_f32_16x16x32_bf16 v[124:127], v[6:9], v[112:115], 0
    v_mfma_f32_16x16x32_bf16 v[128:131], v[14:17], v[116:119], 0
    v_mfma_f32_16x16x32_bf16 v[132:135], v[18:21], v[116:119], 0
    v_mfma_f32_16x16x32_bf16 v[42:45], v[10:13], v[136:139], 0
    v_mfma_f32_16x16x32_bf16 v[50:53], a[216:219], v[136:139], 0
    v_mfma_f32_16x16x32_bf16 v[46:49], v[22:25], v[140:143], 0
    v_mfma_f32_16x16x32_bf16 v[54:57], a[216:219], v[140:143], 0
    v_mfma_f32_16x16x32_bf16 v[144:147], v[2:5], v[136:139], 0
    v_mfma_f32_16x16x32_bf16 v[148:151], v[6:9], v[136:139], 0
    v_mfma_f32_16x16x32_bf16 v[152:155], v[14:17], v[140:143], 0
    v_mfma_f32_16x16x32_bf16 v[156:159], v[18:21], v[140:143], 0
    v_rcp_f32 v34, v34
    s_nop 0
    v_rcp_f32 v50, v50
    v_rcp_f32 v35, v38
    v_rcp_f32 v51, v54
    v_fma_f32 v26, v26, v34, s64
    v_fma_f32 v42, v42, v50, s64
    v_fma_f32 v26, v30, v35, v26
    v_fma_f32 v42, v46, v51, v42
    v_rcp_f32 v26, v26
    v_rcp_f32 v42, v42
    v_pk_mul_f32 v[34:35], v[34:35], v[26:27] op_sel_hi:[1,0]
    v_pk_mul_f32 v[50:51], v[50:51], v[42:43] op_sel_hi:[1,0]
    v_pk_mul_f32 v[120:121], v[120:121], v[34:35] op_sel_hi:[1,0]
    v_pk_mul_f32 v[144:145], v[144:145], v[50:51] op_sel_hi:[1,0]
    v_pk_mul_f32 v[122:123], v[122:123], v[34:35] op_sel_hi:[1,0]
    v_pk_mul_f32 v[146:147], v[146:147], v[50:51] op_sel_hi:[1,0]
    v_pk_mul_f32 v[124:125], v[124:125], v[34:35] op_sel_hi:[1,0]
    v_pk_mul_f32 v[148:149], v[148:149], v[50:51] op_sel_hi:[1,0]
    v_pk_mul_f32 v[126:127], v[126:127], v[34:35] op_sel_hi:[1,0]
    v_pk_mul_f32 v[150:151], v[150:151], v[50:51] op_sel_hi:[1,0]
    v_pk_fma_f32 v[120:121], v[128:129], v[34:35], v[120:121] op_sel:[0,1,0] op_sel_hi:[1,1,1]
    v_pk_fma_f32 v[144:145], v[152:153], v[50:51], v[144:145] op_sel:[0,1,0] op_sel_hi:[1,1,1]
    v_pk_fma_f32 v[122:123], v[130:131], v[34:35], v[122:123] op_sel:[0,1,0] op_sel_hi:[1,1,1]
    v_pk_fma_f32 v[146:147], v[154:155], v[50:51], v[146:147] op_sel:[0,1,0] op_sel_hi:[1,1,1]
    v_pk_fma_f32 v[124:125], v[132:133], v[34:35], v[124:125] op_sel:[0,1,0] op_sel_hi:[1,1,1]
    v_pk_fma_f32 v[148:149], v[156:157], v[50:51], v[148:149] op_sel:[0,1,0] op_sel_hi:[1,1,1]
    v_pk_fma_f32 v[126:127], v[134:135], v[34:35], v[126:127] op_sel:[0,1,0] op_sel_hi:[1,1,1]
    v_pk_fma_f32 v[150:151], v[158:159], v[50:51], v[150:151] op_sel:[0,1,0] op_sel_hi:[1,1,1]
    v_cvt_pk_bf16_f32 v128, v120, v121
    v_cvt_pk_bf16_f32 v152, v144, v145
    v_cvt_pk_bf16_f32 v129, v122, v123
    v_cvt_pk_bf16_f32 v153, v146, v147
    v_cvt_pk_bf16_f32 v130, v124, v125
    v_cvt_pk_bf16_f32 v154, v148, v149
    v_cvt_pk_bf16_f32 v131, v126, v127
    v_cvt_pk_bf16_f32 v155, v150, v151
    s_add_u32 s45, s44, 2048
    s_add_u32 s46, s44, 3072
    buffer_store_dwordx4 v[128:131], v62, s[16:19], s45 offen sc1
    buffer_store_dwordx4 v[152:155], v62, s[16:19], s46 offen sc1
    v_mfma_f32_16x16x32_bf16 v[26:29], v[10:13], v[160:163], 0
    v_mfma_f32_16x16x32_bf16 v[34:37], a[216:219], v[160:163], 0
    v_mfma_f32_16x16x32_bf16 v[30:33], v[22:25], v[164:167], 0
    v_mfma_f32_16x16x32_bf16 v[38:41], a[216:219], v[164:167], 0
    v_mfma_f32_16x16x32_bf16 v[168:171], v[2:5], v[160:163], 0
    v_mfma_f32_16x16x32_bf16 v[172:175], v[6:9], v[160:163], 0
    v_mfma_f32_16x16x32_bf16 v[176:179], v[14:17], v[164:167], 0
    v_mfma_f32_16x16x32_bf16 v[180:183], v[18:21], v[164:167], 0
    v_mfma_f32_16x16x32_bf16 v[42:45], v[10:13], v[184:187], 0
    v_mfma_f32_16x16x32_bf16 v[50:53], a[216:219], v[184:187], 0
    v_mfma_f32_16x16x32_bf16 v[46:49], v[22:25], v[188:191], 0
    v_mfma_f32_16x16x32_bf16 v[54:57], a[216:219], v[188:191], 0
    v_mfma_f32_16x16x32_bf16 v[192:195], v[2:5], v[184:187], 0
    v_mfma_f32_16x16x32_bf16 v[196:199], v[6:9], v[184:187], 0
    v_mfma_f32_16x16x32_bf16 v[200:203], v[14:17], v[188:191], 0
    v_mfma_f32_16x16x32_bf16 v[204:207], v[18:21], v[188:191], 0
    v_rcp_f32 v34, v34
    s_nop 0
    v_rcp_f32 v50, v50
    v_rcp_f32 v35, v38
    v_rcp_f32 v51, v54
    v_fma_f32 v26, v26, v34, s64
    v_fma_f32 v42, v42, v50, s64
    v_fma_f32 v26, v30, v35, v26
    v_fma_f32 v42, v46, v51, v42
    v_rcp_f32 v26, v26
    v_rcp_f32 v42, v42
    v_pk_mul_f32 v[34:35], v[34:35], v[26:27] op_sel_hi:[1,0]
    v_pk_mul_f32 v[50:51], v[50:51], v[42:43] op_sel_hi:[1,0]
    v_pk_mul_f32 v[168:169], v[168:169], v[34:35] op_sel_hi:[1,0]
    v_pk_mul_f32 v[192:193], v[192:193], v[50:51] op_sel_hi:[1,0]
    v_pk_mul_f32 v[170:171], v[170:171], v[34:35] op_sel_hi:[1,0]
    v_pk_mul_f32 v[194:195], v[194:195], v[50:51] op_sel_hi:[1,0]
    v_pk_mul_f32 v[172:173], v[172:173], v[34:35] op_sel_hi:[1,0]
    v_pk_mul_f32 v[196:197], v[196:197], v[50:51] op_sel_hi:[1,0]
    v_pk_mul_f32 v[174:175], v[174:175], v[34:35] op_sel_hi:[1,0]
    v_pk_mul_f32 v[198:199], v[198:199], v[50:51] op_sel_hi:[1,0]
    v_pk_fma_f32 v[168:169], v[176:177], v[34:35], v[168:169] op_sel:[0,1,0] op_sel_hi:[1,1,1]
    v_pk_fma_f32 v[192:193], v[200:201], v[50:51], v[192:193] op_sel:[0,1,0] op_sel_hi:[1,1,1]
    v_pk_fma_f32 v[170:171], v[178:179], v[34:35], v[170:171] op_sel:[0,1,0] op_sel_hi:[1,1,1]
    v_pk_fma_f32 v[194:195], v[202:203], v[50:51], v[194:195] op_sel:[0,1,0] op_sel_hi:[1,1,1]
    v_pk_fma_f32 v[172:173], v[180:181], v[34:35], v[172:173] op_sel:[0,1,0] op_sel_hi:[1,1,1]
    v_pk_fma_f32 v[196:197], v[204:205], v[50:51], v[196:197] op_sel:[0,1,0] op_sel_hi:[1,1,1]
    v_pk_fma_f32 v[174:175], v[182:183], v[34:35], v[174:175] op_sel:[0,1,0] op_sel_hi:[1,1,1]
    v_pk_fma_f32 v[198:199], v[206:207], v[50:51], v[198:199] op_sel:[0,1,0] op_sel_hi:[1,1,1]
    v_cvt_pk_bf16_f32 v176, v168, v169
    v_cvt_pk_bf16_f32 v200, v192, v193
    v_cvt_pk_bf16_f32 v177, v170, v171
    v_cvt_pk_bf16_f32 v201, v194, v195
    v_cvt_pk_bf16_f32 v178, v172, v173
    v_cvt_pk_bf16_f32 v202, v196, v197
    v_cvt_pk_bf16_f32 v179, v174, v175
    v_cvt_pk_bf16_f32 v203, v198, v199
    s_add_u32 s45, s44, 4096
    s_add_u32 s46, s44, 5120
    buffer_store_dwordx4 v[176:179], v62, s[16:19], s45 offen sc1
    buffer_store_dwordx4 v[200:203], v62, s[16:19], s46 offen sc1
    v_mfma_f32_16x16x32_bf16 v[26:29], v[10:13], v[208:211], 0
    v_mfma_f32_16x16x32_bf16 v[34:37], a[216:219], v[208:211], 0
    v_mfma_f32_16x16x32_bf16 v[30:33], v[22:25], v[212:215], 0
    v_mfma_f32_16x16x32_bf16 v[38:41], a[216:219], v[212:215], 0
    v_mfma_f32_16x16x32_bf16 v[216:219], v[2:5], v[208:211], 0
    v_mfma_f32_16x16x32_bf16 v[220:223], v[6:9], v[208:211], 0
    v_mfma_f32_16x16x32_bf16 v[224:227], v[14:17], v[212:215], 0
    v_mfma_f32_16x16x32_bf16 v[228:231], v[18:21], v[212:215], 0
    v_mfma_f32_16x16x32_bf16 v[42:45], v[10:13], v[232:235], 0
    v_mfma_f32_16x16x32_bf16 v[50:53], a[216:219], v[232:235], 0
    v_mfma_f32_16x16x32_bf16 v[46:49], v[22:25], v[236:239], 0
    v_mfma_f32_16x16x32_bf16 v[54:57], a[216:219], v[236:239], 0
    v_mfma_f32_16x16x32_bf16 v[240:243], v[2:5], v[232:235], 0
    v_mfma_f32_16x16x32_bf16 v[244:247], v[6:9], v[232:235], 0
    v_mfma_f32_16x16x32_bf16 v[248:251], v[14:17], v[236:239], 0
    v_mfma_f32_16x16x32_bf16 v[252:255], v[18:21], v[236:239], 0
    v_rcp_f32 v34, v34
    s_nop 0
    v_rcp_f32 v50, v50
    v_rcp_f32 v35, v38
    v_rcp_f32 v51, v54
    v_fma_f32 v26, v26, v34, s64
    v_fma_f32 v42, v42, v50, s64
    v_fma_f32 v26, v30, v35, v26
    v_fma_f32 v42, v46, v51, v42
    v_rcp_f32 v26, v26
    v_rcp_f32 v42, v42
    v_pk_mul_f32 v[34:35], v[34:35], v[26:27] op_sel_hi:[1,0]
    v_pk_mul_f32 v[50:51], v[50:51], v[42:43] op_sel_hi:[1,0]
    v_pk_mul_f32 v[216:217], v[216:217], v[34:35] op_sel_hi:[1,0]
    v_pk_mul_f32 v[240:241], v[240:241], v[50:51] op_sel_hi:[1,0]
    v_pk_mul_f32 v[218:219], v[218:219], v[34:35] op_sel_hi:[1,0]
    v_pk_mul_f32 v[242:243], v[242:243], v[50:51] op_sel_hi:[1,0]
    v_pk_mul_f32 v[220:221], v[220:221], v[34:35] op_sel_hi:[1,0]
    v_pk_mul_f32 v[244:245], v[244:245], v[50:51] op_sel_hi:[1,0]
    v_pk_mul_f32 v[222:223], v[222:223], v[34:35] op_sel_hi:[1,0]
    v_pk_mul_f32 v[246:247], v[246:247], v[50:51] op_sel_hi:[1,0]
    v_pk_fma_f32 v[216:217], v[224:225], v[34:35], v[216:217] op_sel:[0,1,0] op_sel_hi:[1,1,1]
    v_pk_fma_f32 v[240:241], v[248:249], v[50:51], v[240:241] op_sel:[0,1,0] op_sel_hi:[1,1,1]
    v_pk_fma_f32 v[218:219], v[226:227], v[34:35], v[218:219] op_sel:[0,1,0] op_sel_hi:[1,1,1]
    v_pk_fma_f32 v[242:243], v[250:251], v[50:51], v[242:243] op_sel:[0,1,0] op_sel_hi:[1,1,1]
    v_pk_fma_f32 v[220:221], v[228:229], v[34:35], v[220:221] op_sel:[0,1,0] op_sel_hi:[1,1,1]
    v_pk_fma_f32 v[244:245], v[252:253], v[50:51], v[244:245] op_sel:[0,1,0] op_sel_hi:[1,1,1]
    v_pk_fma_f32 v[222:223], v[230:231], v[34:35], v[222:223] op_sel:[0,1,0] op_sel_hi:[1,1,1]
    v_pk_fma_f32 v[246:247], v[254:255], v[50:51], v[246:247] op_sel:[0,1,0] op_sel_hi:[1,1,1]
    v_cvt_pk_bf16_f32 v224, v216, v217
    v_cvt_pk_bf16_f32 v248, v240, v241
    v_cvt_pk_bf16_f32 v225, v218, v219
    v_cvt_pk_bf16_f32 v249, v242, v243
    v_cvt_pk_bf16_f32 v226, v220, v221
    v_cvt_pk_bf16_f32 v250, v244, v245
    v_cvt_pk_bf16_f32 v227, v222, v223
    v_cvt_pk_bf16_f32 v251, v246, v247
    s_add_u32 s45, s44, 6144
    s_add_u32 s46, s44, 7168
    buffer_store_dwordx4 v[224:227], v62, s[16:19], s45 offen sc1
    buffer_store_dwordx4 v[248:251], v62, s[16:19], s46 offen sc1
    s_add_u32 s78, s36, 16
    s_add_u32 s72, s52, 23592960
    s_addc_u32 s73, s53, 0
    s_mov_b32 s74, 65536
    s_mov_b32 s75, 0x20000
    v_and_b32 v60, 1, v1
    v_lshrrev_b32 v61, 1, v1
    v_mov_b32 v56, v60
    v_mov_b32 v57, s35
    v_and_b32 v58, 3, v57
    v_lshl_add_u32 v56, v58, 1, v56
    v_lshrrev_b32 v57, 2, v57
    v_mov_b32 v58, v61
    v_and_b32 v59, 3, v58
    v_lshl_add_u32 v56, v59, 3, v56
    v_lshrrev_b32 v58, 2, v58
    v_lshl_add_u32 v57, v58, 1, v57
    v_lshl_add_u32 v56, v56, 3, v57
    v_lshlrev_b32 v56, 6, v56
    v_add_u32 v56, s78, v56
    v_lshlrev_b32 v56, 2, v56
    v_mov_b32 v57, 0x7ffffff0
    v_cmp_gt_u32 vcc, 32, v1
    s_nop 1
    v_cndmask_b32 v56, v57, v56, vcc
    v_mov_b32 v62, v56
gated_mix__linear_kernel_hedgehog__mixer_channel_mlp__prompt_kernel_p2:
    s_load_dwordx2 s[4:5], s[0:1], 56
    s_load_dwordx2 s[6:7], s[0:1], 24
    s_load_dwordx2 s[52:53], s[0:1], 96
    s_load_dwordx2 s[64:65], s[0:1], 80
    s_load_dwordx2 s[60:61], s[0:1], 88
    s_load_dwordx2 s[66:67], s[0:1], 64
    v_and_b32 v1, 63, v0
    v_lshrrev_b32 v15, 6, v0
    s_and_b32 s44, s2, 7
    s_lshr_b32 s45, s2, 3
    v_readfirstlane_b32 s32, v15
    s_and_b32 s33, s44, 1
    s_lshl_b32 s33, s33, 2
    s_bfe_u32 s46, s45, 0x20001
    s_add_u32 s33, s33, s46
    s_lshl_b32 s33, s33, 1
    s_bfe_u32 s46, s44, 0x10001
    s_add_u32 s33, s33, s46
    s_lshr_b32 s35, s44, 2
    s_lshr_b32 s34, s45, 3
    s_lshl_b32 s34, s34, 1
    s_and_b32 s46, s45, 1
    s_add_u32 s34, s34, s46
    s_waitcnt lgkmcnt(0)
    s_mul_i32 s44, s33, 1179648
    s_mul_i32 s45, s35, 589824
    s_add_u32 s44, s44, s45
    s_add_u32 s8, s52, s44
    s_addc_u32 s9, s53, 0
    s_cmp_eq_u32 s35, 0
    s_mov_b32 s45, 589824
    s_cselect_b32 s10, 589824, s45
    s_mov_b32 s11, 0x20000
    s_lshl_b32 s44, s34, 8
    s_mul_i32 s45, s35, 4718592
    s_add_u32 s45, s45, s44
    s_add_u32 s12, s4, s45
    s_addc_u32 s13, s5, 0
    s_cmp_eq_u32 s35, 0
    s_mov_b32 s45, 2621440
    s_cselect_b32 s45, 4718592, s45
    s_sub_u32 s14, s45, s44
    s_mov_b32 s15, 0x20000
    s_add_u32 s56, s6, s44
    s_addc_u32 s57, s7, 0
    s_sub_u32 s58, 2097152, s44
    s_lshl_b32 s44, s32, 11
    v_lshlrev_b32 v2, 4, v1
    v_add_u32 v2, s44, v2
    s_lshl_b32 s44, s32, 8
    v_add_u32 v15, s44, v1
    v_lshrrev_b32 v16, 4, v15
    v_and_b32 v17, 15, v15
    v_and_b32 v18, 7, v16
    v_lshlrev_b32 v18, 1, v18
    v_xor_b32 v17, v17, v18
    v_lshlrev_b32 v17, 4, v17
    v_lshlrev_b32 v16, 11, v16
    v_add_u32 v4, v16, v17
    s_lshl_b32 s44, s32, 8
    v_add_u32 v15, s44, v1
    v_add_u32 v15, 64, v15
    v_lshrrev_b32 v16, 4, v15
    v_and_b32 v17, 15, v15
    v_and_b32 v18, 7, v16
    v_lshlrev_b32 v18, 1, v18
    v_xor_b32 v17, v17, v18
    v_lshlrev_b32 v17, 4, v17
    v_lshlrev_b32 v16, 11, v16
    v_add_u32 v5, v16, v17
    v_subrev_u32 v5, 1024, v5
    s_lshl_b32 s44, s32, 8
    v_add_u32 v15, s44, v1
    v_add_u32 v15, 128, v15
    v_lshrrev_b32 v16, 4, v15
    v_and_b32 v17, 15, v15
    v_and_b32 v18, 7, v16
    v_lshlrev_b32 v18, 1, v18
    v_xor_b32 v17, v17, v18
    v_lshlrev_b32 v17, 4, v17
    v_lshlrev_b32 v16, 11, v16
    v_add_u32 v6, v16, v17
    v_subrev_u32 v6, 2048, v6
    s_lshl_b32 s44, s32, 8
    v_add_u32 v15, s44, v1
    v_add_u32 v15, 192, v15
    v_lshrrev_b32 v16, 4, v15
    v_and_b32 v17, 15, v15
    v_and_b32 v18, 7, v16
    v_lshlrev_b32 v18, 1, v18
    v_xor_b32 v17, v17, v18
    v_lshlrev_b32 v17, 4, v17
    v_lshlrev_b32 v16, 11, v16
    v_add_u32 v7, v16, v17
    v_subrev_u32 v7, 3072, v7
    s_lshl_b32 s44, s32, 12
    s_add_u32 s24, s44, 49152
    s_add_u32 s25, s44, 65536
    s_add_u32 s26, s44, 81920
    s_add_u32 s27, s44, 98304
    v_lshrrev_b32 v16, 4, v1
    v_bfe_u32 v17, v1, 2, 2
    v_lshlrev_b32 v18, 2, v16
    v_add_u32 v18, v18, v17
    v_lshlrev_b32 v19, 8, v18
    v_and_b32 v21, 3, v1
    v_lshlrev_b32 v21, 3, v21
    v_add_u32 v19, v19, v21
    v_add_u32 v19, 49152, v19
    v_and_b32 v18, 7, v18
    v_xor_b32 v21, 0, v18
    v_lshlrev_b32 v21, 5, v21
    v_add_u32 v22, v19, v21
    v_xor_b32 v21, 1, v18
    v_lshlrev_b32 v21, 5, v21
    v_add_u32 v23, v19, v21
    v_xor_b32 v21, 2, v18
    v_lshlrev_b32 v21, 5, v21
    v_add_u32 v24, v19, v21
    v_xor_b32 v21, 3, v18
    v_lshlrev_b32 v21, 5, v21
    v_add_u32 v25, v19, v21
    v_xor_b32 v21, 4, v18
    v_lshlrev_b32 v21, 5, v21
    v_add_u32 v26, v19, v21
    v_xor_b32 v21, 5, v18
    v_lshlrev_b32 v21, 5, v21
    v_add_u32 v27, v19, v21
    v_xor_b32 v21, 6, v18
    v_lshlrev_b32 v21, 5, v21
    v_add_u32 v28, v19, v21
    v_xor_b32 v21, 7, v18
    v_lshlrev_b32 v21, 5, v21
    v_add_u32 v29, v19, v21
    s_lshl_b32 s44, s33, 3
    s_add_u32 s44, s44, s34
    s_lshl_b32 s44, s44, 15
    s_add_u32 s44, s44, 37748736
    s_add_u32 s20, s52, s44
    s_addc_u32 s21, s53, 0
    s_mov_b32 s22, 32768
    s_mov_b32 s23, 0x20000
    s_lshl_b32 s45, s32, 12
    v_lshlrev_b32 v3, 4, v1
    v_add_u32 v3, s45, v3
    s_lshl_b32 s44, s33, 7
    s_lshl_b32 s45, s32, 5
    s_add_u32 s44, s44, s45
    v_and_b32 v15, 15, v1
    v_add_u32 v15, s44, v15
    v_lshrrev_b32 v16, 4, v1
    v_lshlrev_b32 v10, 11, v15
    v_and_b32 v17, 1, v16
    v_lshlrev_b32 v17, 5, v17
    v_lshrrev_b32 v18, 1, v16
    v_lshlrev_b32 v18, 4, v18
    v_add_u32 v17, v17, v18
    s_lshl_b32 s44, s34, 8
    v_add_u32 v17, s44, v17
    v_add_u32 v10, v10, v17
    v_add_u32 v11, 0x8000, v10
    s_mov_b32 s76, s52
    s_mov_b32 s77, s53
    s_mov_b32 s78, 0
    s_mov_b32 s79, 0x20000
    s_waitcnt vmcnt(0)
    s_barrier
    s_cmp_lg_u32 s32, 0
    s_cbranch_scc1 fire_30
    v_mov_b32 v63, 1
    buffer_store_dword v63, v62, s[72:75], 0 offen sc1
fire_30:
    s_mov_b32 s38, 0
    s_mov_b32 s39, 8192
    s_mov_b32 s40, 0
    s_mov_b32 s41, 4294967292
    s_cmp_eq_u32 s35, 0
    s_cselect_b32 s42, 0x7fffffff, 20
    s_add_u32 s41, s41, 4
    s_cmp_eq_u32 s41, s42
    s_cselect_b32 s12, s56, s12
    s_cselect_b32 s13, s57, s13
    s_cselect_b32 s14, s58, s14
    s_cselect_b32 s40, 0, s40
    s_mov_b32 m0, s24
    s_nop 0
    buffer_load_dwordx4 v4, s[12:15], s40 offen lds
    buffer_load_dwordx4 v5, s[12:15], s40 offen offset:1024 lds
    buffer_load_dwordx4 v6, s[12:15], s40 offen offset:2048 lds
    buffer_load_dwordx4 v7, s[12:15], s40 offen offset:3072 lds
    s_add_u32 s40, s40, 131072
    s_mov_b32 m0, s25
    s_nop 0
    buffer_load_dwordx4 v4, s[12:15], s40 offen lds
    buffer_load_dwordx4 v5, s[12:15], s40 offen offset:1024 lds
    buffer_load_dwordx4 v6, s[12:15], s40 offen offset:2048 lds
    buffer_load_dwordx4 v7, s[12:15], s40 offen offset:3072 lds
    s_add_u32 s40, s40, 131072
    s_mov_b32 m0, s26
    s_nop 0
    buffer_load_dwordx4 v4, s[12:15], s40 offen lds
    buffer_load_dwordx4 v5, s[12:15], s40 offen offset:1024 lds
    buffer_load_dwordx4 v6, s[12:15], s40 offen offset:2048 lds
    buffer_load_dwordx4 v7, s[12:15], s40 offen offset:3072 lds
    s_add_u32 s40, s40, 131072
    s_mov_b32 m0, s27
    s_nop 0
    buffer_load_dwordx4 v4, s[12:15], s40 offen lds
    buffer_load_dwordx4 v5, s[12:15], s40 offen offset:1024 lds
    buffer_load_dwordx4 v6, s[12:15], s40 offen offset:2048 lds
    buffer_load_dwordx4 v7, s[12:15], s40 offen offset:3072 lds
    s_add_u32 s40, s40, 131072
    v_min_u32 v8, 15, v1
    v_add_u32 v8, 0, v8
    v_lshlrev_b32 v8, 2, v8
    global_load_dword v9, v8, s[100:101] sc1
    s_add_u32 s16, s52, 23265280
    s_addc_u32 s17, s53, 0
    s_mov_b32 s18, 8192
    s_mov_b32 s19, 0x20000
    v_lshlrev_b32 v15, 2, v15
    buffer_load_dword v12, v15, s[16:19], 0 offen sc1
    buffer_load_dword v14, v15, s[16:19], 0 offen offset:64 sc1
    s_mov_b32 s16, s66
    s_mov_b32 s17, s67
    s_mov_b32 s18, 2048
    v_lshlrev_b32 v16, 3, v16
    s_lshl_b32 s44, s34, 8
    v_add_u32 v16, s44, v16
    buffer_load_dwordx2 v[32:33], v16, s[16:19], 0 offen offset:0
    buffer_load_dwordx2 v[34:35], v16, s[16:19], 0 offen offset:32
    buffer_load_dwordx2 v[36:37], v16, s[16:19], 0 offen offset:64
    buffer_load_dwordx2 v[38:39], v16, s[16:19], 0 offen offset:96
    buffer_load_dwordx2 v[40:41], v16, s[16:19], 0 offen offset:128
    buffer_load_dwordx2 v[42:43], v16, s[16:19], 0 offen offset:160
    buffer_load_dwordx2 v[44:45], v16, s[16:19], 0 offen offset:192
    buffer_load_dwordx2 v[46:47], v16, s[16:19], 0 offen offset:224
    s_mov_b32 s16, s64
    s_mov_b32 s17, s65
    s_mov_b32 s18, 4194304
    v_mov_b64 v[64:65], 0
    v_mov_b64 v[66:67], 0
    v_mov_b64 v[68:69], 0
    v_mov_b64 v[70:71], 0
    v_mov_b64 v[72:73], 0
    v_mov_b64 v[74:75], 0
    v_mov_b64 v[76:77], 0
    v_mov_b64 v[78:79], 0
    v_mov_b64 v[80:81], 0
    v_mov_b64 v[82:83], 0
    v_mov_b64 v[84:85], 0
    v_mov_b64 v[86:87], 0
    v_mov_b64 v[88:89], 0
    v_mov_b64 v[90:91], 0
    v_mov_b64 v[92:93], 0
    v_mov_b64 v[94:95], 0
    v_mov_b64 v[96:97], 0
    v_mov_b64 v[98:99], 0
    v_mov_b64 v[100:101], 0
    v_mov_b64 v[102:103], 0
    v_mov_b64 v[104:105], 0
    v_mov_b64 v[106:107], 0
    v_mov_b64 v[108:109], 0
    v_mov_b64 v[110:111], 0
    v_mov_b64 v[112:113], 0
    v_mov_b64 v[114:115], 0
    v_mov_b64 v[116:117], 0
    v_mov_b64 v[118:119], 0
    v_mov_b64 v[120:121], 0
    v_mov_b64 v[122:123], 0
    v_mov_b64 v[124:125], 0
    v_mov_b64 v[126:127], 0
    s_waitcnt vmcnt(10)
    s_mov_b32 s44, 32768
wait_31:
    v_cmp_ne_u32 vcc, 1, v9
    s_nop 4
    s_cbranch_vccz wait_31_ok
    s_sub_u32 s44, s44, 1
    s_cbranch_scc1 wait_31_ok
    s_sleep 1
    global_load_dword v9, v8, s[100:101] sc1
    s_waitcnt vmcnt(0)
    s_branch wait_31
wait_31_ok:
    buffer_load_dwordx4 a[64:67], v2, s[8:11], s38 offen sc1
    buffer_load_dwordx4 a[68:71], v2, s[8:11], s38 offen offset:1024 sc1
    s_add_u32 s38, s38, 16384
    buffer_load_dwordx4 a[72:75], v2, s[8:11], s39 offen sc1
    buffer_load_dwordx4 a[76:79], v2, s[8:11], s39 offen offset:1024 sc1
    s_add_u32 s39, s39, 16384
    buffer_load_dwordx4 a[80:83], v2, s[8:11], s38 offen sc1
    buffer_load_dwordx4 a[84:87], v2, s[8:11], s38 offen offset:1024 sc1
    s_add_u32 s38, s38, 16384
    buffer_load_dwordx4 a[88:91], v2, s[8:11], s39 offen sc1
    buffer_load_dwordx4 a[92:95], v2, s[8:11], s39 offen offset:1024 sc1
    s_add_u32 s39, s39, 16384
    buffer_load_dwordx4 a[96:99], v2, s[8:11], s38 offen sc1
    buffer_load_dwordx4 a[100:103], v2, s[8:11], s38 offen offset:1024 sc1
    s_add_u32 s38, s38, 16384
    buffer_load_dwordx4 a[104:107], v2, s[8:11], s39 offen sc1
    buffer_load_dwordx4 a[108:111], v2, s[8:11], s39 offen offset:1024 sc1
    s_add_u32 s39, s39, 16384
    buffer_load_dwordx4 a[112:115], v2, s[8:11], s38 offen sc1
    buffer_load_dwordx4 a[116:119], v2, s[8:11], s38 offen offset:1024 sc1
    s_add_u32 s38, s38, 16384
    s_waitcnt vmcnt(36)
    s_barrier
    ds_read_b64_tr_b16 a[0:1], v22 offset:0
    ds_read_b64_tr_b16 a[2:3], v22 offset:4096
    ds_read_b64_tr_b16 a[4:5], v23 offset:0
    ds_read_b64_tr_b16 a[6:7], v23 offset:4096
    ds_read_b64_tr_b16 a[8:9], v24 offset:0
    ds_read_b64_tr_b16 a[10:11], v24 offset:4096
    ds_read_b64_tr_b16 a[12:13], v25 offset:0
    ds_read_b64_tr_b16 a[14:15], v25 offset:4096
    ds_read_b64_tr_b16 a[16:17], v26 offset:0
    ds_read_b64_tr_b16 a[18:19], v26 offset:4096
    ds_read_b64_tr_b16 a[20:21], v27 offset:0
    ds_read_b64_tr_b16 a[22:23], v27 offset:4096
    ds_read_b64_tr_b16 a[24:25], v28 offset:0
    ds_read_b64_tr_b16 a[26:27], v28 offset:4096
    ds_read_b64_tr_b16 a[28:29], v29 offset:0
    ds_read_b64_tr_b16 a[30:31], v29 offset:4096
    s_mov_b32 s37, 0
    v_min_u32 v8, 15, v1
    v_add_u32 v8, 16, v8
    v_lshlrev_b32 v8, 2, v8
    s_waitcnt vmcnt(12) lgkmcnt(0)
    v_mfma_f32_16x16x32_bf16 v[64:67], a[0:3], a[64:67], v[64:67]
    ds_read_b64_tr_b16 a[32:33], v22 offset:8192
    ds_read_b64_tr_b16 a[34:35], v22 offset:12288
    v_mfma_f32_16x16x32_bf16 v[96:99], a[0:3], a[68:71], v[96:99]
    ds_read_b64_tr_b16 a[36:37], v23 offset:8192
    v_mfma_f32_16x16x32_bf16 v[68:71], a[4:7], a[64:67], v[68:71]
    ds_read_b64_tr_b16 a[38:39], v23 offset:12288
    ds_read_b64_tr_b16 a[40:41], v24 offset:8192
    v_mfma_f32_16x16x32_bf16 v[100:103], a[4:7], a[68:71], v[100:103]
    ds_read_b64_tr_b16 a[42:43], v24 offset:12288
    v_mfma_f32_16x16x32_bf16 v[72:75], a[8:11], a[64:67], v[72:75]
    ds_read_b64_tr_b16 a[44:45], v25 offset:8192
    ds_read_b64_tr_b16 a[46:47], v25 offset:12288
    v_mfma_f32_16x16x32_bf16 v[104:107], a[8:11], a[68:71], v[104:107]
    ds_read_b64_tr_b16 a[48:49], v26 offset:8192
    v_mfma_f32_16x16x32_bf16 v[76:79], a[12:15], a[64:67], v[76:79]
    ds_read_b64_tr_b16 a[50:51], v26 offset:12288
    ds_read_b64_tr_b16 a[52:53], v27 offset:8192
    v_mfma_f32_16x16x32_bf16 v[108:111], a[12:15], a[68:71], v[108:111]
    ds_read_b64_tr_b16 a[54:55], v27 offset:12288
    v_mfma_f32_16x16x32_bf16 v[80:83], a[16:19], a[64:67], v[80:83]
    ds_read_b64_tr_b16 a[56:57], v28 offset:8192
    ds_read_b64_tr_b16 a[58:59], v28 offset:12288
    v_mfma_f32_16x16x32_bf16 v[112:115], a[16:19], a[68:71], v[112:115]
    ds_read_b64_tr_b16 a[60:61], v29 offset:8192
    v_mfma_f32_16x16x32_bf16 v[84:87], a[20:23], a[64:67], v[84:87]
    ds_read_b64_tr_b16 a[62:63], v29 offset:12288
    v_mfma_f32_16x16x32_bf16 v[116:119], a[20:23], a[68:71], v[116:119]
    buffer_load_dwordx4 a[120:123], v2, s[8:11], s39 offen sc1
    buffer_load_dwordx4 a[124:127], v2, s[8:11], s39 offen offset:1024 sc1
    v_mfma_f32_16x16x32_bf16 v[88:91], a[24:27], a[64:67], v[88:91]
    s_add_u32 s39, s39, 16384
    s_waitcnt vmcnt(34) lgkmcnt(0)
    s_barrier
    v_mfma_f32_16x16x32_bf16 v[120:123], a[24:27], a[68:71], v[120:123]
    s_add_u32 s41, s41, 4
    s_cmp_eq_u32 s41, s42
    v_mfma_f32_16x16x32_bf16 v[92:95], a[28:31], a[64:67], v[92:95]
    s_cselect_b32 s12, s56, s12
    s_cselect_b32 s13, s57, s13
    v_mfma_f32_16x16x32_bf16 v[124:127], a[28:31], a[68:71], v[124:127]
    s_cselect_b32 s14, s58, s14
    s_cselect_b32 s40, 0, s40
    s_mov_b32 m0, s24
    s_waitcnt vmcnt(12)
    v_mfma_f32_16x16x32_bf16 v[64:67], a[32:35], a[72:75], v[64:67]
    ds_read_b64_tr_b16 a[0:1], v22 offset:16384
    ds_read_b64_tr_b16 a[2:3], v22 offset:20480
    v_mfma_f32_16x16x32_bf16 v[96:99], a[32:35], a[76:79], v[96:99]
    buffer_load_dwordx4 v4, s[12:15], s40 offen lds
    ds_read_b64_tr_b16 a[4:5], v23 offset:16384
    v_mfma_f32_16x16x32_bf16 v[68:71], a[36:39], a[72:75], v[68:71]
    ds_read_b64_tr_b16 a[6:7], v23 offset:20480
    ds_read_b64_tr_b16 a[8:9], v24 offset:16384
    v_mfma_f32_16x16x32_bf16 v[100:103], a[36:39], a[76:79], v[100:103]
    ds_read_b64_tr_b16 a[10:11], v24 offset:20480
    v_mfma_f32_16x16x32_bf16 v[72:75], a[40:43], a[72:75], v[72:75]
    buffer_load_dwordx4 v5, s[12:15], s40 offen offset:1024 lds
    ds_read_b64_tr_b16 a[12:13], v25 offset:16384
    v_mfma_f32_16x16x32_bf16 v[104:107], a[40:43], a[76:79], v[104:107]
    ds_read_b64_tr_b16 a[14:15], v25 offset:20480
    ds_read_b64_tr_b16 a[16:17], v26 offset:16384
    v_mfma_f32_16x16x32_bf16 v[76:79], a[44:47], a[72:75], v[76:79]
    ds_read_b64_tr_b16 a[18:19], v26 offset:20480
    ds_read_b64_tr_b16 a[20:21], v27 offset:16384
    v_mfma_f32_16x16x32_bf16 v[108:111], a[44:47], a[76:79], v[108:111]
    buffer_load_dwordx4 v6, s[12:15], s40 offen offset:2048 lds
    ds_read_b64_tr_b16 a[22:23], v27 offset:20480
    v_mfma_f32_16x16x32_bf16 v[80:83], a[48:51], a[72:75], v[80:83]
    ds_read_b64_tr_b16 a[24:25], v28 offset:16384
    ds_read_b64_tr_b16 a[26:27], v28 offset:20480
    v_mfma_f32_16x16x32_bf16 v[112:115], a[48:51], a[76:79], v[112:115]
    ds_read_b64_tr_b16 a[28:29], v29 offset:16384
    v_mfma_f32_16x16x32_bf16 v[84:87], a[52:55], a[72:75], v[84:87]
    buffer_load_dwordx4 v7, s[12:15], s40 offen offset:3072 lds
    ds_read_b64_tr_b16 a[30:31], v29 offset:20480
    v_mfma_f32_16x16x32_bf16 v[116:119], a[52:55], a[76:79], v[116:119]
    s_add_u32 s40, s40, 131072
    v_mfma_f32_16x16x32_bf16 v[88:91], a[56:59], a[72:75], v[88:91]
    v_mfma_f32_16x16x32_bf16 v[120:123], a[56:59], a[76:79], v[120:123]
    buffer_load_dwordx4 a[64:67], v2, s[8:11], s38 offen sc1
    v_mfma_f32_16x16x32_bf16 v[92:95], a[60:63], a[72:75], v[92:95]
    buffer_load_dwordx4 a[68:71], v2, s[8:11], s38 offen offset:1024 sc1
    v_mfma_f32_16x16x32_bf16 v[124:127], a[60:63], a[76:79], v[124:127]
    s_add_u32 s38, s38, 16384
    s_waitcnt vmcnt(16) lgkmcnt(0)
    v_mfma_f32_16x16x32_bf16 v[64:67], a[0:3], a[80:83], v[64:67]
    ds_read_b64_tr_b16 a[32:33], v22 offset:24576
    ds_read_b64_tr_b16 a[34:35], v22 offset:28672
    v_mfma_f32_16x16x32_bf16 v[96:99], a[0:3], a[84:87], v[96:99]
    ds_read_b64_tr_b16 a[36:37], v23 offset:24576
    v_mfma_f32_16x16x32_bf16 v[68:71], a[4:7], a[80:83], v[68:71]
    ds_read_b64_tr_b16 a[38:39], v23 offset:28672
    ds_read_b64_tr_b16 a[40:41], v24 offset:24576
    v_mfma_f32_16x16x32_bf16 v[100:103], a[4:7], a[84:87], v[100:103]
    ds_read_b64_tr_b16 a[42:43], v24 offset:28672
    v_mfma_f32_16x16x32_bf16 v[72:75], a[8:11], a[80:83], v[72:75]
    ds_read_b64_tr_b16 a[44:45], v25 offset:24576
    ds_read_b64_tr_b16 a[46:47], v25 offset:28672
    v_mfma_f32_16x16x32_bf16 v[104:107], a[8:11], a[84:87], v[104:107]
    ds_read_b64_tr_b16 a[48:49], v26 offset:24576
    v_mfma_f32_16x16x32_bf16 v[76:79], a[12:15], a[80:83], v[76:79]
    ds_read_b64_tr_b16 a[50:51], v26 offset:28672
    ds_read_b64_tr_b16 a[52:53], v27 offset:24576
    v_mfma_f32_16x16x32_bf16 v[108:111], a[12:15], a[84:87], v[108:111]
    ds_read_b64_tr_b16 a[54:55], v27 offset:28672
    v_mfma_f32_16x16x32_bf16 v[80:83], a[16:19], a[80:83], v[80:83]
    ds_read_b64_tr_b16 a[56:57], v28 offset:24576
    ds_read_b64_tr_b16 a[58:59], v28 offset:28672
    v_mfma_f32_16x16x32_bf16 v[112:115], a[16:19], a[84:87], v[112:115]
    ds_read_b64_tr_b16 a[60:61], v29 offset:24576
    v_mfma_f32_16x16x32_bf16 v[84:87], a[20:23], a[80:83], v[84:87]
    ds_read_b64_tr_b16 a[62:63], v29 offset:28672
    v_mfma_f32_16x16x32_bf16 v[116:119], a[20:23], a[84:87], v[116:119]
    buffer_load_dwordx4 a[72:75], v2, s[8:11], s39 offen sc1
    buffer_load_dwordx4 a[76:79], v2, s[8:11], s39 offen offset:1024 sc1
    v_mfma_f32_16x16x32_bf16 v[88:91], a[24:27], a[80:83], v[88:91]
    s_add_u32 s39, s39, 16384
    s_waitcnt vmcnt(38) lgkmcnt(0)
    s_barrier
    v_mfma_f32_16x16x32_bf16 v[120:123], a[24:27], a[84:87], v[120:123]
    s_mov_b32 m0, s25
    v_mfma_f32_16x16x32_bf16 v[92:95], a[28:31], a[80:83], v[92:95]
    buffer_load_dwordx4 v4, s[12:15], s40 offen lds
    v_mfma_f32_16x16x32_bf16 v[124:127], a[28:31], a[84:87], v[124:127]
    s_waitcnt vmcnt(17)
    v_mfma_f32_16x16x32_bf16 v[64:67], a[32:35], a[88:91], v[64:67]
    ds_read_b64_tr_b16 a[0:1], v22 offset:32768
    ds_read_b64_tr_b16 a[2:3], v22 offset:36864
    v_mfma_f32_16x16x32_bf16 v[96:99], a[32:35], a[92:95], v[96:99]
    ds_read_b64_tr_b16 a[4:5], v23 offset:32768
    v_mfma_f32_16x16x32_bf16 v[68:71], a[36:39], a[88:91], v[68:71]
    buffer_load_dwordx4 v5, s[12:15], s40 offen offset:1024 lds
    ds_read_b64_tr_b16 a[6:7], v23 offset:36864
    v_mfma_f32_16x16x32_bf16 v[100:103], a[36:39], a[92:95], v[100:103]
    ds_read_b64_tr_b16 a[8:9], v24 offset:32768
    ds_read_b64_tr_b16 a[10:11], v24 offset:36864
    v_mfma_f32_16x16x32_bf16 v[72:75], a[40:43], a[88:91], v[72:75]
    ds_read_b64_tr_b16 a[12:13], v25 offset:32768
    ds_read_b64_tr_b16 a[14:15], v25 offset:36864
    v_mfma_f32_16x16x32_bf16 v[104:107], a[40:43], a[92:95], v[104:107]
    ds_read_b64_tr_b16 a[16:17], v26 offset:32768
    v_mfma_f32_16x16x32_bf16 v[76:79], a[44:47], a[88:91], v[76:79]
    buffer_load_dwordx4 v6, s[12:15], s40 offen offset:2048 lds
    ds_read_b64_tr_b16 a[18:19], v26 offset:36864
    v_mfma_f32_16x16x32_bf16 v[108:111], a[44:47], a[92:95], v[108:111]
    ds_read_b64_tr_b16 a[20:21], v27 offset:32768
    ds_read_b64_tr_b16 a[22:23], v27 offset:36864
    v_mfma_f32_16x16x32_bf16 v[80:83], a[48:51], a[88:91], v[80:83]
    ds_read_b64_tr_b16 a[24:25], v28 offset:32768
    ds_read_b64_tr_b16 a[26:27], v28 offset:36864
    v_mfma_f32_16x16x32_bf16 v[112:115], a[48:51], a[92:95], v[112:115]
    ds_read_b64_tr_b16 a[28:29], v29 offset:32768
    v_mfma_f32_16x16x32_bf16 v[84:87], a[52:55], a[88:91], v[84:87]
    buffer_load_dwordx4 v7, s[12:15], s40 offen offset:3072 lds
    ds_read_b64_tr_b16 a[30:31], v29 offset:36864
    v_mfma_f32_16x16x32_bf16 v[116:119], a[52:55], a[92:95], v[116:119]
    s_add_u32 s40, s40, 131072
    v_mfma_f32_16x16x32_bf16 v[88:91], a[56:59], a[88:91], v[88:91]
    v_mfma_f32_16x16x32_bf16 v[120:123], a[56:59], a[92:95], v[120:123]
    buffer_load_dwordx4 a[80:83], v2, s[8:11], s38 offen sc1
    v_mfma_f32_16x16x32_bf16 v[92:95], a[60:63], a[88:91], v[92:95]
    buffer_load_dwordx4 a[84:87], v2, s[8:11], s38 offen offset:1024 sc1
    v_mfma_f32_16x16x32_bf16 v[124:127], a[60:63], a[92:95], v[124:127]
    s_add_u32 s38, s38, 16384
    s_waitcnt vmcnt(20) lgkmcnt(0)
    v_mfma_f32_16x16x32_bf16 v[64:67], a[0:3], a[96:99], v[64:67]
    ds_read_b64_tr_b16 a[32:33], v22 offset:40960
    ds_read_b64_tr_b16 a[34:35], v22 offset:45056
    v_mfma_f32_16x16x32_bf16 v[96:99], a[0:3], a[100:103], v[96:99]
    ds_read_b64_tr_b16 a[36:37], v23 offset:40960
    v_mfma_f32_16x16x32_bf16 v[68:71], a[4:7], a[96:99], v[68:71]
    ds_read_b64_tr_b16 a[38:39], v23 offset:45056
    ds_read_b64_tr_b16 a[40:41], v24 offset:40960
    v_mfma_f32_16x16x32_bf16 v[100:103], a[4:7], a[100:103], v[100:103]
    ds_read_b64_tr_b16 a[42:43], v24 offset:45056
    v_mfma_f32_16x16x32_bf16 v[72:75], a[8:11], a[96:99], v[72:75]
    ds_read_b64_tr_b16 a[44:45], v25 offset:40960
    ds_read_b64_tr_b16 a[46:47], v25 offset:45056
    v_mfma_f32_16x16x32_bf16 v[104:107], a[8:11], a[100:103], v[104:107]
    ds_read_b64_tr_b16 a[48:49], v26 offset:40960
    v_mfma_f32_16x16x32_bf16 v[76:79], a[12:15], a[96:99], v[76:79]
    ds_read_b64_tr_b16 a[50:51], v26 offset:45056
    ds_read_b64_tr_b16 a[52:53], v27 offset:40960
    v_mfma_f32_16x16x32_bf16 v[108:111], a[12:15], a[100:103], v[108:111]
    ds_read_b64_tr_b16 a[54:55], v27 offset:45056
    v_mfma_f32_16x16x32_bf16 v[80:83], a[16:19], a[96:99], v[80:83]
    ds_read_b64_tr_b16 a[56:57], v28 offset:40960
    ds_read_b64_tr_b16 a[58:59], v28 offset:45056
    v_mfma_f32_16x16x32_bf16 v[112:115], a[16:19], a[100:103], v[112:115]
    ds_read_b64_tr_b16 a[60:61], v29 offset:40960
    v_mfma_f32_16x16x32_bf16 v[84:87], a[20:23], a[96:99], v[84:87]
    ds_read_b64_tr_b16 a[62:63], v29 offset:45056
    v_mfma_f32_16x16x32_bf16 v[116:119], a[20:23], a[100:103], v[116:119]
    buffer_load_dwordx4 a[88:91], v2, s[8:11], s39 offen sc1
    buffer_load_dwordx4 a[92:95], v2, s[8:11], s39 offen offset:1024 sc1
    v_mfma_f32_16x16x32_bf16 v[88:91], a[24:27], a[96:99], v[88:91]
    s_add_u32 s39, s39, 16384
    s_waitcnt vmcnt(42) lgkmcnt(0)
    s_barrier
    v_mfma_f32_16x16x32_bf16 v[120:123], a[24:27], a[100:103], v[120:123]
    s_mov_b32 m0, s26
    v_mfma_f32_16x16x32_bf16 v[92:95], a[28:31], a[96:99], v[92:95]
    buffer_load_dwordx4 v4, s[12:15], s40 offen lds
    v_mfma_f32_16x16x32_bf16 v[124:127], a[28:31], a[100:103], v[124:127]
    s_waitcnt vmcnt(21)
    v_mfma_f32_16x16x32_bf16 v[64:67], a[32:35], a[104:107], v[64:67]
    ds_read_b64_tr_b16 a[0:1], v22 offset:49152
    ds_read_b64_tr_b16 a[2:3], v22 offset:53248
    v_mfma_f32_16x16x32_bf16 v[96:99], a[32:35], a[108:111], v[96:99]
    ds_read_b64_tr_b16 a[4:5], v23 offset:49152
    v_mfma_f32_16x16x32_bf16 v[68:71], a[36:39], a[104:107], v[68:71]
    buffer_load_dwordx4 v5, s[12:15], s40 offen offset:1024 lds
    ds_read_b64_tr_b16 a[6:7], v23 offset:53248
    v_mfma_f32_16x16x32_bf16 v[100:103], a[36:39], a[108:111], v[100:103]
    ds_read_b64_tr_b16 a[8:9], v24 offset:49152
    ds_read_b64_tr_b16 a[10:11], v24 offset:53248
    v_mfma_f32_16x16x32_bf16 v[72:75], a[40:43], a[104:107], v[72:75]
    ds_read_b64_tr_b16 a[12:13], v25 offset:49152
    ds_read_b64_tr_b16 a[14:15], v25 offset:53248
    v_mfma_f32_16x16x32_bf16 v[104:107], a[40:43], a[108:111], v[104:107]
    ds_read_b64_tr_b16 a[16:17], v26 offset:49152
    v_mfma_f32_16x16x32_bf16 v[76:79], a[44:47], a[104:107], v[76:79]
    buffer_load_dwordx4 v6, s[12:15], s40 offen offset:2048 lds
    ds_read_b64_tr_b16 a[18:19], v26 offset:53248
    v_mfma_f32_16x16x32_bf16 v[108:111], a[44:47], a[108:111], v[108:111]
    ds_read_b64_tr_b16 a[20:21], v27 offset:49152
    ds_read_b64_tr_b16 a[22:23], v27 offset:53248
    v_mfma_f32_16x16x32_bf16 v[80:83], a[48:51], a[104:107], v[80:83]
    ds_read_b64_tr_b16 a[24:25], v28 offset:49152
    ds_read_b64_tr_b16 a[26:27], v28 offset:53248
    v_mfma_f32_16x16x32_bf16 v[112:115], a[48:51], a[108:111], v[112:115]
    ds_read_b64_tr_b16 a[28:29], v29 offset:49152
    v_mfma_f32_16x16x32_bf16 v[84:87], a[52:55], a[104:107], v[84:87]
    buffer_load_dwordx4 v7, s[12:15], s40 offen offset:3072 lds
    ds_read_b64_tr_b16 a[30:31], v29 offset:53248
    v_mfma_f32_16x16x32_bf16 v[116:119], a[52:55], a[108:111], v[116:119]
    s_add_u32 s40, s40, 131072
    v_mfma_f32_16x16x32_bf16 v[88:91], a[56:59], a[104:107], v[88:91]
    v_mfma_f32_16x16x32_bf16 v[120:123], a[56:59], a[108:111], v[120:123]
    buffer_load_dwordx4 a[96:99], v2, s[8:11], s38 offen sc1
    v_mfma_f32_16x16x32_bf16 v[92:95], a[60:63], a[104:107], v[92:95]
    buffer_load_dwordx4 a[100:103], v2, s[8:11], s38 offen offset:1024 sc1
    v_mfma_f32_16x16x32_bf16 v[124:127], a[60:63], a[108:111], v[124:127]
    s_add_u32 s38, s38, 16384
    s_waitcnt vmcnt(24) lgkmcnt(0)
    v_mfma_f32_16x16x32_bf16 v[64:67], a[0:3], a[112:115], v[64:67]
    ds_read_b64_tr_b16 a[32:33], v22 offset:57344
    ds_read_b64_tr_b16 a[34:35], v22 offset:61440
    v_mfma_f32_16x16x32_bf16 v[96:99], a[0:3], a[116:119], v[96:99]
    ds_read_b64_tr_b16 a[36:37], v23 offset:57344
    v_mfma_f32_16x16x32_bf16 v[68:71], a[4:7], a[112:115], v[68:71]
    ds_read_b64_tr_b16 a[38:39], v23 offset:61440
    ds_read_b64_tr_b16 a[40:41], v24 offset:57344
    v_mfma_f32_16x16x32_bf16 v[100:103], a[4:7], a[116:119], v[100:103]
    ds_read_b64_tr_b16 a[42:43], v24 offset:61440
    v_mfma_f32_16x16x32_bf16 v[72:75], a[8:11], a[112:115], v[72:75]
    ds_read_b64_tr_b16 a[44:45], v25 offset:57344
    ds_read_b64_tr_b16 a[46:47], v25 offset:61440
    v_mfma_f32_16x16x32_bf16 v[104:107], a[8:11], a[116:119], v[104:107]
    ds_read_b64_tr_b16 a[48:49], v26 offset:57344
    v_mfma_f32_16x16x32_bf16 v[76:79], a[12:15], a[112:115], v[76:79]
    ds_read_b64_tr_b16 a[50:51], v26 offset:61440
    ds_read_b64_tr_b16 a[52:53], v27 offset:57344
    v_mfma_f32_16x16x32_bf16 v[108:111], a[12:15], a[116:119], v[108:111]
    ds_read_b64_tr_b16 a[54:55], v27 offset:61440
    v_mfma_f32_16x16x32_bf16 v[80:83], a[16:19], a[112:115], v[80:83]
    ds_read_b64_tr_b16 a[56:57], v28 offset:57344
    ds_read_b64_tr_b16 a[58:59], v28 offset:61440
    v_mfma_f32_16x16x32_bf16 v[112:115], a[16:19], a[116:119], v[112:115]
    ds_read_b64_tr_b16 a[60:61], v29 offset:57344
    v_mfma_f32_16x16x32_bf16 v[84:87], a[20:23], a[112:115], v[84:87]
    ds_read_b64_tr_b16 a[62:63], v29 offset:61440
    v_mfma_f32_16x16x32_bf16 v[116:119], a[20:23], a[116:119], v[116:119]
    buffer_load_dwordx4 a[104:107], v2, s[8:11], s39 offen sc1
    buffer_load_dwordx4 a[108:111], v2, s[8:11], s39 offen offset:1024 sc1
    v_mfma_f32_16x16x32_bf16 v[88:91], a[24:27], a[112:115], v[88:91]
    s_add_u32 s39, s39, 16384
    s_waitcnt vmcnt(20) lgkmcnt(0)
    s_barrier
    v_mfma_f32_16x16x32_bf16 v[120:123], a[24:27], a[116:119], v[120:123]
    s_mov_b32 m0, s27
    v_mfma_f32_16x16x32_bf16 v[92:95], a[28:31], a[112:115], v[92:95]
    buffer_load_dwordx4 v4, s[12:15], s40 offen lds
    v_mfma_f32_16x16x32_bf16 v[124:127], a[28:31], a[116:119], v[124:127]
    s_waitcnt vmcnt(25)
    v_mfma_f32_16x16x32_bf16 v[64:67], a[32:35], a[120:123], v[64:67]
    ds_read_b64_tr_b16 a[0:1], v22 offset:0
    ds_read_b64_tr_b16 a[2:3], v22 offset:4096
    v_mfma_f32_16x16x32_bf16 v[96:99], a[32:35], a[124:127], v[96:99]
    ds_read_b64_tr_b16 a[4:5], v23 offset:0
    v_mfma_f32_16x16x32_bf16 v[68:71], a[36:39], a[120:123], v[68:71]
    buffer_load_dwordx4 v5, s[12:15], s40 offen offset:1024 lds
    ds_read_b64_tr_b16 a[6:7], v23 offset:4096
    v_mfma_f32_16x16x32_bf16 v[100:103], a[36:39], a[124:127], v[100:103]
    ds_read_b64_tr_b16 a[8:9], v24 offset:0
    ds_read_b64_tr_b16 a[10:11], v24 offset:4096
    v_mfma_f32_16x16x32_bf16 v[72:75], a[40:43], a[120:123], v[72:75]
    ds_read_b64_tr_b16 a[12:13], v25 offset:0
    ds_read_b64_tr_b16 a[14:15], v25 offset:4096
    v_mfma_f32_16x16x32_bf16 v[104:107], a[40:43], a[124:127], v[104:107]
    ds_read_b64_tr_b16 a[16:17], v26 offset:0
    v_mfma_f32_16x16x32_bf16 v[76:79], a[44:47], a[120:123], v[76:79]
    buffer_load_dwordx4 v6, s[12:15], s40 offen offset:2048 lds
    ds_read_b64_tr_b16 a[18:19], v26 offset:4096
    v_mfma_f32_16x16x32_bf16 v[108:111], a[44:47], a[124:127], v[108:111]
    ds_read_b64_tr_b16 a[20:21], v27 offset:0
    ds_read_b64_tr_b16 a[22:23], v27 offset:4096
    v_mfma_f32_16x16x32_bf16 v[80:83], a[48:51], a[120:123], v[80:83]
    ds_read_b64_tr_b16 a[24:25], v28 offset:0
    ds_read_b64_tr_b16 a[26:27], v28 offset:4096
    v_mfma_f32_16x16x32_bf16 v[112:115], a[48:51], a[124:127], v[112:115]
    ds_read_b64_tr_b16 a[28:29], v29 offset:0
    v_mfma_f32_16x16x32_bf16 v[84:87], a[52:55], a[120:123], v[84:87]
    buffer_load_dwordx4 v7, s[12:15], s40 offen offset:3072 lds
    ds_read_b64_tr_b16 a[30:31], v29 offset:4096
    v_mfma_f32_16x16x32_bf16 v[116:119], a[52:55], a[124:127], v[116:119]
    s_add_u32 s40, s40, 131072
    v_mfma_f32_16x16x32_bf16 v[88:91], a[56:59], a[120:123], v[88:91]
    v_mfma_f32_16x16x32_bf16 v[120:123], a[56:59], a[124:127], v[120:123]
    buffer_load_dwordx4 a[112:115], v2, s[8:11], s38 offen sc1
    v_mfma_f32_16x16x32_bf16 v[92:95], a[60:63], a[120:123], v[92:95]
    buffer_load_dwordx4 a[116:119], v2, s[8:11], s38 offen offset:1024 sc1
    v_mfma_f32_16x16x32_bf16 v[124:127], a[60:63], a[124:127], v[124:127]
    s_add_u32 s38, s38, 16384
    s_cmp_eq_u32 s35, 0
    s_mov_b32 s44, 4
    s_cselect_b32 s36, 8, s44
.p2align 6
gated_mix__linear_kernel_hedgehog__mixer_channel_mlp__prompt_kernel_s2_loop:
    s_waitcnt vmcnt(24) lgkmcnt(0)
    v_mfma_f32_16x16x32_bf16 v[64:67], a[0:3], a[64:67], v[64:67]
    ds_read_b64_tr_b16 a[32:33], v22 offset:8192
    ds_read_b64_tr_b16 a[34:35], v22 offset:12288
    v_mfma_f32_16x16x32_bf16 v[96:99], a[0:3], a[68:71], v[96:99]
    ds_read_b64_tr_b16 a[36:37], v23 offset:8192
    v_mfma_f32_16x16x32_bf16 v[68:71], a[4:7], a[64:67], v[68:71]
    ds_read_b64_tr_b16 a[38:39], v23 offset:12288
    ds_read_b64_tr_b16 a[40:41], v24 offset:8192
    v_mfma_f32_16x16x32_bf16 v[100:103], a[4:7], a[68:71], v[100:103]
    ds_read_b64_tr_b16 a[42:43], v24 offset:12288
    v_mfma_f32_16x16x32_bf16 v[72:75], a[8:11], a[64:67], v[72:75]
    ds_read_b64_tr_b16 a[44:45], v25 offset:8192
    ds_read_b64_tr_b16 a[46:47], v25 offset:12288
    v_mfma_f32_16x16x32_bf16 v[104:107], a[8:11], a[68:71], v[104:107]
    ds_read_b64_tr_b16 a[48:49], v26 offset:8192
    v_mfma_f32_16x16x32_bf16 v[76:79], a[12:15], a[64:67], v[76:79]
    ds_read_b64_tr_b16 a[50:51], v26 offset:12288
    ds_read_b64_tr_b16 a[52:53], v27 offset:8192
    v_mfma_f32_16x16x32_bf16 v[108:111], a[12:15], a[68:71], v[108:111]
    ds_read_b64_tr_b16 a[54:55], v27 offset:12288
    v_mfma_f32_16x16x32_bf16 v[80:83], a[16:19], a[64:67], v[80:83]
    ds_read_b64_tr_b16 a[56:57], v28 offset:8192
    ds_read_b64_tr_b16 a[58:59], v28 offset:12288
    v_mfma_f32_16x16x32_bf16 v[112:115], a[16:19], a[68:71], v[112:115]
    ds_read_b64_tr_b16 a[60:61], v29 offset:8192
    v_mfma_f32_16x16x32_bf16 v[84:87], a[20:23], a[64:67], v[84:87]
    ds_read_b64_tr_b16 a[62:63], v29 offset:12288
    v_mfma_f32_16x16x32_bf16 v[116:119], a[20:23], a[68:71], v[116:119]
    buffer_load_dwordx4 a[120:123], v2, s[8:11], s39 offen sc1
    buffer_load_dwordx4 a[124:127], v2, s[8:11], s39 offen offset:1024 sc1
    v_mfma_f32_16x16x32_bf16 v[88:91], a[24:27], a[64:67], v[88:91]
    s_add_u32 s39, s39, 16384
    s_waitcnt vmcnt(20) lgkmcnt(0)
    s_barrier
    v_mfma_f32_16x16x32_bf16 v[120:123], a[24:27], a[68:71], v[120:123]
    s_add_u32 s41, s41, 4
    s_cmp_eq_u32 s41, s42
    v_mfma_f32_16x16x32_bf16 v[92:95], a[28:31], a[64:67], v[92:95]
    s_cselect_b32 s12, s56, s12
    s_cselect_b32 s13, s57, s13
    v_mfma_f32_16x16x32_bf16 v[124:127], a[28:31], a[68:71], v[124:127]
    s_cselect_b32 s14, s58, s14
    s_cselect_b32 s40, 0, s40
    s_mov_b32 m0, s24
    s_waitcnt vmcnt(24)
    v_mfma_f32_16x16x32_bf16 v[64:67], a[32:35], a[72:75], v[64:67]
    ds_read_b64_tr_b16 a[0:1], v22 offset:16384
    ds_read_b64_tr_b16 a[2:3], v22 offset:20480
    v_mfma_f32_16x16x32_bf16 v[96:99], a[32:35], a[76:79], v[96:99]
    buffer_load_dwordx4 v4, s[12:15], s40 offen lds
    ds_read_b64_tr_b16 a[4:5], v23 offset:16384
    v_mfma_f32_16x16x32_bf16 v[68:71], a[36:39], a[72:75], v[68:71]
    ds_read_b64_tr_b16 a[6:7], v23 offset:20480
    ds_read_b64_tr_b16 a[8:9], v24 offset:16384
    v_mfma_f32_16x16x32_bf16 v[100:103], a[36:39], a[76:79], v[100:103]
    ds_read_b64_tr_b16 a[10:11], v24 offset:20480
    v_mfma_f32_16x16x32_bf16 v[72:75], a[40:43], a[72:75], v[72:75]
    buffer_load_dwordx4 v5, s[12:15], s40 offen offset:1024 lds
    ds_read_b64_tr_b16 a[12:13], v25 offset:16384
    v_mfma_f32_16x16x32_bf16 v[104:107], a[40:43], a[76:79], v[104:107]
    ds_read_b64_tr_b16 a[14:15], v25 offset:20480
    ds_read_b64_tr_b16 a[16:17], v26 offset:16384
    v_mfma_f32_16x16x32_bf16 v[76:79], a[44:47], a[72:75], v[76:79]
    ds_read_b64_tr_b16 a[18:19], v26 offset:20480
    ds_read_b64_tr_b16 a[20:21], v27 offset:16384
    v_mfma_f32_16x16x32_bf16 v[108:111], a[44:47], a[76:79], v[108:111]
    buffer_load_dwordx4 v6, s[12:15], s40 offen offset:2048 lds
    ds_read_b64_tr_b16 a[22:23], v27 offset:20480
    v_mfma_f32_16x16x32_bf16 v[80:83], a[48:51], a[72:75], v[80:83]
    ds_read_b64_tr_b16 a[24:25], v28 offset:16384
    ds_read_b64_tr_b16 a[26:27], v28 offset:20480
    v_mfma_f32_16x16x32_bf16 v[112:115], a[48:51], a[76:79], v[112:115]
    ds_read_b64_tr_b16 a[28:29], v29 offset:16384
    v_mfma_f32_16x16x32_bf16 v[84:87], a[52:55], a[72:75], v[84:87]
    buffer_load_dwordx4 v7, s[12:15], s40 offen offset:3072 lds
    ds_read_b64_tr_b16 a[30:31], v29 offset:20480
    v_mfma_f32_16x16x32_bf16 v[116:119], a[52:55], a[76:79], v[116:119]
    s_add_u32 s40, s40, 131072
    v_mfma_f32_16x16x32_bf16 v[88:91], a[56:59], a[72:75], v[88:91]
    v_mfma_f32_16x16x32_bf16 v[120:123], a[56:59], a[76:79], v[120:123]
    buffer_load_dwordx4 a[64:67], v2, s[8:11], s38 offen sc1
    v_mfma_f32_16x16x32_bf16 v[92:95], a[60:63], a[72:75], v[92:95]
    buffer_load_dwordx4 a[68:71], v2, s[8:11], s38 offen offset:1024 sc1
    v_mfma_f32_16x16x32_bf16 v[124:127], a[60:63], a[76:79], v[124:127]
    s_add_u32 s38, s38, 16384
    s_waitcnt vmcnt(24) lgkmcnt(0)
    v_mfma_f32_16x16x32_bf16 v[64:67], a[0:3], a[80:83], v[64:67]
    ds_read_b64_tr_b16 a[32:33], v22 offset:24576
    ds_read_b64_tr_b16 a[34:35], v22 offset:28672
    v_mfma_f32_16x16x32_bf16 v[96:99], a[0:3], a[84:87], v[96:99]
    ds_read_b64_tr_b16 a[36:37], v23 offset:24576
    v_mfma_f32_16x16x32_bf16 v[68:71], a[4:7], a[80:83], v[68:71]
    ds_read_b64_tr_b16 a[38:39], v23 offset:28672
    ds_read_b64_tr_b16 a[40:41], v24 offset:24576
    v_mfma_f32_16x16x32_bf16 v[100:103], a[4:7], a[84:87], v[100:103]
    ds_read_b64_tr_b16 a[42:43], v24 offset:28672
    v_mfma_f32_16x16x32_bf16 v[72:75], a[8:11], a[80:83], v[72:75]
    ds_read_b64_tr_b16 a[44:45], v25 offset:24576
    ds_read_b64_tr_b16 a[46:47], v25 offset:28672
    v_mfma_f32_16x16x32_bf16 v[104:107], a[8:11], a[84:87], v[104:107]
    ds_read_b64_tr_b16 a[48:49], v26 offset:24576
    v_mfma_f32_16x16x32_bf16 v[76:79], a[12:15], a[80:83], v[76:79]
    ds_read_b64_tr_b16 a[50:51], v26 offset:28672
    ds_read_b64_tr_b16 a[52:53], v27 offset:24576
    v_mfma_f32_16x16x32_bf16 v[108:111], a[12:15], a[84:87], v[108:111]
    ds_read_b64_tr_b16 a[54:55], v27 offset:28672
    v_mfma_f32_16x16x32_bf16 v[80:83], a[16:19], a[80:83], v[80:83]
    ds_read_b64_tr_b16 a[56:57], v28 offset:24576
    ds_read_b64_tr_b16 a[58:59], v28 offset:28672
    v_mfma_f32_16x16x32_bf16 v[112:115], a[16:19], a[84:87], v[112:115]
    ds_read_b64_tr_b16 a[60:61], v29 offset:24576
    v_mfma_f32_16x16x32_bf16 v[84:87], a[20:23], a[80:83], v[84:87]
    ds_read_b64_tr_b16 a[62:63], v29 offset:28672
    v_mfma_f32_16x16x32_bf16 v[116:119], a[20:23], a[84:87], v[116:119]
    buffer_load_dwordx4 a[72:75], v2, s[8:11], s39 offen sc1
    buffer_load_dwordx4 a[76:79], v2, s[8:11], s39 offen offset:1024 sc1
    v_mfma_f32_16x16x32_bf16 v[88:91], a[24:27], a[80:83], v[88:91]
    s_add_u32 s39, s39, 16384
    s_waitcnt vmcnt(20) lgkmcnt(0)
    s_barrier
    v_mfma_f32_16x16x32_bf16 v[120:123], a[24:27], a[84:87], v[120:123]
    s_mov_b32 m0, s25
    v_mfma_f32_16x16x32_bf16 v[92:95], a[28:31], a[80:83], v[92:95]
    buffer_load_dwordx4 v4, s[12:15], s40 offen lds
    v_mfma_f32_16x16x32_bf16 v[124:127], a[28:31], a[84:87], v[124:127]
    s_waitcnt vmcnt(25)
    v_mfma_f32_16x16x32_bf16 v[64:67], a[32:35], a[88:91], v[64:67]
    ds_read_b64_tr_b16 a[0:1], v22 offset:32768
    ds_read_b64_tr_b16 a[2:3], v22 offset:36864
    v_mfma_f32_16x16x32_bf16 v[96:99], a[32:35], a[92:95], v[96:99]
    ds_read_b64_tr_b16 a[4:5], v23 offset:32768
    v_mfma_f32_16x16x32_bf16 v[68:71], a[36:39], a[88:91], v[68:71]
    buffer_load_dwordx4 v5, s[12:15], s40 offen offset:1024 lds
    ds_read_b64_tr_b16 a[6:7], v23 offset:36864
    v_mfma_f32_16x16x32_bf16 v[100:103], a[36:39], a[92:95], v[100:103]
    ds_read_b64_tr_b16 a[8:9], v24 offset:32768
    ds_read_b64_tr_b16 a[10:11], v24 offset:36864
    v_mfma_f32_16x16x32_bf16 v[72:75], a[40:43], a[88:91], v[72:75]
    ds_read_b64_tr_b16 a[12:13], v25 offset:32768
    ds_read_b64_tr_b16 a[14:15], v25 offset:36864
    v_mfma_f32_16x16x32_bf16 v[104:107], a[40:43], a[92:95], v[104:107]
    ds_read_b64_tr_b16 a[16:17], v26 offset:32768
    v_mfma_f32_16x16x32_bf16 v[76:79], a[44:47], a[88:91], v[76:79]
    buffer_load_dwordx4 v6, s[12:15], s40 offen offset:2048 lds
    ds_read_b64_tr_b16 a[18:19], v26 offset:36864
    v_mfma_f32_16x16x32_bf16 v[108:111], a[44:47], a[92:95], v[108:111]
    ds_read_b64_tr_b16 a[20:21], v27 offset:32768
    ds_read_b64_tr_b16 a[22:23], v27 offset:36864
    v_mfma_f32_16x16x32_bf16 v[80:83], a[48:51], a[88:91], v[80:83]
    ds_read_b64_tr_b16 a[24:25], v28 offset:32768
    ds_read_b64_tr_b16 a[26:27], v28 offset:36864
    v_mfma_f32_16x16x32_bf16 v[112:115], a[48:51], a[92:95], v[112:115]
    ds_read_b64_tr_b16 a[28:29], v29 offset:32768
    v_mfma_f32_16x16x32_bf16 v[84:87], a[52:55], a[88:91], v[84:87]
    buffer_load_dwordx4 v7, s[12:15], s40 offen offset:3072 lds
    ds_read_b64_tr_b16 a[30:31], v29 offset:36864
    v_mfma_f32_16x16x32_bf16 v[116:119], a[52:55], a[92:95], v[116:119]
    s_add_u32 s40, s40, 131072
    v_mfma_f32_16x16x32_bf16 v[88:91], a[56:59], a[88:91], v[88:91]
    v_mfma_f32_16x16x32_bf16 v[120:123], a[56:59], a[92:95], v[120:123]
    buffer_load_dwordx4 a[80:83], v2, s[8:11], s38 offen sc1
    v_mfma_f32_16x16x32_bf16 v[92:95], a[60:63], a[88:91], v[92:95]
    buffer_load_dwordx4 a[84:87], v2, s[8:11], s38 offen offset:1024 sc1
    v_mfma_f32_16x16x32_bf16 v[124:127], a[60:63], a[92:95], v[124:127]
    s_add_u32 s38, s38, 16384
    s_waitcnt vmcnt(24) lgkmcnt(0)
    v_mfma_f32_16x16x32_bf16 v[64:67], a[0:3], a[96:99], v[64:67]
    ds_read_b64_tr_b16 a[32:33], v22 offset:40960
    ds_read_b64_tr_b16 a[34:35], v22 offset:45056
    v_mfma_f32_16x16x32_bf16 v[96:99], a[0:3], a[100:103], v[96:99]
    ds_read_b64_tr_b16 a[36:37], v23 offset:40960
    v_mfma_f32_16x16x32_bf16 v[68:71], a[4:7], a[96:99], v[68:71]
    ds_read_b64_tr_b16 a[38:39], v23 offset:45056
    ds_read_b64_tr_b16 a[40:41], v24 offset:40960
    v_mfma_f32_16x16x32_bf16 v[100:103], a[4:7], a[100:103], v[100:103]
    ds_read_b64_tr_b16 a[42:43], v24 offset:45056
    v_mfma_f32_16x16x32_bf16 v[72:75], a[8:11], a[96:99], v[72:75]
    ds_read_b64_tr_b16 a[44:45], v25 offset:40960
    ds_read_b64_tr_b16 a[46:47], v25 offset:45056
    v_mfma_f32_16x16x32_bf16 v[104:107], a[8:11], a[100:103], v[104:107]
    ds_read_b64_tr_b16 a[48:49], v26 offset:40960
    v_mfma_f32_16x16x32_bf16 v[76:79], a[12:15], a[96:99], v[76:79]
    ds_read_b64_tr_b16 a[50:51], v26 offset:45056
    ds_read_b64_tr_b16 a[52:53], v27 offset:40960
    v_mfma_f32_16x16x32_bf16 v[108:111], a[12:15], a[100:103], v[108:111]
    ds_read_b64_tr_b16 a[54:55], v27 offset:45056
    v_mfma_f32_16x16x32_bf16 v[80:83], a[16:19], a[96:99], v[80:83]
    ds_read_b64_tr_b16 a[56:57], v28 offset:40960
    ds_read_b64_tr_b16 a[58:59], v28 offset:45056
    v_mfma_f32_16x16x32_bf16 v[112:115], a[16:19], a[100:103], v[112:115]
    ds_read_b64_tr_b16 a[60:61], v29 offset:40960
    v_mfma_f32_16x16x32_bf16 v[84:87], a[20:23], a[96:99], v[84:87]
    ds_read_b64_tr_b16 a[62:63], v29 offset:45056
    v_mfma_f32_16x16x32_bf16 v[116:119], a[20:23], a[100:103], v[116:119]
    buffer_load_dwordx4 a[88:91], v2, s[8:11], s39 offen sc1
    buffer_load_dwordx4 a[92:95], v2, s[8:11], s39 offen offset:1024 sc1
    v_mfma_f32_16x16x32_bf16 v[88:91], a[24:27], a[96:99], v[88:91]
    s_add_u32 s39, s39, 16384
    s_waitcnt vmcnt(20) lgkmcnt(0)
    s_barrier
    v_mfma_f32_16x16x32_bf16 v[120:123], a[24:27], a[100:103], v[120:123]
    s_mov_b32 m0, s26
    v_mfma_f32_16x16x32_bf16 v[92:95], a[28:31], a[96:99], v[92:95]
    buffer_load_dwordx4 v4, s[12:15], s40 offen lds
    v_mfma_f32_16x16x32_bf16 v[124:127], a[28:31], a[100:103], v[124:127]
    s_waitcnt vmcnt(25)
    v_mfma_f32_16x16x32_bf16 v[64:67], a[32:35], a[104:107], v[64:67]
    ds_read_b64_tr_b16 a[0:1], v22 offset:49152
    ds_read_b64_tr_b16 a[2:3], v22 offset:53248
    v_mfma_f32_16x16x32_bf16 v[96:99], a[32:35], a[108:111], v[96:99]
    ds_read_b64_tr_b16 a[4:5], v23 offset:49152
    v_mfma_f32_16x16x32_bf16 v[68:71], a[36:39], a[104:107], v[68:71]
    buffer_load_dwordx4 v5, s[12:15], s40 offen offset:1024 lds
    ds_read_b64_tr_b16 a[6:7], v23 offset:53248
    v_mfma_f32_16x16x32_bf16 v[100:103], a[36:39], a[108:111], v[100:103]
    ds_read_b64_tr_b16 a[8:9], v24 offset:49152
    ds_read_b64_tr_b16 a[10:11], v24 offset:53248
    v_mfma_f32_16x16x32_bf16 v[72:75], a[40:43], a[104:107], v[72:75]
    ds_read_b64_tr_b16 a[12:13], v25 offset:49152
    ds_read_b64_tr_b16 a[14:15], v25 offset:53248
    v_mfma_f32_16x16x32_bf16 v[104:107], a[40:43], a[108:111], v[104:107]
    ds_read_b64_tr_b16 a[16:17], v26 offset:49152
    v_mfma_f32_16x16x32_bf16 v[76:79], a[44:47], a[104:107], v[76:79]
    buffer_load_dwordx4 v6, s[12:15], s40 offen offset:2048 lds
    ds_read_b64_tr_b16 a[18:19], v26 offset:53248
    v_mfma_f32_16x16x32_bf16 v[108:111], a[44:47], a[108:111], v[108:111]
    ds_read_b64_tr_b16 a[20:21], v27 offset:49152
    ds_read_b64_tr_b16 a[22:23], v27 offset:53248
    v_mfma_f32_16x16x32_bf16 v[80:83], a[48:51], a[104:107], v[80:83]
    ds_read_b64_tr_b16 a[24:25], v28 offset:49152
    ds_read_b64_tr_b16 a[26:27], v28 offset:53248
    v_mfma_f32_16x16x32_bf16 v[112:115], a[48:51], a[108:111], v[112:115]
    ds_read_b64_tr_b16 a[28:29], v29 offset:49152
    v_mfma_f32_16x16x32_bf16 v[84:87], a[52:55], a[104:107], v[84:87]
    buffer_load_dwordx4 v7, s[12:15], s40 offen offset:3072 lds
    ds_read_b64_tr_b16 a[30:31], v29 offset:53248
    v_mfma_f32_16x16x32_bf16 v[116:119], a[52:55], a[108:111], v[116:119]
    s_add_u32 s40, s40, 131072
    v_mfma_f32_16x16x32_bf16 v[88:91], a[56:59], a[104:107], v[88:91]
    v_mfma_f32_16x16x32_bf16 v[120:123], a[56:59], a[108:111], v[120:123]
    buffer_load_dwordx4 a[96:99], v2, s[8:11], s38 offen sc1
    v_mfma_f32_16x16x32_bf16 v[92:95], a[60:63], a[104:107], v[92:95]
    buffer_load_dwordx4 a[100:103], v2, s[8:11], s38 offen offset:1024 sc1
    v_mfma_f32_16x16x32_bf16 v[124:127], a[60:63], a[108:111], v[124:127]
    s_add_u32 s38, s38, 16384
    s_waitcnt vmcnt(24) lgkmcnt(0)
    v_mfma_f32_16x16x32_bf16 v[64:67], a[0:3], a[112:115], v[64:67]
    ds_read_b64_tr_b16 a[32:33], v22 offset:57344
    ds_read_b64_tr_b16 a[34:35], v22 offset:61440
    v_mfma_f32_16x16x32_bf16 v[96:99], a[0:3], a[116:119], v[96:99]
    ds_read_b64_tr_b16 a[36:37], v23 offset:57344
    v_mfma_f32_16x16x32_bf16 v[68:71], a[4:7], a[112:115], v[68:71]
    ds_read_b64_tr_b16 a[38:39], v23 offset:61440
    ds_read_b64_tr_b16 a[40:41], v24 offset:57344
    v_mfma_f32_16x16x32_bf16 v[100:103], a[4:7], a[116:119], v[100:103]
    ds_read_b64_tr_b16 a[42:43], v24 offset:61440
    v_mfma_f32_16x16x32_bf16 v[72:75], a[8:11], a[112:115], v[72:75]
    ds_read_b64_tr_b16 a[44:45], v25 offset:57344
    ds_read_b64_tr_b16 a[46:47], v25 offset:61440
    v_mfma_f32_16x16x32_bf16 v[104:107], a[8:11], a[116:119], v[104:107]
    ds_read_b64_tr_b16 a[48:49], v26 offset:57344
    v_mfma_f32_16x16x32_bf16 v[76:79], a[12:15], a[112:115], v[76:79]
    ds_read_b64_tr_b16 a[50:51], v26 offset:61440
    ds_read_b64_tr_b16 a[52:53], v27 offset:57344
    v_mfma_f32_16x16x32_bf16 v[108:111], a[12:15], a[116:119], v[108:111]
    ds_read_b64_tr_b16 a[54:55], v27 offset:61440
    v_mfma_f32_16x16x32_bf16 v[80:83], a[16:19], a[112:115], v[80:83]
    ds_read_b64_tr_b16 a[56:57], v28 offset:57344
    ds_read_b64_tr_b16 a[58:59], v28 offset:61440
    v_mfma_f32_16x16x32_bf16 v[112:115], a[16:19], a[116:119], v[112:115]
    ds_read_b64_tr_b16 a[60:61], v29 offset:57344
    v_mfma_f32_16x16x32_bf16 v[84:87], a[20:23], a[112:115], v[84:87]
    ds_read_b64_tr_b16 a[62:63], v29 offset:61440
    v_mfma_f32_16x16x32_bf16 v[116:119], a[20:23], a[116:119], v[116:119]
    buffer_load_dwordx4 a[104:107], v2, s[8:11], s39 offen sc1
    buffer_load_dwordx4 a[108:111], v2, s[8:11], s39 offen offset:1024 sc1
    v_mfma_f32_16x16x32_bf16 v[88:91], a[24:27], a[112:115], v[88:91]
    s_add_u32 s39, s39, 16384
    s_waitcnt vmcnt(20) lgkmcnt(0)
    s_barrier
    v_mfma_f32_16x16x32_bf16 v[120:123], a[24:27], a[116:119], v[120:123]
    s_mov_b32 m0, s27
    v_mfma_f32_16x16x32_bf16 v[92:95], a[28:31], a[112:115], v[92:95]
    buffer_load_dwordx4 v4, s[12:15], s40 offen lds
    v_mfma_f32_16x16x32_bf16 v[124:127], a[28:31], a[116:119], v[124:127]
    s_waitcnt vmcnt(25)
    v_mfma_f32_16x16x32_bf16 v[64:67], a[32:35], a[120:123], v[64:67]
    ds_read_b64_tr_b16 a[0:1], v22 offset:0
    ds_read_b64_tr_b16 a[2:3], v22 offset:4096
    v_mfma_f32_16x16x32_bf16 v[96:99], a[32:35], a[124:127], v[96:99]
    ds_read_b64_tr_b16 a[4:5], v23 offset:0
    v_mfma_f32_16x16x32_bf16 v[68:71], a[36:39], a[120:123], v[68:71]
    buffer_load_dwordx4 v5, s[12:15], s40 offen offset:1024 lds
    ds_read_b64_tr_b16 a[6:7], v23 offset:4096
    v_mfma_f32_16x16x32_bf16 v[100:103], a[36:39], a[124:127], v[100:103]
    ds_read_b64_tr_b16 a[8:9], v24 offset:0
    ds_read_b64_tr_b16 a[10:11], v24 offset:4096
    v_mfma_f32_16x16x32_bf16 v[72:75], a[40:43], a[120:123], v[72:75]
    ds_read_b64_tr_b16 a[12:13], v25 offset:0
    ds_read_b64_tr_b16 a[14:15], v25 offset:4096
    v_mfma_f32_16x16x32_bf16 v[104:107], a[40:43], a[124:127], v[104:107]
    ds_read_b64_tr_b16 a[16:17], v26 offset:0
    v_mfma_f32_16x16x32_bf16 v[76:79], a[44:47], a[120:123], v[76:79]
    buffer_load_dwordx4 v6, s[12:15], s40 offen offset:2048 lds
    ds_read_b64_tr_b16 a[18:19], v26 offset:4096
    v_mfma_f32_16x16x32_bf16 v[108:111], a[44:47], a[124:127], v[108:111]
    ds_read_b64_tr_b16 a[20:21], v27 offset:0
    ds_read_b64_tr_b16 a[22:23], v27 offset:4096
    v_mfma_f32_16x16x32_bf16 v[80:83], a[48:51], a[120:123], v[80:83]
    ds_read_b64_tr_b16 a[24:25], v28 offset:0
    ds_read_b64_tr_b16 a[26:27], v28 offset:4096
    v_mfma_f32_16x16x32_bf16 v[112:115], a[48:51], a[124:127], v[112:115]
    ds_read_b64_tr_b16 a[28:29], v29 offset:0
    v_mfma_f32_16x16x32_bf16 v[84:87], a[52:55], a[120:123], v[84:87]
    buffer_load_dwordx4 v7, s[12:15], s40 offen offset:3072 lds
    ds_read_b64_tr_b16 a[30:31], v29 offset:4096
    v_mfma_f32_16x16x32_bf16 v[116:119], a[52:55], a[124:127], v[116:119]
    s_add_u32 s40, s40, 131072
    v_mfma_f32_16x16x32_bf16 v[88:91], a[56:59], a[120:123], v[88:91]
    v_mfma_f32_16x16x32_bf16 v[120:123], a[56:59], a[124:127], v[120:123]
    buffer_load_dwordx4 a[112:115], v2, s[8:11], s38 offen sc1
    v_mfma_f32_16x16x32_bf16 v[92:95], a[60:63], a[120:123], v[92:95]
    buffer_load_dwordx4 a[116:119], v2, s[8:11], s38 offen offset:1024 sc1
    v_mfma_f32_16x16x32_bf16 v[124:127], a[60:63], a[124:127], v[124:127]
    s_add_u32 s38, s38, 16384
    s_sub_u32 s36, s36, 1
    s_add_u32 s44, s37, s35
    s_cmp_lg_u32 s44, 1
    s_cbranch_scc1 ow_32
    s_cmp_lg_u32 s37, 0
    s_cbranch_scc1 ow_32
    s_cmp_lg_u32 s36, 2
    s_cbranch_scc1 ow_32_b
    global_load_dword v9, v8, s[100:101] sc1
ow_32_b:
    s_cmp_lg_u32 s36, 1
    s_cbranch_scc1 ow_32
    s_mov_b32 s44, 32768
wait_33:
    v_cmp_ne_u32 vcc, 1, v9
    s_nop 4
    s_cbranch_vccz wait_33_ok
    s_sub_u32 s44, s44, 1
    s_cbranch_scc1 wait_33_ok
    s_sleep 1
    global_load_dword v9, v8, s[100:101] sc1
    s_waitcnt vmcnt(0)
    s_branch wait_33
wait_33_ok:
ow_32:
    s_branch pl_34
    s_cmp_lg_u32 s37, 1
    s_cbranch_scc1 pl_34
    s_cmp_lg_u32 s36, 1
    s_cbranch_scc1 pl_34
    s_add_u32 s44, s32, 56
    s_lshl_b32 s44, s44, 2
    v_mov_b32 v8, s44
    global_load_dword v9, v8, s[100:101] sc1
pl_34:
    s_cmp_lg_u32 s36, 0
    s_cbranch_scc1 gated_mix__linear_kernel_hedgehog__mixer_channel_mlp__prompt_kernel_s2_loop
    s_nop 7
    s_cmp_eq_u32 s35, 0
    s_cbranch_scc1 gated_mix__linear_kernel_hedgehog__mixer_channel_mlp__prompt_kernel_s2_publish
    s_cmp_lg_u32 s37, 0
    s_cbranch_scc1 gated_mix__linear_kernel_hedgehog__mixer_channel_mlp__prompt_kernel_s2_final
    v_mov_b64 v[128:129], v[64:65]
    v_mov_b64 v[64:65], 0
    v_mov_b64 v[130:131], v[66:67]
    v_mov_b64 v[66:67], 0
    v_mov_b64 v[132:133], v[68:69]
    v_mov_b64 v[68:69], 0
    v_mov_b64 v[134:135], v[70:71]
    v_mov_b64 v[70:71], 0
    v_mov_b64 v[136:137], v[72:73]
    v_mov_b64 v[72:73], 0
    v_mov_b64 v[138:139], v[74:75]
    v_mov_b64 v[74:75], 0
    v_mov_b64 v[140:141], v[76:77]
    v_mov_b64 v[76:77], 0
    v_mov_b64 v[142:143], v[78:79]
    v_mov_b64 v[78:79], 0
    v_mov_b64 v[144:145], v[80:81]
    v_mov_b64 v[80:81], 0
    v_mov_b64 v[146:147], v[82:83]
    v_mov_b64 v[82:83], 0
    v_mov_b64 v[148:149], v[84:85]
    v_mov_b64 v[84:85], 0
    v_mov_b64 v[150:151], v[86:87]
    v_mov_b64 v[86:87], 0
    v_mov_b64 v[152:153], v[88:89]
    v_mov_b64 v[88:89], 0
    v_mov_b64 v[154:155], v[90:91]
    v_mov_b64 v[90:91], 0
    v_mov_b64 v[156:157], v[92:93]
    v_mov_b64 v[92:93], 0
    v_mov_b64 v[158:159], v[94:95]
    v_mov_b64 v[94:95], 0
    v_mov_b64 v[160:161], v[96:97]
    v_mov_b64 v[96:97], 0
    v_mov_b64 v[162:163], v[98:99]
    v_mov_b64 v[98:99], 0
    v_mov_b64 v[164:165], v[100:101]
    v_mov_b64 v[100:101], 0
    v_mov_b64 v[166:167], v[102:103]
    v_mov_b64 v[102:103], 0
    v_mov_b64 v[168:169], v[104:105]
    v_mov_b64 v[104:105], 0
    v_mov_b64 v[170:171], v[106:107]
    v_mov_b64 v[106:107], 0
    v_mov_b64 v[172:173], v[108:109]
    v_mov_b64 v[108:109], 0
    v_mov_b64 v[174:175], v[110:111]
    v_mov_b64 v[110:111], 0
    v_mov_b64 v[176:177], v[112:113]
    v_mov_b64 v[112:113], 0
    v_mov_b64 v[178:179], v[114:115]
    v_mov_b64 v[114:115], 0
    v_mov_b64 v[180:181], v[116:117]
    v_mov_b64 v[116:117], 0
    v_mov_b64 v[182:183], v[118:119]
    v_mov_b64 v[118:119], 0
    v_mov_b64 v[184:185], v[120:121]
    v_mov_b64 v[120:121], 0
    v_mov_b64 v[186:187], v[122:123]
    v_mov_b64 v[122:123], 0
    v_mov_b64 v[188:189], v[124:125]
    v_mov_b64 v[124:125], 0
    v_mov_b64 v[190:191], v[126:127]
    v_mov_b64 v[126:127], 0
    s_mov_b32 s37, 1
    s_mov_b32 s36, 4
    s_nop 1
    s_branch gated_mix__linear_kernel_hedgehog__mixer_channel_mlp__prompt_kernel_s2_loop
gated_mix__linear_kernel_hedgehog__mixer_channel_mlp__prompt_kernel_s2_publish:
    v_sub_f32 v13, 1.0, v12
    v_sub_f32 v15, 1.0, v14
    s_mov_b32 s46, 0
    v_cvt_pk_bf16_f32 v192, v80, v81
    v_cvt_pk_bf16_f32 v193, v82, v83
    v_cvt_pk_bf16_f32 v194, v84, v85
    v_cvt_pk_bf16_f32 v195, v86, v87
    buffer_store_dwordx4 v[192:195], v3, s[20:23], s46 offen sc1
    v_cvt_pk_bf16_f32 v196, v88, v89
    v_cvt_pk_bf16_f32 v197, v90, v91
    v_cvt_pk_bf16_f32 v198, v92, v93
    v_cvt_pk_bf16_f32 v199, v94, v95
    buffer_store_dwordx4 v[196:199], v3, s[20:23], s46 offen offset:1024 sc1
    v_cvt_pk_bf16_f32 v200, v112, v113
    v_cvt_pk_bf16_f32 v201, v114, v115
    v_cvt_pk_bf16_f32 v202, v116, v117
    v_cvt_pk_bf16_f32 v203, v118, v119
    buffer_store_dwordx4 v[200:203], v3, s[20:23], s46 offen offset:2048 sc1
    v_cvt_pk_bf16_f32 v204, v120, v121
    v_cvt_pk_bf16_f32 v205, v122, v123
    v_cvt_pk_bf16_f32 v206, v124, v125
    v_cvt_pk_bf16_f32 v207, v126, v127
    buffer_store_dwordx4 v[204:207], v3, s[20:23], s46 offen offset:3072 sc1
    v_lshlrev_b32 v18, 16, v32
    v_and_b32 v19, 0xffff0000, v32
    v_lshlrev_b32 v20, 16, v33
    v_and_b32 v21, 0xffff0000, v33
    v_pk_add_f32 v[64:65], v[64:65], v[18:19]
    v_pk_add_f32 v[66:67], v[66:67], v[20:21]
    v_pk_mul_f32 v[64:65], v[64:65], v[12:13] op_sel:[0,1] op_sel_hi:[1,1]
    v_pk_mul_f32 v[66:67], v[66:67], v[12:13] op_sel:[0,1] op_sel_hi:[1,1]
    v_pk_add_f32 v[96:97], v[96:97], v[18:19]
    v_pk_add_f32 v[98:99], v[98:99], v[20:21]
    v_pk_mul_f32 v[96:97], v[96:97], v[14:15] op_sel:[0,1] op_sel_hi:[1,1]
    v_pk_mul_f32 v[98:99], v[98:99], v[14:15] op_sel:[0,1] op_sel_hi:[1,1]
    v_lshlrev_b32 v18, 16, v34
    v_and_b32 v19, 0xffff0000, v34
    v_lshlrev_b32 v20, 16, v35
    v_and_b32 v21, 0xffff0000, v35
    v_pk_add_f32 v[68:69], v[68:69], v[18:19]
    v_pk_add_f32 v[70:71], v[70:71], v[20:21]
    v_pk_mul_f32 v[68:69], v[68:69], v[12:13] op_sel:[0,1] op_sel_hi:[1,1]
    v_pk_mul_f32 v[70:71], v[70:71], v[12:13] op_sel:[0,1] op_sel_hi:[1,1]
    v_pk_add_f32 v[100:101], v[100:101], v[18:19]
    v_pk_add_f32 v[102:103], v[102:103], v[20:21]
    v_pk_mul_f32 v[100:101], v[100:101], v[14:15] op_sel:[0,1] op_sel_hi:[1,1]
    v_pk_mul_f32 v[102:103], v[102:103], v[14:15] op_sel:[0,1] op_sel_hi:[1,1]
    v_lshlrev_b32 v18, 16, v36
    v_and_b32 v19, 0xffff0000, v36
    v_lshlrev_b32 v20, 16, v37
    v_and_b32 v21, 0xffff0000, v37
    v_pk_add_f32 v[72:73], v[72:73], v[18:19]
    v_pk_add_f32 v[74:75], v[74:75], v[20:21]
    v_pk_mul_f32 v[72:73], v[72:73], v[12:13] op_sel:[0,1] op_sel_hi:[1,1]
    v_pk_mul_f32 v[74:75], v[74:75], v[12:13] op_sel:[0,1] op_sel_hi:[1,1]
    v_pk_add_f32 v[104:105], v[104:105], v[18:19]
    v_pk_add_f32 v[106:107], v[106:107], v[20:21]
    v_pk_mul_f32 v[104:105], v[104:105], v[14:15] op_sel:[0,1] op_sel_hi:[1,1]
    v_pk_mul_f32 v[106:107], v[106:107], v[14:15] op_sel:[0,1] op_sel_hi:[1,1]
    v_lshlrev_b32 v18, 16, v38
    v_and_b32 v19, 0xffff0000, v38
    v_lshlrev_b32 v20, 16, v39
    v_and_b32 v21, 0xffff0000, v39
    v_pk_add_f32 v[76:77], v[76:77], v[18:19]
    v_pk_add_f32 v[78:79], v[78:79], v[20:21]
    v_pk_mul_f32 v[76:77], v[76:77], v[12:13] op_sel:[0,1] op_sel_hi:[1,1]
    v_pk_mul_f32 v[78:79], v[78:79], v[12:13] op_sel:[0,1] op_sel_hi:[1,1]
    v_pk_add_f32 v[108:109], v[108:109], v[18:19]
    v_pk_add_f32 v[110:111], v[110:111], v[20:21]
    v_pk_mul_f32 v[108:109], v[108:109], v[14:15] op_sel:[0,1] op_sel_hi:[1,1]
    v_pk_mul_f32 v[110:111], v[110:111], v[14:15] op_sel:[0,1] op_sel_hi:[1,1]
    s_xor_b32 s46, s2, 4
    s_add_u32 s45, s32, 56
    s_add_u32 s72, s52, 23592960
    s_addc_u32 s73, s53, 0
    s_mov_b32 s74, 65536
    s_mov_b32 s75, 0x20000
    v_mov_b32 v8, s46
    v_lshlrev_b32 v8, 6, v8
    v_add_u32 v8, s45, v8
    v_lshlrev_b32 v8, 2, v8
    v_mov_b32 v9, 0x7ffffff0
    v_cmp_gt_u32 vcc, 1, v1
    s_nop 1
    v_cndmask_b32 v8, v9, v8, vcc
    s_lshl_b32 s45, s45, 2
    v_mov_b32 v16, s45
    v_mov_b32 v9, 1
    s_waitcnt vmcnt(0)
    buffer_store_dword v9, v8, s[72:75], 0 offen sc1
    global_load_dword v17, v16, s[100:101] sc1
    s_waitcnt vmcnt(0)
    s_mov_b32 s44, 32768
wait_35:
    v_cmp_ne_u32 vcc, 1, v17
    s_nop 4
    s_cbranch_vccz wait_35_ok
    s_sub_u32 s44, s44, 1
    s_cbranch_scc1 wait_35_ok
    s_sleep 1
    global_load_dword v17, v16, s[100:101] sc1
    s_waitcnt vmcnt(0)
    s_branch wait_35
wait_35_ok:
    s_mov_b32 s46, 16384
    buffer_load_dwordx4 v[192:195], v3, s[20:23], s46 offen sc1
    buffer_load_dwordx4 v[196:199], v3, s[20:23], s46 offen offset:1024 sc1
    buffer_load_dwordx4 v[200:203], v3, s[20:23], s46 offen offset:2048 sc1
    buffer_load_dwordx4 v[204:207], v3, s[20:23], s46 offen offset:3072 sc1
    s_waitcnt vmcnt(3)
    v_lshlrev_b32 v56, 16, v192
    v_and_b32 v57, 0xffff0000, v192
    v_lshlrev_b32 v58, 16, v193
    v_and_b32 v59, 0xffff0000, v193
    v_pk_add_f32 v[64:65], v[64:65], v[56:57]
    v_pk_add_f32 v[66:67], v[66:67], v[58:59]
    v_cvt_pk_bf16_f32 v48, v64, v65
    v_cvt_pk_bf16_f32 v49, v66, v67
    v_lshlrev_b32 v56, 16, v194
    v_and_b32 v57, 0xffff0000, v194
    v_lshlrev_b32 v58, 16, v195
    v_and_b32 v59, 0xffff0000, v195
    v_pk_add_f32 v[68:69], v[68:69], v[56:57]
    v_pk_add_f32 v[70:71], v[70:71], v[58:59]
    v_cvt_pk_bf16_f32 v50, v68, v69
    v_cvt_pk_bf16_f32 v51, v70, v71
    s_nop 0
    v_permlane16_swap_b32 v48, v50
    v_permlane16_swap_b32 v49, v51
    buffer_store_dwordx4 v[48:51], v10, s[16:19], 0 offen offset:0 sc0 sc1
    s_waitcnt vmcnt(3)
    v_lshlrev_b32 v56, 16, v196
    v_and_b32 v57, 0xffff0000, v196
    v_lshlrev_b32 v58, 16, v197
    v_and_b32 v59, 0xffff0000, v197
    v_pk_add_f32 v[72:73], v[72:73], v[56:57]
    v_pk_add_f32 v[74:75], v[74:75], v[58:59]
    v_cvt_pk_bf16_f32 v52, v72, v73
    v_cvt_pk_bf16_f32 v53, v74, v75
    v_lshlrev_b32 v56, 16, v198
    v_and_b32 v57, 0xffff0000, v198
    v_lshlrev_b32 v58, 16, v199
    v_and_b32 v59, 0xffff0000, v199
    v_pk_add_f32 v[76:77], v[76:77], v[56:57]
    v_pk_add_f32 v[78:79], v[78:79], v[58:59]
    v_cvt_pk_bf16_f32 v54, v76, v77
    v_cvt_pk_bf16_f32 v55, v78, v79
    s_nop 0
    v_permlane16_swap_b32 v52, v54
    v_permlane16_swap_b32 v53, v55
    buffer_store_dwordx4 v[52:55], v10, s[16:19], 0 offen offset:64 sc0 sc1
    s_waitcnt vmcnt(3)
    v_lshlrev_b32 v56, 16, v200
    v_and_b32 v57, 0xffff0000, v200
    v_lshlrev_b32 v58, 16, v201
    v_and_b32 v59, 0xffff0000, v201
    v_pk_add_f32 v[96:97], v[96:97], v[56:57]
    v_pk_add_f32 v[98:99], v[98:99], v[58:59]
    v_cvt_pk_bf16_f32 v48, v96, v97
    v_cvt_pk_bf16_f32 v49, v98, v99
    v_lshlrev_b32 v56, 16, v202
    v_and_b32 v57, 0xffff0000, v202
    v_lshlrev_b32 v58, 16, v203
    v_and_b32 v59, 0xffff0000, v203
    v_pk_add_f32 v[100:101], v[100:101], v[56:57]
    v_pk_add_f32 v[102:103], v[102:103], v[58:59]
    v_cvt_pk_bf16_f32 v50, v100, v101
    v_cvt_pk_bf16_f32 v51, v102, v103
    s_nop 0
    v_permlane16_swap_b32 v48, v50
    v_permlane16_swap_b32 v49, v51
    buffer_store_dwordx4 v[48:51], v11, s[16:19], 0 offen offset:0 sc0 sc1
    s_waitcnt vmcnt(3)
    v_lshlrev_b32 v56, 16, v204
    v_and_b32 v57, 0xffff0000, v204
    v_lshlrev_b32 v58, 16, v205
    v_and_b32 v59, 0xffff0000, v205
    v_pk_add_f32 v[104:105], v[104:105], v[56:57]
    v_pk_add_f32 v[106:107], v[106:107], v[58:59]
    v_cvt_pk_bf16_f32 v52, v104, v105
    v_cvt_pk_bf16_f32 v53, v106, v107
    v_lshlrev_b32 v56, 16, v206
    v_and_b32 v57, 0xffff0000, v206
    v_lshlrev_b32 v58, 16, v207
    v_and_b32 v59, 0xffff0000, v207
    v_pk_add_f32 v[108:109], v[108:109], v[56:57]
    v_pk_add_f32 v[110:111], v[110:111], v[58:59]
    v_cvt_pk_bf16_f32 v54, v108, v109
    v_cvt_pk_bf16_f32 v55, v110, v111
    s_nop 0
    v_permlane16_swap_b32 v52, v54
    v_permlane16_swap_b32 v53, v55
    buffer_store_dwordx4 v[52:55], v11, s[16:19], 0 offen offset:64 sc0 sc1
    s_branch gated_mix__linear_kernel_hedgehog__mixer_channel_mlp__prompt_kernel_s2_done
gated_mix__linear_kernel_hedgehog__mixer_channel_mlp__prompt_kernel_s2_final:
    v_sub_f32 v13, 1.0, v12
    v_sub_f32 v15, 1.0, v14
    s_mov_b32 s46, 16384
    v_pk_mul_f32 v[128:129], v[128:129], v[12:13] op_sel:[0,1] op_sel_hi:[1,1]
    v_pk_mul_f32 v[130:131], v[130:131], v[12:13] op_sel:[0,1] op_sel_hi:[1,1]
    v_pk_fma_f32 v[128:129], v[64:65], v[12:13], v[128:129] op_sel_hi:[1,0,1]
    v_pk_fma_f32 v[130:131], v[66:67], v[12:13], v[130:131] op_sel_hi:[1,0,1]
    v_cvt_pk_bf16_f32 v192, v128, v129
    v_cvt_pk_bf16_f32 v193, v130, v131
    v_pk_mul_f32 v[132:133], v[132:133], v[12:13] op_sel:[0,1] op_sel_hi:[1,1]
    v_pk_mul_f32 v[134:135], v[134:135], v[12:13] op_sel:[0,1] op_sel_hi:[1,1]
    v_pk_fma_f32 v[132:133], v[68:69], v[12:13], v[132:133] op_sel_hi:[1,0,1]
    v_pk_fma_f32 v[134:135], v[70:71], v[12:13], v[134:135] op_sel_hi:[1,0,1]
    v_cvt_pk_bf16_f32 v194, v132, v133
    v_cvt_pk_bf16_f32 v195, v134, v135
    buffer_store_dwordx4 v[192:195], v3, s[20:23], s46 offen sc1
    v_pk_mul_f32 v[136:137], v[136:137], v[12:13] op_sel:[0,1] op_sel_hi:[1,1]
    v_pk_mul_f32 v[138:139], v[138:139], v[12:13] op_sel:[0,1] op_sel_hi:[1,1]
    v_pk_fma_f32 v[136:137], v[72:73], v[12:13], v[136:137] op_sel_hi:[1,0,1]
    v_pk_fma_f32 v[138:139], v[74:75], v[12:13], v[138:139] op_sel_hi:[1,0,1]
    v_cvt_pk_bf16_f32 v196, v136, v137
    v_cvt_pk_bf16_f32 v197, v138, v139
    v_pk_mul_f32 v[140:141], v[140:141], v[12:13] op_sel:[0,1] op_sel_hi:[1,1]
    v_pk_mul_f32 v[142:143], v[142:143], v[12:13] op_sel:[0,1] op_sel_hi:[1,1]
    v_pk_fma_f32 v[140:141], v[76:77], v[12:13], v[140:141] op_sel_hi:[1,0,1]
    v_pk_fma_f32 v[142:143], v[78:79], v[12:13], v[142:143] op_sel_hi:[1,0,1]
    v_cvt_pk_bf16_f32 v198, v140, v141
    v_cvt_pk_bf16_f32 v199, v142, v143
    buffer_store_dwordx4 v[196:199], v3, s[20:23], s46 offen offset:1024 sc1
    v_pk_mul_f32 v[160:161], v[160:161], v[14:15] op_sel:[0,1] op_sel_hi:[1,1]
    v_pk_mul_f32 v[162:163], v[162:163], v[14:15] op_sel:[0,1] op_sel_hi:[1,1]
    v_pk_fma_f32 v[160:161], v[96:97], v[14:15], v[160:161] op_sel_hi:[1,0,1]
    v_pk_fma_f32 v[162:163], v[98:99], v[14:15], v[162:163] op_sel_hi:[1,0,1]
    v_cvt_pk_bf16_f32 v200, v160, v161
    v_cvt_pk_bf16_f32 v201, v162, v163
    v_pk_mul_f32 v[164:165], v[164:165], v[14:15] op_sel:[0,1] op_sel_hi:[1,1]
    v_pk_mul_f32 v[166:167], v[166:167], v[14:15] op_sel:[0,1] op_sel_hi:[1,1]
    v_pk_fma_f32 v[164:165], v[100:101], v[14:15], v[164:165] op_sel_hi:[1,0,1]
    v_pk_fma_f32 v[166:167], v[102:103], v[14:15], v[166:167] op_sel_hi:[1,0,1]
    v_cvt_pk_bf16_f32 v202, v164, v165
    v_cvt_pk_bf16_f32 v203, v166, v167
    buffer_store_dwordx4 v[200:203], v3, s[20:23], s46 offen offset:2048 sc1
    v_pk_mul_f32 v[168:169], v[168:169], v[14:15] op_sel:[0,1] op_sel_hi:[1,1]
    v_pk_mul_f32 v[170:171], v[170:171], v[14:15] op_sel:[0,1] op_sel_hi:[1,1]
    v_pk_fma_f32 v[168:169], v[104:105], v[14:15], v[168:169] op_sel_hi:[1,0,1]
    v_pk_fma_f32 v[170:171], v[106:107], v[14:15], v[170:171] op_sel_hi:[1,0,1]
    v_cvt_pk_bf16_f32 v204, v168, v169
    v_cvt_pk_bf16_f32 v205, v170, v171
    v_pk_mul_f32 v[172:173], v[172:173], v[14:15] op_sel:[0,1] op_sel_hi:[1,1]
    v_pk_mul_f32 v[174:175], v[174:175], v[14:15] op_sel:[0,1] op_sel_hi:[1,1]
    v_pk_fma_f32 v[172:173], v[108:109], v[14:15], v[172:173] op_sel_hi:[1,0,1]
    v_pk_fma_f32 v[174:175], v[110:111], v[14:15], v[174:175] op_sel_hi:[1,0,1]
    v_cvt_pk_bf16_f32 v206, v172, v173
    v_cvt_pk_bf16_f32 v207, v174, v175
    buffer_store_dwordx4 v[204:207], v3, s[20:23], s46 offen offset:3072 sc1
    v_lshlrev_b32 v18, 16, v40
    v_and_b32 v19, 0xffff0000, v40
    v_lshlrev_b32 v20, 16, v41
    v_and_b32 v21, 0xffff0000, v41
    v_pk_add_f32 v[144:145], v[144:145], v[18:19]
    v_pk_add_f32 v[146:147], v[146:147], v[20:21]
    v_pk_mul_f32 v[144:145], v[144:145], v[12:13] op_sel:[0,1] op_sel_hi:[1,1]
    v_pk_mul_f32 v[146:147], v[146:147], v[12:13] op_sel:[0,1] op_sel_hi:[1,1]
    v_pk_fma_f32 v[144:145], v[80:81], v[12:13], v[144:145] op_sel_hi:[1,0,1]
    v_pk_fma_f32 v[146:147], v[82:83], v[12:13], v[146:147] op_sel_hi:[1,0,1]
    v_pk_add_f32 v[176:177], v[176:177], v[18:19]
    v_pk_add_f32 v[178:179], v[178:179], v[20:21]
    v_pk_mul_f32 v[176:177], v[176:177], v[14:15] op_sel:[0,1] op_sel_hi:[1,1]
    v_pk_mul_f32 v[178:179], v[178:179], v[14:15] op_sel:[0,1] op_sel_hi:[1,1]
    v_pk_fma_f32 v[176:177], v[112:113], v[14:15], v[176:177] op_sel_hi:[1,0,1]
    v_pk_fma_f32 v[178:179], v[114:115], v[14:15], v[178:179] op_sel_hi:[1,0,1]
    v_lshlrev_b32 v18, 16, v42
    v_and_b32 v19, 0xffff0000, v42
    v_lshlrev_b32 v20, 16, v43
    v_and_b32 v21, 0xffff0000, v43
    v_pk_add_f32 v[148:149], v[148:149], v[18:19]
    v_pk_add_f32 v[150:151], v[150:151], v[20:21]
    v_pk_mul_f32 v[148:149], v[148:149], v[12:13] op_sel:[0,1] op_sel_hi:[1,1]
    v_pk_mul_f32 v[150:151], v[150:151], v[12:13] op_sel:[0,1] op_sel_hi:[1,1]
    v_pk_fma_f32 v[148:149], v[84:85], v[12:13], v[148:149] op_sel_hi:[1,0,1]
    v_pk_fma_f32 v[150:151], v[86:87], v[12:13], v[150:151] op_sel_hi:[1,0,1]
    v_pk_add_f32 v[180:181], v[180:181], v[18:19]
    v_pk_add_f32 v[182:183], v[182:183], v[20:21]
    v_pk_mul_f32 v[180:181], v[180:181], v[14:15] op_sel:[0,1] op_sel_hi:[1,1]
    v_pk_mul_f32 v[182:183], v[182:183], v[14:15] op_sel:[0,1] op_sel_hi:[1,1]
    v_pk_fma_f32 v[180:181], v[116:117], v[14:15], v[180:181] op_sel_hi:[1,0,1]
    v_pk_fma_f32 v[182:183], v[118:119], v[14:15], v[182:183] op_sel_hi:[1,0,1]
    v_lshlrev_b32 v18, 16, v44
    v_and_b32 v19, 0xffff0000, v44
    v_lshlrev_b32 v20, 16, v45
    v_and_b32 v21, 0xffff0000, v45
    v_pk_add_f32 v[152:153], v[152:153], v[18:19]
    v_pk_add_f32 v[154:155], v[154:155], v[20:21]
    v_pk_mul_f32 v[152:153], v[152:153], v[12:13] op_sel:[0,1] op_sel_hi:[1,1]
    v_pk_mul_f32 v[154:155], v[154:155], v[12:13] op_sel:[0,1] op_sel_hi:[1,1]
    v_pk_fma_f32 v[152:153], v[88:89], v[12:13], v[152:153] op_sel_hi:[1,0,1]
    v_pk_fma_f32 v[154:155], v[90:91], v[12:13], v[154:155] op_sel_hi:[1,0,1]
    v_pk_add_f32 v[184:185], v[184:185], v[18:19]
    v_pk_add_f32 v[186:187], v[186:187], v[20:21]
    v_pk_mul_f32 v[184:185], v[184:185], v[14:15] op_sel:[0,1] op_sel_hi:[1,1]
    v_pk_mul_f32 v[186:187], v[186:187], v[14:15] op_sel:[0,1] op_sel_hi:[1,1]
    v_pk_fma_f32 v[184:185], v[120:121], v[14:15], v[184:185] op_sel_hi:[1,0,1]
    v_pk_fma_f32 v[186:187], v[122:123], v[14:15], v[186:187] op_sel_hi:[1,0,1]
    v_lshlrev_b32 v18, 16, v46
    v_and_b32 v19, 0xffff0000, v46
    v_lshlrev_b32 v20, 16, v47
    v_and_b32 v21, 0xffff0000, v47
    v_pk_add_f32 v[156:157], v[156:157], v[18:19]
    v_pk_add_f32 v[158:159], v[158:159], v[20:21]
    v_pk_mul_f32 v[156:157], v[156:157], v[12:13] op_sel:[0,1] op_sel_hi:[1,1]
    v_pk_mul_f32 v[158:159], v[158:159], v[12:13] op_sel:[0,1] op_sel_hi:[1,1]
    v_pk_fma_f32 v[156:157], v[92:93], v[12:13], v[156:157] op_sel_hi:[1,0,1]
    v_pk_fma_f32 v[158:159], v[94:95], v[12:13], v[158:159] op_sel_hi:[1,0,1]
    v_pk_add_f32 v[188:189], v[188:189], v[18:19]
    v_pk_add_f32 v[190:191], v[190:191], v[20:21]
    v_pk_mul_f32 v[188:189], v[188:189], v[14:15] op_sel:[0,1] op_sel_hi:[1,1]
    v_pk_mul_f32 v[190:191], v[190:191], v[14:15] op_sel:[0,1] op_sel_hi:[1,1]
    v_pk_fma_f32 v[188:189], v[124:125], v[14:15], v[188:189] op_sel_hi:[1,0,1]
    v_pk_fma_f32 v[190:191], v[126:127], v[14:15], v[190:191] op_sel_hi:[1,0,1]
    s_xor_b32 s46, s2, 4
    s_add_u32 s45, s32, 56
    s_add_u32 s72, s52, 23592960
    s_addc_u32 s73, s53, 0
    s_mov_b32 s74, 65536
    s_mov_b32 s75, 0x20000
    v_mov_b32 v8, s46
    v_lshlrev_b32 v8, 6, v8
    v_add_u32 v8, s45, v8
    v_lshlrev_b32 v8, 2, v8
    v_mov_b32 v9, 0x7ffffff0
    v_cmp_gt_u32 vcc, 1, v1
    s_nop 1
    v_cndmask_b32 v8, v9, v8, vcc
    s_lshl_b32 s45, s45, 2
    v_mov_b32 v16, s45
    v_mov_b32 v9, 1
    s_waitcnt vmcnt(0)
    buffer_store_dword v9, v8, s[72:75], 0 offen sc1
    global_load_dword v17, v16, s[100:101] sc1
    s_waitcnt vmcnt(0)
    s_mov_b32 s44, 32768
wait_36:
    v_cmp_ne_u32 vcc, 1, v17
    s_nop 4
    s_cbranch_vccz wait_36_ok
    s_sub_u32 s44, s44, 1
    s_cbranch_scc1 wait_36_ok
    s_sleep 1
    global_load_dword v17, v16, s[100:101] sc1
    s_waitcnt vmcnt(0)
    s_branch wait_36
wait_36_ok:
    s_mov_b32 s46, 0
    buffer_load_dwordx4 v[192:195], v3, s[20:23], s46 offen sc1
    buffer_load_dwordx4 v[196:199], v3, s[20:23], s46 offen offset:1024 sc1
    buffer_load_dwordx4 v[200:203], v3, s[20:23], s46 offen offset:2048 sc1
    buffer_load_dwordx4 v[204:207], v3, s[20:23], s46 offen offset:3072 sc1
    s_waitcnt vmcnt(3)
    v_lshlrev_b32 v56, 16, v192
    v_and_b32 v57, 0xffff0000, v192
    v_lshlrev_b32 v58, 16, v193
    v_and_b32 v59, 0xffff0000, v193
    v_pk_fma_f32 v[144:145], v[56:57], v[12:13], v[144:145] op_sel:[0,1,0] op_sel_hi:[1,1,1]
    v_pk_fma_f32 v[146:147], v[58:59], v[12:13], v[146:147] op_sel:[0,1,0] op_sel_hi:[1,1,1]
    v_cvt_pk_bf16_f32 v48, v144, v145
    v_cvt_pk_bf16_f32 v49, v146, v147
    v_lshlrev_b32 v56, 16, v194
    v_and_b32 v57, 0xffff0000, v194
    v_lshlrev_b32 v58, 16, v195
    v_and_b32 v59, 0xffff0000, v195
    v_pk_fma_f32 v[148:149], v[56:57], v[12:13], v[148:149] op_sel:[0,1,0] op_sel_hi:[1,1,1]
    v_pk_fma_f32 v[150:151], v[58:59], v[12:13], v[150:151] op_sel:[0,1,0] op_sel_hi:[1,1,1]
    v_cvt_pk_bf16_f32 v50, v148, v149
    v_cvt_pk_bf16_f32 v51, v150, v151
    s_nop 0
    v_permlane16_swap_b32 v48, v50
    v_permlane16_swap_b32 v49, v51
    buffer_store_dwordx4 v[48:51], v10, s[16:19], 0 offen offset:128 sc0 sc1
    s_waitcnt vmcnt(3)
    v_lshlrev_b32 v56, 16, v196
    v_and_b32 v57, 0xffff0000, v196
    v_lshlrev_b32 v58, 16, v197
    v_and_b32 v59, 0xffff0000, v197
    v_pk_fma_f32 v[152:153], v[56:57], v[12:13], v[152:153] op_sel:[0,1,0] op_sel_hi:[1,1,1]
    v_pk_fma_f32 v[154:155], v[58:59], v[12:13], v[154:155] op_sel:[0,1,0] op_sel_hi:[1,1,1]
    v_cvt_pk_bf16_f32 v52, v152, v153
    v_cvt_pk_bf16_f32 v53, v154, v155
    v_lshlrev_b32 v56, 16, v198
    v_and_b32 v57, 0xffff0000, v198
    v_lshlrev_b32 v58, 16, v199
    v_and_b32 v59, 0xffff0000, v199
    v_pk_fma_f32 v[156:157], v[56:57], v[12:13], v[156:157] op_sel:[0,1,0] op_sel_hi:[1,1,1]
    v_pk_fma_f32 v[158:159], v[58:59], v[12:13], v[158:159] op_sel:[0,1,0] op_sel_hi:[1,1,1]
    v_cvt_pk_bf16_f32 v54, v156, v157
    v_cvt_pk_bf16_f32 v55, v158, v159
    s_nop 0
    v_permlane16_swap_b32 v52, v54
    v_permlane16_swap_b32 v53, v55
    buffer_store_dwordx4 v[52:55], v10, s[16:19], 0 offen offset:192 sc0 sc1
    s_waitcnt vmcnt(3)
    v_lshlrev_b32 v56, 16, v200
    v_and_b32 v57, 0xffff0000, v200
    v_lshlrev_b32 v58, 16, v201
    v_and_b32 v59, 0xffff0000, v201
    v_pk_fma_f32 v[176:177], v[56:57], v[14:15], v[176:177] op_sel:[0,1,0] op_sel_hi:[1,1,1]
    v_pk_fma_f32 v[178:179], v[58:59], v[14:15], v[178:179] op_sel:[0,1,0] op_sel_hi:[1,1,1]
    v_cvt_pk_bf16_f32 v48, v176, v177
    v_cvt_pk_bf16_f32 v49, v178, v179
    v_lshlrev_b32 v56, 16, v202
    v_and_b32 v57, 0xffff0000, v202
    v_lshlrev_b32 v58, 16, v203
    v_and_b32 v59, 0xffff0000, v203
    v_pk_fma_f32 v[180:181], v[56:57], v[14:15], v[180:181] op_sel:[0,1,0] op_sel_hi:[1,1,1]
    v_pk_fma_f32 v[182:183], v[58:59], v[14:15], v[182:183] op_sel:[0,1,0] op_sel_hi:[1,1,1]
    v_cvt_pk_bf16_f32 v50, v180, v181
    v_cvt_pk_bf16_f32 v51, v182, v183
    s_nop 0
    v_permlane16_swap_b32 v48, v50
    v_permlane16_swap_b32 v49, v51
    buffer_store_dwordx4 v[48:51], v11, s[16:19], 0 offen offset:128 sc0 sc1
    s_waitcnt vmcnt(3)
    v_lshlrev_b32 v56, 16, v204
    v_and_b32 v57, 0xffff0000, v204
    v_lshlrev_b32 v58, 16, v205
    v_and_b32 v59, 0xffff0000, v205
    v_pk_fma_f32 v[184:185], v[56:57], v[14:15], v[184:185] op_sel:[0,1,0] op_sel_hi:[1,1,1]
    v_pk_fma_f32 v[186:187], v[58:59], v[14:15], v[186:187] op_sel:[0,1,0] op_sel_hi:[1,1,1]
    v_cvt_pk_bf16_f32 v52, v184, v185
    v_cvt_pk_bf16_f32 v53, v186, v187
    v_lshlrev_b32 v56, 16, v206
    v_and_b32 v57, 0xffff0000, v206
    v_lshlrev_b32 v58, 16, v207
    v_and_b32 v59, 0xffff0000, v207
    v_pk_fma_f32 v[188:189], v[56:57], v[14:15], v[188:189] op_sel:[0,1,0] op_sel_hi:[1,1,1]
    v_pk_fma_f32 v[190:191], v[58:59], v[14:15], v[190:191] op_sel:[0,1,0] op_sel_hi:[1,1,1]
    v_cvt_pk_bf16_f32 v54, v188, v189
    v_cvt_pk_bf16_f32 v55, v190, v191
    s_nop 0
    v_permlane16_swap_b32 v52, v54
    v_permlane16_swap_b32 v53, v55
    buffer_store_dwordx4 v[52:55], v11, s[16:19], 0 offen offset:192 sc0 sc1
gated_mix__linear_kernel_hedgehog__mixer_channel_mlp__prompt_kernel_s2_done:
gated_mix__linear_kernel_hedgehog__mixer_channel_mlp__prompt_kernel_end:
    s_endpgm
.section .rodata,"a"
.p2align 6
.amdhsa_kernel gated_mix__linear_kernel_hedgehog__mixer_channel_mlp__prompt_kernel
  .amdhsa_next_free_vgpr 512
  .amdhsa_next_free_sgpr 102
  .amdhsa_accum_offset 256
  .amdhsa_group_segment_fixed_size 0
  .amdhsa_kernarg_size 104
  .amdhsa_user_sgpr_count 2
  .amdhsa_user_sgpr_kernarg_segment_ptr 1
  .amdhsa_system_sgpr_workgroup_id_x 1
  .amdhsa_float_denorm_mode_32 3
  .amdhsa_float_denorm_mode_16_64 3
.end_amdhsa_kernel
.text
```
